```python
import torch

def _softmax(x, axis=-1):
    return torch.softmax(x, dim=axis)
def _gelu(x):
    return torch.nn.functional.gelu(x, approximate="tanh")
def _silu(x):
    return torch.nn.functional.silu(x)
def _sigmoid(x):
    return torch.sigmoid(x)
def _layernorm(x, axis=-1, eps=1e-5):
    m = x.mean(dim=axis, keepdim=True)
    v = x.var(dim=axis, keepdim=True, unbiased=False)
    return (x - m) / torch.sqrt(v + eps)
def _scatter_add(tgt, idx, src, axis=0):
    return tgt.clone().index_add_(axis, idx, src)
def _segment_sum(src, seg, n):
    out = torch.zeros((n,) + src.shape[1:], dtype=src.dtype)
    return out.index_add_(0, seg, src)
def _pad(x, pw):
    flat = tuple(v for pair in reversed(pw) for v in pair)
    return torch.nn.functional.pad(x, flat)

kernel_name = 'gated_mix__ssm_conv_s4d__ssm_conv_s5__prompt'

def setup_inputs():

    _w = (lambda a: (lambda t: t.to(torch.bfloat16) if t.is_floating_point() else t)(torch.as_tensor(a)))
    def _A_setup():
        Bsz, L, D, N = 1, 2048, 640, 128
        return {
            "u": _w((lambda *s: torch.randn(*s, dtype=torch.bfloat16) * 0.05)(Bsz, L, D)),
            "log_A_real": _w((lambda *s: torch.randn(*s, dtype=torch.bfloat16) * 3.2)(D, N) * 0.5),
            "A_imag": _w((lambda *s: torch.randn(*s, dtype=torch.bfloat16) * 0.05)(D, N) * 3.14),
            "C_real": _w((lambda *s: torch.randn(*s, dtype=torch.bfloat16) * 0.1)(D, N) / N ** 0.5),
            "C_imag": _w((lambda *s: torch.randn(*s, dtype=torch.bfloat16) * 0.1)(D, N) / N ** 0.5),
            "log_dt": _w((lambda *s: torch.randn(*s, dtype=torch.bfloat16) * 0.05)(D) * 0.5 - 4.0),
            "D_skip": _w((lambda *s: torch.randn(*s, dtype=torch.bfloat16) * 0.05)(D)),
        }
    _A_in = _A_setup()

    def _B_setup():
        B, S, D = 1, 2048, 640
        P = D
        Lambda_re = -0.5 * (lambda _x: torch.exp(torch.as_tensor(_x)))((lambda *s: torch.randn(*s, dtype=torch.bfloat16) * 0.2)(P))
        Lambda_im = (lambda *s: torch.randn(*s, dtype=torch.bfloat16) * 0.4)(P) * 1.0
        B_re = (lambda *s: torch.randn(*s, dtype=torch.bfloat16) * 0.2)(P, D) * (D ** -0.5)
        B_im = (lambda *s: torch.randn(*s, dtype=torch.bfloat16) * 0.2)(P, D) * (D ** -0.5)
        C_re = (lambda *s: torch.randn(*s, dtype=torch.bfloat16) * 0.2)(D, P) * (P ** -0.5)
        C_im = (lambda *s: torch.randn(*s, dtype=torch.bfloat16) * 0.2)(D, P) * (P ** -0.5)
        log_dt = (lambda *s: torch.randn(*s, dtype=torch.bfloat16) * 0.2)(P) * 0.3 - 2.0
        Dskip = (lambda *s: torch.randn(*s, dtype=torch.bfloat16) * 0.05)(D)
        return {
            "x": _w((lambda *s: torch.randn(*s, dtype=torch.bfloat16) * 0.05)(B, S, D)),
            "Lambda_re": _w(Lambda_re),
            "Lambda_im": _w(Lambda_im),
            "B_re": _w(B_re),
            "B_im": _w(B_im),
            "C_re": _w(C_re),
            "C_im": _w(C_im),
            "log_dt": _w(log_dt),
            "Dskip": _w(Dskip),
        }
    _B_in = _B_setup()

    return {
        "A_u": _A_in["u"],
        "A_log_A_real": _A_in["log_A_real"],
        "A_A_imag": _A_in["A_imag"],
        "A_C_real": _A_in["C_real"],
        "A_C_imag": _A_in["C_imag"],
        "A_log_dt": _A_in["log_dt"],
        "A_D_skip": _A_in["D_skip"],
        "B_x": _B_in["x"],
        "B_Lambda_re": _B_in["Lambda_re"],
        "B_Lambda_im": _B_in["Lambda_im"],
        "B_B_re": _B_in["B_re"],
        "B_B_im": _B_in["B_im"],
        "B_C_re": _B_in["C_re"],
        "B_C_im": _B_in["C_im"],
        "B_log_dt": _B_in["log_dt"],
        "B_Dskip": _B_in["Dskip"],
        "gate_w": _w((lambda *s: torch.randn(*s, dtype=torch.bfloat16) * 0.05)(640) * 16.0),
    }

def reference(A_u, A_log_A_real, A_A_imag, A_C_real, A_C_imag, A_log_dt, A_D_skip, B_x, B_Lambda_re, B_Lambda_im, B_B_re, B_B_im, B_C_re, B_C_im, B_log_dt, B_Dskip, gate_w):
    def _A_ref(u, log_A_real, A_imag, C_real, C_imag, log_dt, D_skip):
        L = u.shape[1]
        dt = torch.exp(log_dt)
        A = -torch.exp(log_A_real) + 1j * A_imag
        C = (C_real + 1j * C_imag) * dt[:, None]
        pos = (lambda x, dt: x.to(dt))(torch.arange(L), log_dt.dtype)
        P = torch.exp((A * dt[:, None])[:, :, None] * pos[None, None, :])
        K = 2.0 * torch.einsum("dn,dnl->dl", C, P).real
        L2 = 2 * L
        u_t = (lambda x, *d: x.permute(*d))(u, 0, 2, 1)
        Kf = (lambda x, *a, **k: torch.fft.rfft(x.float(), *a, **k))(K, L2)
        Uf = (lambda x, *a, **k: torch.fft.rfft(x.float(), *a, **k))(u_t, L2)
        y = (lambda x, *a, **k: torch.fft.irfft(x, *a, **k).to(torch.bfloat16))(Uf * Kf[None, :, :], L2)[:, :, :L]
        y = (lambda x, *d: x.permute(*d))(y, 0, 2, 1)
        return y + u * D_skip[None, None, :]

    def _B_ref(x, Lambda_re, Lambda_im, B_re, B_im, C_re, C_im, log_dt, Dskip):
        Bsz, L, H = x.shape
        Lam = Lambda_re + 1j * Lambda_im
        Bmat = B_re + 1j * B_im
        Cmat = C_re + 1j * C_im
        dt = torch.exp(log_dt)
        Lam_bar = torch.exp(dt * Lam)
        B_bar = ((Lam_bar - 1.0) / Lam)[:, None] * Bmat
        Bu = torch.einsum("bld,pd->blp", x + 0j, B_bar)
        h = torch.zeros_like(Bu[:, 0, :])
        hs = []
        for t in range(L):
            h = Lam_bar[None, :] * h + Bu[:, t, :]
            hs.append(h)
        hseq = torch.stack(hs, 1)
        y = 2.0 * torch.einsum("blp,dp->bld", hseq, Cmat).real + x * Dskip[None, None, :]
        return y

    x = A_u
    g = _sigmoid((x * gate_w).sum(-1, keepdims=True))
    a = _A_ref(x, A_log_A_real, A_A_imag, A_C_real, A_C_imag, A_log_dt, A_D_skip)
    b = _B_ref(x, B_Lambda_re, B_Lambda_im, B_B_re, B_B_im, B_C_re, B_C_im, B_log_dt, B_Dskip)
    return g * a + (1 - g) * b
```

```asm
; @launch grid=(512,1,1) block=(256,1,1) lds=81920
.amdgcn_target "amdgcn-amd-amdhsa--gfx950"
.text
.globl gated_mix__ssm_conv_s4d__ssm_conv_s5__prompt_kernel
.p2align 8
.type gated_mix__ssm_conv_s4d__ssm_conv_s5__prompt_kernel,@function
gated_mix__ssm_conv_s4d__ssm_conv_s5__prompt_kernel:
    s_cmp_ge_u32 s2, 512
    s_cbranch_scc1 L_done
    s_and_b32 s3, s2, 255
    s_cmp_lt_u32 s2, 256
    s_cbranch_scc1 L_B
    s_load_dwordx2 s[8:9], s[0:1], 0
    s_load_dwordx4 s[12:15], s[0:1], 8
    s_load_dwordx4 s[16:19], s[0:1], 24
    s_load_dwordx4 s[20:23], s[0:1], 40
    s_load_dwordx2 s[24:25], s[0:1], 128
    s_load_dwordx2 s[26:27], s[0:1], 152
    s_load_dwordx4 s[28:31], s[0:1], 80
    v_lshrrev_b32 v2, 6, v0
    v_and_b32 v1, 63, v0
    v_readfirstlane_b32 s52, v2
    s_and_b32 s55, s3, 7
    s_lshr_b32 s56, s3, 3
    s_lshr_b32 s60, s55, 1
    s_lshl_b32 s68, s55, 5
    s_add_u32 s68, s68, s56
    s_lshl_b32 s60, s60, 3
    s_and_b32 s61, s56, 7
    s_add_u32 s60, s60, s61
    s_and_b32 s61, s55, 1
    s_lshl_b32 s61, s61, 2
    s_lshr_b32 s56, s56, 3
    s_add_u32 s61, s61, s56
    s_mul_i32 s55, s3, 3
    s_lshl_b32 s56, s3, 1
    s_add_u32 s56, s56, 128
    s_cmp_lt_u32 s3, 128
    s_cselect_b32 s53, s55, s56
    s_cselect_b32 s54, 3, 2
    s_add_u32 s53, s53, s52
    s_mul_i32 s57, s52, 23872
    v_lshlrev_b32 v10, 4, v1
    s_cmp_lt_u32 s52, s54
    s_cbranch_scc1 akg_2
    s_cmp_lg_u32 s52, 3
    s_cbranch_scc1 aexit_1
    v_add_u32 v2, 0, v1
    v_mul_u32_u24 v3, 205, v2
    v_lshrrev_b32 v3, 11, v3
    v_mul_u32_u24 v4, 10, v3
    v_sub_u32 v4, v2, v4
    v_lshlrev_b32 v4, 4, v4
    v_mul_u32_u24 v112, 1280, v3
    v_add_u32 v112, v112, v4
    v_add_u32 v2, 64, v1
    v_mul_u32_u24 v3, 205, v2
    v_lshrrev_b32 v3, 11, v3
    v_mul_u32_u24 v4, 10, v3
    v_sub_u32 v4, v2, v4
    v_lshlrev_b32 v4, 4, v4
    v_mul_u32_u24 v113, 1280, v3
    v_add_u32 v113, v113, v4
    v_add_u32 v2, 128, v1
    v_mul_u32_u24 v3, 205, v2
    v_lshrrev_b32 v3, 11, v3
    v_mul_u32_u24 v4, 10, v3
    v_sub_u32 v4, v2, v4
    v_lshlrev_b32 v4, 4, v4
    v_mul_u32_u24 v114, 1280, v3
    v_add_u32 v114, v114, v4
    v_add_u32 v2, 192, v1
    v_mul_u32_u24 v3, 205, v2
    v_lshrrev_b32 v3, 11, v3
    v_mul_u32_u24 v4, 10, v3
    v_sub_u32 v4, v2, v4
    v_lshlrev_b32 v4, 4, v4
    v_mul_u32_u24 v115, 1280, v3
    v_add_u32 v115, v115, v4
    v_add_u32 v2, 256, v1
    v_mul_u32_u24 v3, 205, v2
    v_lshrrev_b32 v3, 11, v3
    v_mul_u32_u24 v4, 10, v3
    v_sub_u32 v4, v2, v4
    v_lshlrev_b32 v4, 4, v4
    v_mul_u32_u24 v116, 1280, v3
    v_add_u32 v116, v116, v4
    v_add_u32 v2, 320, v1
    v_mul_u32_u24 v3, 205, v2
    v_lshrrev_b32 v3, 11, v3
    v_mul_u32_u24 v4, 10, v3
    v_sub_u32 v4, v2, v4
    v_lshlrev_b32 v4, 4, v4
    v_mul_u32_u24 v117, 1280, v3
    v_add_u32 v117, v117, v4
    v_add_u32 v2, 384, v1
    v_mul_u32_u24 v3, 205, v2
    v_lshrrev_b32 v3, 11, v3
    v_mul_u32_u24 v4, 10, v3
    v_sub_u32 v4, v2, v4
    v_lshlrev_b32 v4, 4, v4
    v_mul_u32_u24 v118, 1280, v3
    v_add_u32 v118, v118, v4
    v_add_u32 v2, 448, v1
    v_mul_u32_u24 v3, 205, v2
    v_lshrrev_b32 v3, 11, v3
    v_mul_u32_u24 v4, 10, v3
    v_sub_u32 v4, v2, v4
    v_lshlrev_b32 v4, 4, v4
    v_mul_u32_u24 v119, 1280, v3
    v_add_u32 v119, v119, v4
    v_add_u32 v2, 512, v1
    v_mul_u32_u24 v3, 205, v2
    v_lshrrev_b32 v3, 11, v3
    v_mul_u32_u24 v4, 10, v3
    v_sub_u32 v4, v2, v4
    v_lshlrev_b32 v4, 4, v4
    v_mul_u32_u24 v120, 1280, v3
    v_add_u32 v120, v120, v4
    v_add_u32 v2, 576, v1
    v_mul_u32_u24 v3, 205, v2
    v_lshrrev_b32 v3, 11, v3
    v_mul_u32_u24 v4, 10, v3
    v_sub_u32 v4, v2, v4
    v_lshlrev_b32 v4, 4, v4
    v_mul_u32_u24 v121, 1280, v3
    v_add_u32 v121, v121, v4
    v_lshrrev_b32 v2, 4, v1
    v_and_b32 v3, 15, v1
    v_lshlrev_b32 v124, 4, v3
    v_mul_u32_u24 v122, 1280, v2
    v_add_u32 v122, v122, v124
    v_add_u32 v123, 5120, v122
    s_waitcnt lgkmcnt(0)
    s_add_u32 s64, s26, 13320192
    s_addc_u32 s65, s27, 0
    s_load_dword s62, s[64:65], 0
    s_mov_b32 s32, s8
    s_and_b32 s33, s9, 0xffff
    s_mov_b32 s34, 2621440
    s_mov_b32 s35, 0x00020000
    s_mov_b32 s36, s24
    s_and_b32 s37, s25, 0xffff
    s_mov_b32 s38, 1280
    s_mov_b32 s39, 0x00020000
    s_mul_i32 s55, s60, 81920
    s_mul_i32 s56, s61, 160
    s_add_u32 s55, s55, s56
    buffer_load_dwordx4 v[12:15], v112, s[32:35], s55 offen
    buffer_load_dwordx4 v[16:19], v113, s[32:35], s55 offen
    buffer_load_dwordx4 v[20:23], v114, s[32:35], s55 offen
    buffer_load_dwordx4 v[24:27], v115, s[32:35], s55 offen
    buffer_load_dwordx4 v[28:31], v116, s[32:35], s55 offen
    buffer_load_dwordx4 v[32:35], v117, s[32:35], s55 offen
    buffer_load_dwordx4 v[36:39], v118, s[32:35], s55 offen
    buffer_load_dwordx4 v[40:43], v119, s[32:35], s55 offen
    buffer_load_dwordx4 v[44:47], v120, s[32:35], s55 offen
    buffer_load_dwordx4 v[48:51], v121, s[32:35], s55 offen
    s_mul_i32 s56, s68, 10240
    buffer_load_dwordx4 v[52:55], v122, s[32:35], s56 offen offset:0
    buffer_load_dwordx4 v[56:59], v122, s[32:35], s56 offen offset:256
    buffer_load_dwordx4 v[60:63], v122, s[32:35], s56 offen offset:512
    buffer_load_dwordx4 v[64:67], v122, s[32:35], s56 offen offset:768
    buffer_load_dwordx4 v[68:71], v122, s[32:35], s56 offen offset:1024
    buffer_load_dwordx4 v[72:75], v123, s[32:35], s56 offen offset:0
    buffer_load_dwordx4 v[76:79], v123, s[32:35], s56 offen offset:256
    buffer_load_dwordx4 v[80:83], v123, s[32:35], s56 offen offset:512
    buffer_load_dwordx4 v[84:87], v123, s[32:35], s56 offen offset:768
    buffer_load_dwordx4 v[88:91], v123, s[32:35], s56 offen offset:1024
    buffer_load_dwordx4 v[92:95], v124, s[36:39], 0 offen offset:0
    buffer_load_dwordx4 v[96:99], v124, s[36:39], 0 offen offset:256
    buffer_load_dwordx4 v[100:103], v124, s[36:39], 0 offen offset:512
    buffer_load_dwordx4 v[104:107], v124, s[36:39], 0 offen offset:768
    buffer_load_dwordx4 v[108:111], v124, s[36:39], 0 offen offset:1024
    s_add_u32 s40, s26, 5414912
    s_addc_u32 s41, s27, 0
    s_and_b32 s41, s41, 0xffff
    s_mov_b32 s42, 2621440
    s_mov_b32 s43, 0x00020000
    s_add_u32 s48, s26, 5406720
    s_addc_u32 s49, s27, 0
    s_and_b32 s49, s49, 0xffff
    s_mov_b32 s50, 8192
    s_mov_b32 s51, 0x00020000
    s_add_u32 s44, s26, 13320448
    s_addc_u32 s45, s27, 0
    s_and_b32 s45, s45, 0xffff
    s_mov_b32 s46, 12288
    s_mov_b32 s47, 0x00020000
    v_add_u32 v125, 71680, v10
    v_lshrrev_b32 v2, 4, v1
    v_and_b32 v3, 15, v1
    v_lshrrev_b32 v4, 2, v3
    v_and_b32 v5, 3, v3
    v_lshlrev_b32 v6, 3, v2
    v_add_u32 v6, v6, v4
    v_mul_u32_u24 v6, 160, v6
    v_lshlrev_b32 v5, 3, v5
    v_add_u32 v126, v6, v5
    v_add_u32 v126, 71680, v126
    v_lshlrev_b32 v127, 12, v3
    v_lshlrev_b32 v2, 4, v2
    v_add_u32 v127, v127, v2
    s_mul_i32 s12, s61, 327680
    s_lshl_b32 s56, s60, 7
    s_add_u32 s12, s12, s56
    s_waitcnt vmcnt(24)
    ds_write_b128 v125, v[12:15] offset:0
    s_waitcnt vmcnt(23)
    ds_write_b128 v125, v[16:19] offset:1024
    s_waitcnt vmcnt(22)
    ds_write_b128 v125, v[20:23] offset:2048
    s_waitcnt vmcnt(21)
    ds_write_b128 v125, v[24:27] offset:3072
    s_waitcnt vmcnt(20)
    ds_write_b128 v125, v[28:31] offset:4096
    s_waitcnt vmcnt(19)
    ds_write_b128 v125, v[32:35] offset:5120
    s_waitcnt vmcnt(18)
    ds_write_b128 v125, v[36:39] offset:6144
    s_waitcnt vmcnt(17)
    ds_write_b128 v125, v[40:43] offset:7168
    s_waitcnt vmcnt(16)
    ds_write_b128 v125, v[44:47] offset:8192
    s_waitcnt vmcnt(15)
    ds_write_b128 v125, v[48:51] offset:9216
    s_waitcnt lgkmcnt(0)
    s_add_u32 s62, s62, 1
    s_barrier
    ds_read_b64_tr_b16 v[12:13], v126 offset:0
    ds_read_b64_tr_b16 v[14:15], v126 offset:640
    ds_read_b64_tr_b16 v[16:17], v126 offset:5120
    ds_read_b64_tr_b16 v[18:19], v126 offset:5760
    ds_read_b64_tr_b16 v[20:21], v126 offset:32
    ds_read_b64_tr_b16 v[22:23], v126 offset:672
    ds_read_b64_tr_b16 v[24:25], v126 offset:5152
    ds_read_b64_tr_b16 v[26:27], v126 offset:5792
    ds_read_b64_tr_b16 v[28:29], v126 offset:64
    ds_read_b64_tr_b16 v[30:31], v126 offset:704
    ds_read_b64_tr_b16 v[32:33], v126 offset:5184
    ds_read_b64_tr_b16 v[34:35], v126 offset:5824
    ds_read_b64_tr_b16 v[36:37], v126 offset:96
    ds_read_b64_tr_b16 v[38:39], v126 offset:736
    ds_read_b64_tr_b16 v[40:41], v126 offset:5216
    ds_read_b64_tr_b16 v[42:43], v126 offset:5856
    ds_read_b64_tr_b16 v[44:45], v126 offset:128
    ds_read_b64_tr_b16 v[46:47], v126 offset:768
    ds_read_b64_tr_b16 v[48:49], v126 offset:5248
    ds_read_b64_tr_b16 v[50:51], v126 offset:5888
    v_and_b32 v2, 15, v1
    v_lshrrev_b32 v3, 4, v1
    v_and_b32 v4, 7, v2
    v_add_u32 v5, 0, v3
    v_xor_b32 v5, v5, v4
    v_lshlrev_b32 v5, 4, v5
    v_lshlrev_b32 v128, 7, v2
    v_add_u32 v128, v128, v5
    v_add_u32 v128, 71680, v128
    v_add_u32 v5, 4, v3
    v_xor_b32 v5, v5, v4
    v_lshlrev_b32 v5, 4, v5
    v_lshlrev_b32 v129, 7, v2
    v_add_u32 v129, v129, v5
    v_add_u32 v129, 71680, v129
    v_lshrrev_b32 v2, 3, v1
    v_and_b32 v3, 7, v1
    v_xor_b32 v3, v3, v2
    v_lshlrev_b32 v3, 4, v3
    v_lshlrev_b32 v131, 12, v2
    v_add_u32 v131, v131, v3
    v_add_u32 v130, 71680, v10
    s_waitcnt lgkmcnt(0)
    ds_write_b128 v128, v[12:15] offset:0
    ds_write_b128 v129, v[16:19] offset:0
    ds_write_b128 v128, v[20:23] offset:2048
    ds_write_b128 v129, v[24:27] offset:2048
    ds_write_b128 v128, v[28:31] offset:4096
    ds_write_b128 v129, v[32:35] offset:4096
    ds_write_b128 v128, v[36:39] offset:6144
    ds_write_b128 v129, v[40:43] offset:6144
    ds_write_b128 v128, v[44:47] offset:8192
    ds_write_b128 v129, v[48:51] offset:8192
    s_waitcnt lgkmcnt(0)
    ds_read_b128 v[12:15], v130 offset:0
    ds_read_b128 v[16:19], v130 offset:1024
    ds_read_b128 v[20:23], v130 offset:2048
    ds_read_b128 v[24:27], v130 offset:3072
    ds_read_b128 v[28:31], v130 offset:4096
    ds_read_b128 v[32:35], v130 offset:5120
    ds_read_b128 v[36:39], v130 offset:6144
    ds_read_b128 v[40:43], v130 offset:7168
    ds_read_b128 v[44:47], v130 offset:8192
    ds_read_b128 v[48:51], v130 offset:9216
    s_add_u32 s14, s12, 0
    s_waitcnt lgkmcnt(9)
    buffer_store_dwordx4 v[12:15], v131, s[40:43], s14 offen sc1
    s_add_u32 s14, s12, 32768
    s_waitcnt lgkmcnt(8)
    buffer_store_dwordx4 v[16:19], v131, s[40:43], s14 offen sc1
    s_add_u32 s14, s12, 65536
    s_waitcnt lgkmcnt(7)
    buffer_store_dwordx4 v[20:23], v131, s[40:43], s14 offen sc1
    s_add_u32 s14, s12, 98304
    s_waitcnt lgkmcnt(6)
    buffer_store_dwordx4 v[24:27], v131, s[40:43], s14 offen sc1
    s_add_u32 s14, s12, 131072
    s_waitcnt lgkmcnt(5)
    buffer_store_dwordx4 v[28:31], v131, s[40:43], s14 offen sc1
    s_add_u32 s14, s12, 163840
    s_waitcnt lgkmcnt(4)
    buffer_store_dwordx4 v[32:35], v131, s[40:43], s14 offen sc1
    s_add_u32 s14, s12, 196608
    s_waitcnt lgkmcnt(3)
    buffer_store_dwordx4 v[36:39], v131, s[40:43], s14 offen sc1
    s_add_u32 s14, s12, 229376
    s_waitcnt lgkmcnt(2)
    buffer_store_dwordx4 v[40:43], v131, s[40:43], s14 offen sc1
    s_add_u32 s14, s12, 262144
    s_waitcnt lgkmcnt(1)
    buffer_store_dwordx4 v[44:47], v131, s[40:43], s14 offen sc1
    s_add_u32 s14, s12, 294912
    s_waitcnt lgkmcnt(0)
    buffer_store_dwordx4 v[48:51], v131, s[40:43], s14 offen sc1
    s_waitcnt vmcnt(10)
    v_mov_b32 v2, 0
    v_mov_b32 v3, 0
    v_dot2_f32_bf16 v2, v52, v92, v2
    v_dot2_f32_bf16 v3, v72, v92, v3
    v_dot2_f32_bf16 v2, v53, v93, v2
    v_dot2_f32_bf16 v3, v73, v93, v3
    v_dot2_f32_bf16 v2, v54, v94, v2
    v_dot2_f32_bf16 v3, v74, v94, v3
    v_dot2_f32_bf16 v2, v55, v95, v2
    v_dot2_f32_bf16 v3, v75, v95, v3
    v_dot2_f32_bf16 v2, v56, v96, v2
    v_dot2_f32_bf16 v3, v76, v96, v3
    v_dot2_f32_bf16 v2, v57, v97, v2
    v_dot2_f32_bf16 v3, v77, v97, v3
    v_dot2_f32_bf16 v2, v58, v98, v2
    v_dot2_f32_bf16 v3, v78, v98, v3
    v_dot2_f32_bf16 v2, v59, v99, v2
    v_dot2_f32_bf16 v3, v79, v99, v3
    v_dot2_f32_bf16 v2, v60, v100, v2
    v_dot2_f32_bf16 v3, v80, v100, v3
    v_dot2_f32_bf16 v2, v61, v101, v2
    v_dot2_f32_bf16 v3, v81, v101, v3
    v_dot2_f32_bf16 v2, v62, v102, v2
    v_dot2_f32_bf16 v3, v82, v102, v3
    v_dot2_f32_bf16 v2, v63, v103, v2
    v_dot2_f32_bf16 v3, v83, v103, v3
    v_dot2_f32_bf16 v2, v64, v104, v2
    v_dot2_f32_bf16 v3, v84, v104, v3
    v_dot2_f32_bf16 v2, v65, v105, v2
    v_dot2_f32_bf16 v3, v85, v105, v3
    v_dot2_f32_bf16 v2, v66, v106, v2
    v_dot2_f32_bf16 v3, v86, v106, v3
    v_dot2_f32_bf16 v2, v67, v107, v2
    v_dot2_f32_bf16 v3, v87, v107, v3
    v_dot2_f32_bf16 v2, v68, v108, v2
    v_dot2_f32_bf16 v3, v88, v108, v3
    v_dot2_f32_bf16 v2, v69, v109, v2
    v_dot2_f32_bf16 v3, v89, v109, v3
    v_dot2_f32_bf16 v2, v70, v110, v2
    v_dot2_f32_bf16 v3, v90, v110, v3
    v_dot2_f32_bf16 v2, v71, v111, v2
    v_dot2_f32_bf16 v3, v91, v111, v3
    s_nop 1
    v_add_f32_dpp v2, v2, v2 row_shr:1 row_mask:0xf bank_mask:0xf
    v_add_f32_dpp v3, v3, v3 row_shr:1 row_mask:0xf bank_mask:0xf
    s_nop 1
    v_add_f32_dpp v2, v2, v2 row_shr:2 row_mask:0xf bank_mask:0xf
    v_add_f32_dpp v3, v3, v3 row_shr:2 row_mask:0xf bank_mask:0xf
    s_nop 1
    v_add_f32_dpp v2, v2, v2 row_shr:4 row_mask:0xf bank_mask:0xf
    v_add_f32_dpp v3, v3, v3 row_shr:4 row_mask:0xf bank_mask:0xf
    s_nop 1
    v_add_f32_dpp v2, v2, v2 row_shr:8 row_mask:0xf bank_mask:0xf
    v_add_f32_dpp v3, v3, v3 row_shr:8 row_mask:0xf bank_mask:0xf
    s_nop 1
    v_cvt_pk_bf16_f32 v2, v2, v2
    v_lshlrev_b32 v2, 16, v2
    v_mul_f32 v2, 0xbfb8aa3b, v2
    v_exp_f32 v2, v2
    s_nop 0
    v_add_f32 v2, 1.0, v2
    v_rcp_f32 v2, v2
    s_nop 0
    v_cvt_pk_bf16_f32 v2, v2, v2
    v_lshlrev_b32 v2, 16, v2
    v_cvt_pk_bf16_f32 v3, v3, v3
    v_lshlrev_b32 v3, 16, v3
    v_mul_f32 v3, 0xbfb8aa3b, v3
    v_exp_f32 v3, v3
    s_nop 0
    v_add_f32 v3, 1.0, v3
    v_rcp_f32 v3, v3
    s_nop 0
    v_cvt_pk_bf16_f32 v3, v3, v3
    v_lshlrev_b32 v3, 16, v3
    v_lshrrev_b32 v6, 4, v1
    v_lshlrev_b32 v6, 2, v6
    s_lshl_b32 s55, s68, 5
    s_mov_b32 s58, 0x80008000
    s_mov_b32 s59, 0x80008000
    s_mov_b64 exec, s[58:59]
    buffer_store_dword v2, v6, s[48:51], s55 offen sc1
    buffer_store_dword v3, v6, s[48:51], s55 offen offset:16 sc1
    s_mov_b64 exec, -1
    s_waitcnt vmcnt(0)
    s_lshl_b32 s55, s61, 7
    s_lshl_b32 s56, s60, 2
    s_add_u32 s55, s55, s56
    s_lshr_b32 s56, s68, 3
    s_lshl_b32 s56, s56, 7
    s_and_b32 s63, s68, 7
    s_lshl_b32 s63, s63, 2
    s_add_u32 s56, s56, s63
    s_add_u32 s56, s56, 1024
    v_mov_b32 v6, s55
    v_mov_b32 v8, s56
    v_cmp_eq_u32 vcc, 1, v1
    v_mov_b32 v7, s62
    v_cndmask_b32 v6, v6, v8, vcc
    v_cmp_gt_u32 vcc, 2, v1
    s_and_saveexec_b64 s[58:59], vcc
    buffer_store_dword v7, v6, s[44:47], 0 offen sc1
    s_mov_b64 exec, s[58:59]
    s_endpgm
akg_2:
    s_lshl_b32 s55, s53, 8
    v_lshlrev_b32 v17, 2, v1
    v_add_u32 v17, s55, v17
    s_waitcnt lgkmcnt(0)
    s_mov_b32 s36, s12
    s_and_b32 s37, s13, 0xffff
    s_mov_b32 s38, 163840
    s_mov_b32 s39, 0x00020000
    buffer_load_dword v12, v17, s[36:39], 0 offen
    s_mov_b32 s36, s14
    s_and_b32 s37, s15, 0xffff
    s_mov_b32 s38, 163840
    s_mov_b32 s39, 0x00020000
    buffer_load_dword v13, v17, s[36:39], 0 offen
    s_mov_b32 s36, s16
    s_and_b32 s37, s17, 0xffff
    s_mov_b32 s38, 163840
    s_mov_b32 s39, 0x00020000
    buffer_load_dword v14, v17, s[36:39], 0 offen
    s_mov_b32 s36, s18
    s_and_b32 s37, s19, 0xffff
    s_mov_b32 s38, 163840
    s_mov_b32 s39, 0x00020000
    buffer_load_dword v15, v17, s[36:39], 0 offen
    s_lshl_b32 s55, s53, 1
    s_and_b32 s55, s55, 0xfffffffc
    s_add_u32 s20, s20, s55
    s_addc_u32 s21, s21, 0
    s_add_u32 s22, s22, s55
    s_addc_u32 s23, s23, 0
    s_load_dword s66, s[20:21], 0
    s_load_dword s67, s[22:23], 0
    s_add_u32 s64, s26, 13320192
    s_addc_u32 s65, s27, 0
    s_load_dword s62, s[64:65], 0
    s_add_u32 s40, s26, 5414912
    s_addc_u32 s41, s27, 0
    s_and_b32 s41, s41, 0xffff
    s_mov_b32 s42, 2621440
    s_mov_b32 s43, 0x00020000
    s_add_u32 s44, s26, 13320448
    s_addc_u32 s45, s27, 0
    s_and_b32 s45, s45, 0xffff
    s_mov_b32 s46, 12288
    s_mov_b32 s47, 0x00020000
    s_waitcnt lgkmcnt(0)
    s_add_u32 s62, s62, 1
    s_and_b32 s55, s53, 1
    s_lshl_b32 s56, s66, 16
    s_and_b32 s66, s66, 0xffff0000
    s_cmp_eq_u32 s55, 0
    s_cselect_b32 s66, s56, s66
    s_lshl_b32 s56, s67, 16
    s_and_b32 s67, s67, 0xffff0000
    s_cmp_eq_u32 s55, 0
    s_cselect_b32 s67, s56, s67
    v_mov_b32 v16, s67
    s_waitcnt vmcnt(0)
    s_barrier
    v_mov_b32 v36, s66
    v_mul_f32 v36, 0x3fb8aa3b, v36
    v_exp_f32 v36, v36
    s_nop 0
    v_cvt_pk_bf16_f32 v36, v36, v36
    v_lshlrev_b32 v36, 16, v36
    v_mov_b32 v62, 1.0
    v_mov_b32 v63, 0
    v_lshrrev_b32 v2, 1, v1
    v_and_b32 v2, 3, v2
    v_lshlrev_b32 v3, 6, v1
    v_add_u32 v3, s57, v3
    v_xor_b32 v4, 0, v2
    v_lshlrev_b32 v4, 4, v4
    v_add_u32 v104, v3, v4
    v_xor_b32 v4, 1, v2
    v_lshlrev_b32 v4, 4, v4
    v_add_u32 v105, v3, v4
    v_xor_b32 v4, 2, v2
    v_lshlrev_b32 v4, 4, v4
    v_add_u32 v106, v3, v4
    v_xor_b32 v4, 3, v2
    v_lshlrev_b32 v4, 4, v4
    v_add_u32 v107, v3, v4
    v_lshrrev_b32 v2, 5, v1
    v_bfe_u32 v3, v1, 4, 1
    v_bfe_u32 v4, v1, 2, 2
    v_and_b32 v5, 3, v1
    v_lshlrev_b32 v6, 2, v2
    v_add_u32 v6, v6, v4
    v_lshrrev_b32 v7, 1, v6
    v_and_b32 v7, 3, v7
    v_lshlrev_b32 v3, 1, v3
    v_lshrrev_b32 v8, 1, v5
    v_add_u32 v3, v3, v8
    v_xor_b32 v3, v3, v7
    v_lshlrev_b32 v3, 4, v3
    v_and_b32 v5, 1, v5
    v_lshlrev_b32 v5, 3, v5
    v_lshlrev_b32 v6, 6, v6
    v_add3_u32 v108, v6, v3, v5
    v_add_u32 v108, s57, v108
    v_lshlrev_b32 v42, 16, v12
    v_lshlrev_b32 v43, 16, v13
    v_lshlrev_b32 v44, 16, v14
    v_lshlrev_b32 v45, 16, v15
    v_mul_f32 v37, 0x3fb8aa3b, v42
    v_exp_f32 v37, v37
    v_mul_f32 v38, v43, v36
    v_cvt_pk_bf16_f32 v37, v37, v37
    v_lshlrev_b32 v37, 16, v37
    v_mul_f32 v37, -v37, v36
    v_mul_f32 v38, 0x3e22f983, v38
    v_mul_f32 v37, 0x3fb8aa3b, v37
    v_mul_f32 v2, 0x3f800000, v37
    v_mul_f32 v3, 0x3f800000, v38
    v_exp_f32 v2, v2
    v_fract_f32 v3, v3
    v_cos_f32 v4, v3
    v_sin_f32 v5, v3
    s_nop 0
    v_mul_f32 v46, v2, v4
    v_mul_f32 v47, v2, v5
    v_mul_f32 v2, 0x41000000, v37
    v_mul_f32 v3, 0x41000000, v38
    v_exp_f32 v2, v2
    v_fract_f32 v3, v3
    v_cos_f32 v4, v3
    v_sin_f32 v5, v3
    s_nop 0
    v_mul_f32 v48, v2, v4
    v_mul_f32 v49, v2, v5
    v_mul_f32 v2, 0x43800000, v37
    v_mul_f32 v3, 0x43800000, v38
    v_exp_f32 v2, v2
    v_fract_f32 v3, v3
    v_cos_f32 v4, v3
    v_sin_f32 v5, v3
    s_nop 0
    v_mul_f32 v50, v2, v4
    v_mul_f32 v51, v2, v5
    v_add_f32 v6, v36, v36
    v_mul_f32 v54, v44, v6
    v_mul_f32 v55, -v45, v6
    v_pk_mul_f32 v[56:57], v[48:49], v[54:55] op_sel:[0,0] op_sel_hi:[0,1]
    v_pk_fma_f32 v[56:57], v[48:49], v[54:55], v[56:57] op_sel:[1,1,0] op_sel_hi:[1,0,1] neg_hi:[1,0,0]
    v_pk_mul_f32 v[52:53], v[48:49], v[48:49] op_sel:[0,0] op_sel_hi:[0,1]
    v_pk_fma_f32 v[52:53], v[48:49], v[48:49], v[52:53] op_sel:[1,1,0] op_sel_hi:[1,0,1] neg_lo:[1,0,0]
    v_cvt_pk_bf16_f32 v144, v54, v56
    v_cvt_pk_bf16_f32 v148, v55, v57
    v_pk_mul_f32 v[58:59], v[52:53], v[54:55] op_sel:[0,0] op_sel_hi:[0,1]
    v_pk_fma_f32 v[58:59], v[52:53], v[54:55], v[58:59] op_sel:[1,1,0] op_sel_hi:[1,0,1] neg_hi:[1,0,0]
    v_pk_mul_f32 v[60:61], v[52:53], v[56:57] op_sel:[0,0] op_sel_hi:[0,1]
    v_pk_fma_f32 v[60:61], v[52:53], v[56:57], v[60:61] op_sel:[1,1,0] op_sel_hi:[1,0,1] neg_hi:[1,0,0]
    v_pk_mul_f32 v[64:65], v[46:47], v[46:47] op_sel:[0,0] op_sel_hi:[0,1]
    v_pk_fma_f32 v[64:65], v[46:47], v[46:47], v[64:65] op_sel:[1,1,0] op_sel_hi:[1,0,1] neg_lo:[1,0,0]
    v_cvt_pk_bf16_f32 v208, v62, v46
    v_cvt_pk_bf16_f32 v212, v63, v47
    v_pk_mul_f32 v[66:67], v[46:47], v[64:65] op_sel:[0,0] op_sel_hi:[0,1]
    v_pk_fma_f32 v[66:67], v[46:47], v[64:65], v[66:67] op_sel:[1,1,0] op_sel_hi:[1,0,1] neg_lo:[1,0,0]
    v_cvt_pk_bf16_f32 v145, v58, v60
    v_cvt_pk_bf16_f32 v149, v59, v61
    v_pk_mul_f32 v[54:55], v[52:53], v[58:59] op_sel:[0,0] op_sel_hi:[0,1]
    v_pk_fma_f32 v[54:55], v[52:53], v[58:59], v[54:55] op_sel:[1,1,0] op_sel_hi:[1,0,1] neg_hi:[1,0,0]
    v_pk_mul_f32 v[56:57], v[52:53], v[60:61] op_sel:[0,0] op_sel_hi:[0,1]
    v_pk_fma_f32 v[56:57], v[52:53], v[60:61], v[56:57] op_sel:[1,1,0] op_sel_hi:[1,0,1] neg_hi:[1,0,0]
    v_pk_mul_f32 v[68:69], v[64:65], v[64:65] op_sel:[0,0] op_sel_hi:[0,1]
    v_pk_fma_f32 v[68:69], v[64:65], v[64:65], v[68:69] op_sel:[1,1,0] op_sel_hi:[1,0,1] neg_lo:[1,0,0]
    v_cvt_pk_bf16_f32 v209, v64, v66
    v_cvt_pk_bf16_f32 v213, v65, v67
    v_pk_mul_f32 v[70:71], v[46:47], v[68:69] op_sel:[0,0] op_sel_hi:[0,1]
    v_pk_fma_f32 v[70:71], v[46:47], v[68:69], v[70:71] op_sel:[1,1,0] op_sel_hi:[1,0,1] neg_lo:[1,0,0]
    v_cvt_pk_bf16_f32 v146, v54, v56
    v_cvt_pk_bf16_f32 v150, v55, v57
    v_pk_mul_f32 v[58:59], v[52:53], v[54:55] op_sel:[0,0] op_sel_hi:[0,1]
    v_pk_fma_f32 v[58:59], v[52:53], v[54:55], v[58:59] op_sel:[1,1,0] op_sel_hi:[1,0,1] neg_hi:[1,0,0]
    v_pk_mul_f32 v[60:61], v[52:53], v[56:57] op_sel:[0,0] op_sel_hi:[0,1]
    v_pk_fma_f32 v[60:61], v[52:53], v[56:57], v[60:61] op_sel:[1,1,0] op_sel_hi:[1,0,1] neg_hi:[1,0,0]
    v_pk_mul_f32 v[72:73], v[64:65], v[68:69] op_sel:[0,0] op_sel_hi:[0,1]
    v_pk_fma_f32 v[72:73], v[64:65], v[68:69], v[72:73] op_sel:[1,1,0] op_sel_hi:[1,0,1] neg_lo:[1,0,0]
    v_cvt_pk_bf16_f32 v210, v68, v70
    v_cvt_pk_bf16_f32 v214, v69, v71
    v_pk_mul_f32 v[74:75], v[66:67], v[68:69] op_sel:[0,0] op_sel_hi:[0,1]
    v_pk_fma_f32 v[74:75], v[66:67], v[68:69], v[74:75] op_sel:[1,1,0] op_sel_hi:[1,0,1] neg_lo:[1,0,0]
    v_cvt_pk_bf16_f32 v147, v58, v60
    v_cvt_pk_bf16_f32 v151, v59, v61
    v_pk_mul_f32 v[54:55], v[52:53], v[58:59] op_sel:[0,0] op_sel_hi:[0,1]
    v_pk_fma_f32 v[54:55], v[52:53], v[58:59], v[54:55] op_sel:[1,1,0] op_sel_hi:[1,0,1] neg_hi:[1,0,0]
    v_pk_mul_f32 v[56:57], v[52:53], v[60:61] op_sel:[0,0] op_sel_hi:[0,1]
    v_pk_fma_f32 v[56:57], v[52:53], v[60:61], v[56:57] op_sel:[1,1,0] op_sel_hi:[1,0,1] neg_hi:[1,0,0]
    v_cvt_pk_bf16_f32 v211, v72, v74
    v_cvt_pk_bf16_f32 v215, v73, v75
    v_pk_mul_f32 v[80:81], v[50:51], v[50:51] op_sel:[0,0] op_sel_hi:[0,1]
    v_pk_fma_f32 v[80:81], v[50:51], v[50:51], v[80:81] op_sel:[1,1,0] op_sel_hi:[1,0,1] neg_lo:[1,0,0]
    v_cvt_pk_bf16_f32 v152, v54, v56
    v_cvt_pk_bf16_f32 v156, v55, v57
    v_pk_mul_f32 v[58:59], v[52:53], v[54:55] op_sel:[0,0] op_sel_hi:[0,1]
    v_pk_fma_f32 v[58:59], v[52:53], v[54:55], v[58:59] op_sel:[1,1,0] op_sel_hi:[1,0,1] neg_hi:[1,0,0]
    v_pk_mul_f32 v[60:61], v[52:53], v[56:57] op_sel:[0,0] op_sel_hi:[0,1]
    v_pk_fma_f32 v[60:61], v[52:53], v[56:57], v[60:61] op_sel:[1,1,0] op_sel_hi:[1,0,1] neg_hi:[1,0,0]
    v_pk_mul_f32 v[76:77], v[68:69], v[80:81] op_sel:[0,0] op_sel_hi:[0,1]
    v_pk_fma_f32 v[76:77], v[68:69], v[80:81], v[76:77] op_sel:[1,1,0] op_sel_hi:[1,0,1] neg_lo:[1,0,0]
    v_cvt_pk_bf16_f32 v216, v80, v76
    v_cvt_pk_bf16_f32 v220, v81, v77
    v_pk_mul_f32 v[82:83], v[80:81], v[80:81] op_sel:[0,0] op_sel_hi:[0,1]
    v_pk_fma_f32 v[82:83], v[80:81], v[80:81], v[82:83] op_sel:[1,1,0] op_sel_hi:[1,0,1] neg_lo:[1,0,0]
    v_cvt_pk_bf16_f32 v153, v58, v60
    v_cvt_pk_bf16_f32 v157, v59, v61
    v_pk_mul_f32 v[54:55], v[52:53], v[58:59] op_sel:[0,0] op_sel_hi:[0,1]
    v_pk_fma_f32 v[54:55], v[52:53], v[58:59], v[54:55] op_sel:[1,1,0] op_sel_hi:[1,0,1] neg_hi:[1,0,0]
    v_pk_mul_f32 v[56:57], v[52:53], v[60:61] op_sel:[0,0] op_sel_hi:[0,1]
    v_pk_fma_f32 v[56:57], v[52:53], v[60:61], v[56:57] op_sel:[1,1,0] op_sel_hi:[1,0,1] neg_hi:[1,0,0]
    v_pk_mul_f32 v[78:79], v[50:51], v[82:83] op_sel:[0,0] op_sel_hi:[0,1]
    v_pk_fma_f32 v[78:79], v[50:51], v[82:83], v[78:79] op_sel:[1,1,0] op_sel_hi:[1,0,1] neg_lo:[1,0,0]
    v_cvt_pk_bf16_f32 v217, v82, v78
    v_cvt_pk_bf16_f32 v221, v83, v79
    v_pk_mul_f32 v[84:85], v[50:51], v[80:81] op_sel:[0,0] op_sel_hi:[0,1]
    v_pk_fma_f32 v[84:85], v[50:51], v[80:81], v[84:85] op_sel:[1,1,0] op_sel_hi:[1,0,1] neg_lo:[1,0,0]
    v_cvt_pk_bf16_f32 v154, v54, v56
    v_cvt_pk_bf16_f32 v158, v55, v57
    v_pk_mul_f32 v[58:59], v[52:53], v[54:55] op_sel:[0,0] op_sel_hi:[0,1]
    v_pk_fma_f32 v[58:59], v[52:53], v[54:55], v[58:59] op_sel:[1,1,0] op_sel_hi:[1,0,1] neg_hi:[1,0,0]
    v_pk_mul_f32 v[60:61], v[52:53], v[56:57] op_sel:[0,0] op_sel_hi:[0,1]
    v_pk_fma_f32 v[60:61], v[52:53], v[56:57], v[60:61] op_sel:[1,1,0] op_sel_hi:[1,0,1] neg_hi:[1,0,0]
    v_pk_mul_f32 v[76:77], v[68:69], v[84:85] op_sel:[0,0] op_sel_hi:[0,1]
    v_pk_fma_f32 v[76:77], v[68:69], v[84:85], v[76:77] op_sel:[1,1,0] op_sel_hi:[1,0,1] neg_lo:[1,0,0]
    v_cvt_pk_bf16_f32 v218, v84, v76
    v_cvt_pk_bf16_f32 v222, v85, v77
    v_pk_mul_f32 v[86:87], v[80:81], v[82:83] op_sel:[0,0] op_sel_hi:[0,1]
    v_pk_fma_f32 v[86:87], v[80:81], v[82:83], v[86:87] op_sel:[1,1,0] op_sel_hi:[1,0,1] neg_lo:[1,0,0]
    v_cvt_pk_bf16_f32 v155, v58, v60
    v_cvt_pk_bf16_f32 v159, v59, v61
    v_pk_mul_f32 v[54:55], v[52:53], v[58:59] op_sel:[0,0] op_sel_hi:[0,1]
    v_pk_fma_f32 v[54:55], v[52:53], v[58:59], v[54:55] op_sel:[1,1,0] op_sel_hi:[1,0,1] neg_hi:[1,0,0]
    v_pk_mul_f32 v[56:57], v[52:53], v[60:61] op_sel:[0,0] op_sel_hi:[0,1]
    v_pk_fma_f32 v[56:57], v[52:53], v[60:61], v[56:57] op_sel:[1,1,0] op_sel_hi:[1,0,1] neg_hi:[1,0,0]
    v_pk_mul_f32 v[78:79], v[50:51], v[86:87] op_sel:[0,0] op_sel_hi:[0,1]
    v_pk_fma_f32 v[78:79], v[50:51], v[86:87], v[78:79] op_sel:[1,1,0] op_sel_hi:[1,0,1] neg_lo:[1,0,0]
    v_cvt_pk_bf16_f32 v219, v86, v78
    v_cvt_pk_bf16_f32 v223, v87, v79
    v_cvt_pk_bf16_f32 v160, v54, v56
    v_cvt_pk_bf16_f32 v164, v55, v57
    v_pk_mul_f32 v[58:59], v[52:53], v[54:55] op_sel:[0,0] op_sel_hi:[0,1]
    v_pk_fma_f32 v[58:59], v[52:53], v[54:55], v[58:59] op_sel:[1,1,0] op_sel_hi:[1,0,1] neg_hi:[1,0,0]
    v_pk_mul_f32 v[60:61], v[52:53], v[56:57] op_sel:[0,0] op_sel_hi:[0,1]
    v_pk_fma_f32 v[60:61], v[52:53], v[56:57], v[60:61] op_sel:[1,1,0] op_sel_hi:[1,0,1] neg_hi:[1,0,0]
    v_pk_mul_f32 v[76:77], v[64:65], v[50:51] op_sel:[0,0] op_sel_hi:[0,1]
    v_pk_fma_f32 v[76:77], v[64:65], v[50:51], v[76:77] op_sel:[1,1,0] op_sel_hi:[1,0,1] neg_lo:[1,0,0]
    v_cvt_pk_bf16_f32 v224, v50, v76
    v_cvt_pk_bf16_f32 v228, v51, v77
    v_pk_mul_f32 v[76:77], v[68:69], v[50:51] op_sel:[0,0] op_sel_hi:[0,1]
    v_pk_fma_f32 v[76:77], v[68:69], v[50:51], v[76:77] op_sel:[1,1,0] op_sel_hi:[1,0,1] neg_lo:[1,0,0]
    v_cvt_pk_bf16_f32 v161, v58, v60
    v_cvt_pk_bf16_f32 v165, v59, v61
    v_pk_mul_f32 v[54:55], v[52:53], v[58:59] op_sel:[0,0] op_sel_hi:[0,1]
    v_pk_fma_f32 v[54:55], v[52:53], v[58:59], v[54:55] op_sel:[1,1,0] op_sel_hi:[1,0,1] neg_hi:[1,0,0]
    v_pk_mul_f32 v[56:57], v[52:53], v[60:61] op_sel:[0,0] op_sel_hi:[0,1]
    v_pk_fma_f32 v[56:57], v[52:53], v[60:61], v[56:57] op_sel:[1,1,0] op_sel_hi:[1,0,1] neg_hi:[1,0,0]
    v_pk_mul_f32 v[78:79], v[72:73], v[50:51] op_sel:[0,0] op_sel_hi:[0,1]
    v_pk_fma_f32 v[78:79], v[72:73], v[50:51], v[78:79] op_sel:[1,1,0] op_sel_hi:[1,0,1] neg_lo:[1,0,0]
    v_cvt_pk_bf16_f32 v225, v76, v78
    v_cvt_pk_bf16_f32 v229, v77, v79
    v_pk_mul_f32 v[76:77], v[82:83], v[82:83] op_sel:[0,0] op_sel_hi:[0,1]
    v_pk_fma_f32 v[76:77], v[82:83], v[82:83], v[76:77] op_sel:[1,1,0] op_sel_hi:[1,0,1] neg_lo:[1,0,0]
    v_cvt_pk_bf16_f32 v162, v54, v56
    v_cvt_pk_bf16_f32 v166, v55, v57
    v_pk_mul_f32 v[58:59], v[52:53], v[54:55] op_sel:[0,0] op_sel_hi:[0,1]
    v_pk_fma_f32 v[58:59], v[52:53], v[54:55], v[58:59] op_sel:[1,1,0] op_sel_hi:[1,0,1] neg_hi:[1,0,0]
    v_pk_mul_f32 v[60:61], v[52:53], v[56:57] op_sel:[0,0] op_sel_hi:[0,1]
    v_pk_fma_f32 v[60:61], v[52:53], v[56:57], v[60:61] op_sel:[1,1,0] op_sel_hi:[1,0,1] neg_hi:[1,0,0]
    v_cvt_pk_bf16_f32 v226, v76, v76
    v_cvt_pk_bf16_f32 v230, v77, v77
    v_cvt_pk_bf16_f32 v227, v76, v76
    v_cvt_pk_bf16_f32 v231, v77, v77
    v_cvt_pk_bf16_f32 v163, v58, v60
    v_cvt_pk_bf16_f32 v167, v59, v61
    v_pk_mul_f32 v[54:55], v[52:53], v[58:59] op_sel:[0,0] op_sel_hi:[0,1]
    v_pk_fma_f32 v[54:55], v[52:53], v[58:59], v[54:55] op_sel:[1,1,0] op_sel_hi:[1,0,1] neg_hi:[1,0,0]
    v_pk_mul_f32 v[56:57], v[52:53], v[60:61] op_sel:[0,0] op_sel_hi:[0,1]
    v_pk_fma_f32 v[56:57], v[52:53], v[60:61], v[56:57] op_sel:[1,1,0] op_sel_hi:[1,0,1] neg_hi:[1,0,0]
    v_cvt_pk_bf16_f32 v168, v54, v56
    v_cvt_pk_bf16_f32 v172, v55, v57
    v_pk_mul_f32 v[58:59], v[52:53], v[54:55] op_sel:[0,0] op_sel_hi:[0,1]
    v_pk_fma_f32 v[58:59], v[52:53], v[54:55], v[58:59] op_sel:[1,1,0] op_sel_hi:[1,0,1] neg_hi:[1,0,0]
    v_pk_mul_f32 v[60:61], v[52:53], v[56:57] op_sel:[0,0] op_sel_hi:[0,1]
    v_pk_fma_f32 v[60:61], v[52:53], v[56:57], v[60:61] op_sel:[1,1,0] op_sel_hi:[1,0,1] neg_hi:[1,0,0]
    v_cvt_pk_bf16_f32 v169, v58, v60
    v_cvt_pk_bf16_f32 v173, v59, v61
    v_pk_mul_f32 v[54:55], v[52:53], v[58:59] op_sel:[0,0] op_sel_hi:[0,1]
    v_pk_fma_f32 v[54:55], v[52:53], v[58:59], v[54:55] op_sel:[1,1,0] op_sel_hi:[1,0,1] neg_hi:[1,0,0]
    v_pk_mul_f32 v[56:57], v[52:53], v[60:61] op_sel:[0,0] op_sel_hi:[0,1]
    v_pk_fma_f32 v[56:57], v[52:53], v[60:61], v[56:57] op_sel:[1,1,0] op_sel_hi:[1,0,1] neg_hi:[1,0,0]
    v_cvt_pk_bf16_f32 v170, v54, v56
    v_cvt_pk_bf16_f32 v174, v55, v57
    v_pk_mul_f32 v[58:59], v[52:53], v[54:55] op_sel:[0,0] op_sel_hi:[0,1]
    v_pk_fma_f32 v[58:59], v[52:53], v[54:55], v[58:59] op_sel:[1,1,0] op_sel_hi:[1,0,1] neg_hi:[1,0,0]
    v_pk_mul_f32 v[60:61], v[52:53], v[56:57] op_sel:[0,0] op_sel_hi:[0,1]
    v_pk_fma_f32 v[60:61], v[52:53], v[56:57], v[60:61] op_sel:[1,1,0] op_sel_hi:[1,0,1] neg_hi:[1,0,0]
    v_cvt_pk_bf16_f32 v171, v58, v60
    v_cvt_pk_bf16_f32 v175, v59, v61
    v_and_b32 v42, 0xffff0000, v12
    v_and_b32 v43, 0xffff0000, v13
    v_and_b32 v44, 0xffff0000, v14
    v_and_b32 v45, 0xffff0000, v15
    v_mul_f32 v37, 0x3fb8aa3b, v42
    v_exp_f32 v37, v37
    v_mul_f32 v38, v43, v36
    v_cvt_pk_bf16_f32 v37, v37, v37
    v_lshlrev_b32 v37, 16, v37
    v_mul_f32 v37, -v37, v36
    v_mul_f32 v38, 0x3e22f983, v38
    v_mul_f32 v37, 0x3fb8aa3b, v37
    v_mul_f32 v2, 0x3f800000, v37
    v_mul_f32 v3, 0x3f800000, v38
    v_exp_f32 v2, v2
    v_fract_f32 v3, v3
    v_cos_f32 v4, v3
    v_sin_f32 v5, v3
    s_nop 0
    v_mul_f32 v46, v2, v4
    v_mul_f32 v47, v2, v5
    v_mul_f32 v2, 0x41000000, v37
    v_mul_f32 v3, 0x41000000, v38
    v_exp_f32 v2, v2
    v_fract_f32 v3, v3
    v_cos_f32 v4, v3
    v_sin_f32 v5, v3
    s_nop 0
    v_mul_f32 v48, v2, v4
    v_mul_f32 v49, v2, v5
    v_mul_f32 v2, 0x43800000, v37
    v_mul_f32 v3, 0x43800000, v38
    v_exp_f32 v2, v2
    v_fract_f32 v3, v3
    v_cos_f32 v4, v3
    v_sin_f32 v5, v3
    s_nop 0
    v_mul_f32 v50, v2, v4
    v_mul_f32 v51, v2, v5
    v_add_f32 v6, v36, v36
    v_mul_f32 v54, v44, v6
    v_mul_f32 v55, -v45, v6
    v_pk_mul_f32 v[56:57], v[48:49], v[54:55] op_sel:[0,0] op_sel_hi:[0,1]
    v_pk_fma_f32 v[56:57], v[48:49], v[54:55], v[56:57] op_sel:[1,1,0] op_sel_hi:[1,0,1] neg_hi:[1,0,0]
    v_pk_mul_f32 v[52:53], v[48:49], v[48:49] op_sel:[0,0] op_sel_hi:[0,1]
    v_pk_fma_f32 v[52:53], v[48:49], v[48:49], v[52:53] op_sel:[1,1,0] op_sel_hi:[1,0,1] neg_lo:[1,0,0]
    v_cvt_pk_bf16_f32 v176, v54, v56
    v_cvt_pk_bf16_f32 v180, v55, v57
    v_pk_mul_f32 v[58:59], v[52:53], v[54:55] op_sel:[0,0] op_sel_hi:[0,1]
    v_pk_fma_f32 v[58:59], v[52:53], v[54:55], v[58:59] op_sel:[1,1,0] op_sel_hi:[1,0,1] neg_hi:[1,0,0]
    v_pk_mul_f32 v[60:61], v[52:53], v[56:57] op_sel:[0,0] op_sel_hi:[0,1]
    v_pk_fma_f32 v[60:61], v[52:53], v[56:57], v[60:61] op_sel:[1,1,0] op_sel_hi:[1,0,1] neg_hi:[1,0,0]
    v_pk_mul_f32 v[64:65], v[46:47], v[46:47] op_sel:[0,0] op_sel_hi:[0,1]
    v_pk_fma_f32 v[64:65], v[46:47], v[46:47], v[64:65] op_sel:[1,1,0] op_sel_hi:[1,0,1] neg_lo:[1,0,0]
    v_cvt_pk_bf16_f32 v232, v62, v46
    v_cvt_pk_bf16_f32 v236, v63, v47
    v_pk_mul_f32 v[66:67], v[46:47], v[64:65] op_sel:[0,0] op_sel_hi:[0,1]
    v_pk_fma_f32 v[66:67], v[46:47], v[64:65], v[66:67] op_sel:[1,1,0] op_sel_hi:[1,0,1] neg_lo:[1,0,0]
    v_cvt_pk_bf16_f32 v177, v58, v60
    v_cvt_pk_bf16_f32 v181, v59, v61
    v_pk_mul_f32 v[54:55], v[52:53], v[58:59] op_sel:[0,0] op_sel_hi:[0,1]
    v_pk_fma_f32 v[54:55], v[52:53], v[58:59], v[54:55] op_sel:[1,1,0] op_sel_hi:[1,0,1] neg_hi:[1,0,0]
    v_pk_mul_f32 v[56:57], v[52:53], v[60:61] op_sel:[0,0] op_sel_hi:[0,1]
    v_pk_fma_f32 v[56:57], v[52:53], v[60:61], v[56:57] op_sel:[1,1,0] op_sel_hi:[1,0,1] neg_hi:[1,0,0]
    v_pk_mul_f32 v[68:69], v[64:65], v[64:65] op_sel:[0,0] op_sel_hi:[0,1]
    v_pk_fma_f32 v[68:69], v[64:65], v[64:65], v[68:69] op_sel:[1,1,0] op_sel_hi:[1,0,1] neg_lo:[1,0,0]
    v_cvt_pk_bf16_f32 v233, v64, v66
    v_cvt_pk_bf16_f32 v237, v65, v67
    v_pk_mul_f32 v[70:71], v[46:47], v[68:69] op_sel:[0,0] op_sel_hi:[0,1]
    v_pk_fma_f32 v[70:71], v[46:47], v[68:69], v[70:71] op_sel:[1,1,0] op_sel_hi:[1,0,1] neg_lo:[1,0,0]
    v_cvt_pk_bf16_f32 v178, v54, v56
    v_cvt_pk_bf16_f32 v182, v55, v57
    v_pk_mul_f32 v[58:59], v[52:53], v[54:55] op_sel:[0,0] op_sel_hi:[0,1]
    v_pk_fma_f32 v[58:59], v[52:53], v[54:55], v[58:59] op_sel:[1,1,0] op_sel_hi:[1,0,1] neg_hi:[1,0,0]
    v_pk_mul_f32 v[60:61], v[52:53], v[56:57] op_sel:[0,0] op_sel_hi:[0,1]
    v_pk_fma_f32 v[60:61], v[52:53], v[56:57], v[60:61] op_sel:[1,1,0] op_sel_hi:[1,0,1] neg_hi:[1,0,0]
    v_pk_mul_f32 v[72:73], v[64:65], v[68:69] op_sel:[0,0] op_sel_hi:[0,1]
    v_pk_fma_f32 v[72:73], v[64:65], v[68:69], v[72:73] op_sel:[1,1,0] op_sel_hi:[1,0,1] neg_lo:[1,0,0]
    v_cvt_pk_bf16_f32 v234, v68, v70
    v_cvt_pk_bf16_f32 v238, v69, v71
    v_pk_mul_f32 v[74:75], v[66:67], v[68:69] op_sel:[0,0] op_sel_hi:[0,1]
    v_pk_fma_f32 v[74:75], v[66:67], v[68:69], v[74:75] op_sel:[1,1,0] op_sel_hi:[1,0,1] neg_lo:[1,0,0]
    v_cvt_pk_bf16_f32 v179, v58, v60
    v_cvt_pk_bf16_f32 v183, v59, v61
    v_pk_mul_f32 v[54:55], v[52:53], v[58:59] op_sel:[0,0] op_sel_hi:[0,1]
    v_pk_fma_f32 v[54:55], v[52:53], v[58:59], v[54:55] op_sel:[1,1,0] op_sel_hi:[1,0,1] neg_hi:[1,0,0]
    v_pk_mul_f32 v[56:57], v[52:53], v[60:61] op_sel:[0,0] op_sel_hi:[0,1]
    v_pk_fma_f32 v[56:57], v[52:53], v[60:61], v[56:57] op_sel:[1,1,0] op_sel_hi:[1,0,1] neg_hi:[1,0,0]
    v_cvt_pk_bf16_f32 v235, v72, v74
    v_cvt_pk_bf16_f32 v239, v73, v75
    v_pk_mul_f32 v[80:81], v[50:51], v[50:51] op_sel:[0,0] op_sel_hi:[0,1]
    v_pk_fma_f32 v[80:81], v[50:51], v[50:51], v[80:81] op_sel:[1,1,0] op_sel_hi:[1,0,1] neg_lo:[1,0,0]
    v_cvt_pk_bf16_f32 v184, v54, v56
    v_cvt_pk_bf16_f32 v188, v55, v57
    v_pk_mul_f32 v[58:59], v[52:53], v[54:55] op_sel:[0,0] op_sel_hi:[0,1]
    v_pk_fma_f32 v[58:59], v[52:53], v[54:55], v[58:59] op_sel:[1,1,0] op_sel_hi:[1,0,1] neg_hi:[1,0,0]
    v_pk_mul_f32 v[60:61], v[52:53], v[56:57] op_sel:[0,0] op_sel_hi:[0,1]
    v_pk_fma_f32 v[60:61], v[52:53], v[56:57], v[60:61] op_sel:[1,1,0] op_sel_hi:[1,0,1] neg_hi:[1,0,0]
    v_pk_mul_f32 v[76:77], v[68:69], v[80:81] op_sel:[0,0] op_sel_hi:[0,1]
    v_pk_fma_f32 v[76:77], v[68:69], v[80:81], v[76:77] op_sel:[1,1,0] op_sel_hi:[1,0,1] neg_lo:[1,0,0]
    v_cvt_pk_bf16_f32 v240, v80, v76
    v_cvt_pk_bf16_f32 v244, v81, v77
    v_pk_mul_f32 v[82:83], v[80:81], v[80:81] op_sel:[0,0] op_sel_hi:[0,1]
    v_pk_fma_f32 v[82:83], v[80:81], v[80:81], v[82:83] op_sel:[1,1,0] op_sel_hi:[1,0,1] neg_lo:[1,0,0]
    v_cvt_pk_bf16_f32 v185, v58, v60
    v_cvt_pk_bf16_f32 v189, v59, v61
    v_pk_mul_f32 v[54:55], v[52:53], v[58:59] op_sel:[0,0] op_sel_hi:[0,1]
    v_pk_fma_f32 v[54:55], v[52:53], v[58:59], v[54:55] op_sel:[1,1,0] op_sel_hi:[1,0,1] neg_hi:[1,0,0]
    v_pk_mul_f32 v[56:57], v[52:53], v[60:61] op_sel:[0,0] op_sel_hi:[0,1]
    v_pk_fma_f32 v[56:57], v[52:53], v[60:61], v[56:57] op_sel:[1,1,0] op_sel_hi:[1,0,1] neg_hi:[1,0,0]
    v_pk_mul_f32 v[78:79], v[50:51], v[82:83] op_sel:[0,0] op_sel_hi:[0,1]
    v_pk_fma_f32 v[78:79], v[50:51], v[82:83], v[78:79] op_sel:[1,1,0] op_sel_hi:[1,0,1] neg_lo:[1,0,0]
    v_cvt_pk_bf16_f32 v241, v82, v78
    v_cvt_pk_bf16_f32 v245, v83, v79
    v_pk_mul_f32 v[84:85], v[50:51], v[80:81] op_sel:[0,0] op_sel_hi:[0,1]
    v_pk_fma_f32 v[84:85], v[50:51], v[80:81], v[84:85] op_sel:[1,1,0] op_sel_hi:[1,0,1] neg_lo:[1,0,0]
    v_cvt_pk_bf16_f32 v186, v54, v56
    v_cvt_pk_bf16_f32 v190, v55, v57
    v_pk_mul_f32 v[58:59], v[52:53], v[54:55] op_sel:[0,0] op_sel_hi:[0,1]
    v_pk_fma_f32 v[58:59], v[52:53], v[54:55], v[58:59] op_sel:[1,1,0] op_sel_hi:[1,0,1] neg_hi:[1,0,0]
    v_pk_mul_f32 v[60:61], v[52:53], v[56:57] op_sel:[0,0] op_sel_hi:[0,1]
    v_pk_fma_f32 v[60:61], v[52:53], v[56:57], v[60:61] op_sel:[1,1,0] op_sel_hi:[1,0,1] neg_hi:[1,0,0]
    v_pk_mul_f32 v[76:77], v[68:69], v[84:85] op_sel:[0,0] op_sel_hi:[0,1]
    v_pk_fma_f32 v[76:77], v[68:69], v[84:85], v[76:77] op_sel:[1,1,0] op_sel_hi:[1,0,1] neg_lo:[1,0,0]
    v_cvt_pk_bf16_f32 v242, v84, v76
    v_cvt_pk_bf16_f32 v246, v85, v77
    v_pk_mul_f32 v[86:87], v[80:81], v[82:83] op_sel:[0,0] op_sel_hi:[0,1]
    v_pk_fma_f32 v[86:87], v[80:81], v[82:83], v[86:87] op_sel:[1,1,0] op_sel_hi:[1,0,1] neg_lo:[1,0,0]
    v_cvt_pk_bf16_f32 v187, v58, v60
    v_cvt_pk_bf16_f32 v191, v59, v61
    v_pk_mul_f32 v[54:55], v[52:53], v[58:59] op_sel:[0,0] op_sel_hi:[0,1]
    v_pk_fma_f32 v[54:55], v[52:53], v[58:59], v[54:55] op_sel:[1,1,0] op_sel_hi:[1,0,1] neg_hi:[1,0,0]
    v_pk_mul_f32 v[56:57], v[52:53], v[60:61] op_sel:[0,0] op_sel_hi:[0,1]
    v_pk_fma_f32 v[56:57], v[52:53], v[60:61], v[56:57] op_sel:[1,1,0] op_sel_hi:[1,0,1] neg_hi:[1,0,0]
    v_pk_mul_f32 v[78:79], v[50:51], v[86:87] op_sel:[0,0] op_sel_hi:[0,1]
    v_pk_fma_f32 v[78:79], v[50:51], v[86:87], v[78:79] op_sel:[1,1,0] op_sel_hi:[1,0,1] neg_lo:[1,0,0]
    v_cvt_pk_bf16_f32 v243, v86, v78
    v_cvt_pk_bf16_f32 v247, v87, v79
    v_cvt_pk_bf16_f32 v192, v54, v56
    v_cvt_pk_bf16_f32 v196, v55, v57
    v_pk_mul_f32 v[58:59], v[52:53], v[54:55] op_sel:[0,0] op_sel_hi:[0,1]
    v_pk_fma_f32 v[58:59], v[52:53], v[54:55], v[58:59] op_sel:[1,1,0] op_sel_hi:[1,0,1] neg_hi:[1,0,0]
    v_pk_mul_f32 v[60:61], v[52:53], v[56:57] op_sel:[0,0] op_sel_hi:[0,1]
    v_pk_fma_f32 v[60:61], v[52:53], v[56:57], v[60:61] op_sel:[1,1,0] op_sel_hi:[1,0,1] neg_hi:[1,0,0]
    v_pk_mul_f32 v[76:77], v[64:65], v[50:51] op_sel:[0,0] op_sel_hi:[0,1]
    v_pk_fma_f32 v[76:77], v[64:65], v[50:51], v[76:77] op_sel:[1,1,0] op_sel_hi:[1,0,1] neg_lo:[1,0,0]
    v_cvt_pk_bf16_f32 v248, v50, v76
    v_cvt_pk_bf16_f32 v252, v51, v77
    v_pk_mul_f32 v[76:77], v[68:69], v[50:51] op_sel:[0,0] op_sel_hi:[0,1]
    v_pk_fma_f32 v[76:77], v[68:69], v[50:51], v[76:77] op_sel:[1,1,0] op_sel_hi:[1,0,1] neg_lo:[1,0,0]
    v_cvt_pk_bf16_f32 v193, v58, v60
    v_cvt_pk_bf16_f32 v197, v59, v61
    v_pk_mul_f32 v[54:55], v[52:53], v[58:59] op_sel:[0,0] op_sel_hi:[0,1]
    v_pk_fma_f32 v[54:55], v[52:53], v[58:59], v[54:55] op_sel:[1,1,0] op_sel_hi:[1,0,1] neg_hi:[1,0,0]
    v_pk_mul_f32 v[56:57], v[52:53], v[60:61] op_sel:[0,0] op_sel_hi:[0,1]
    v_pk_fma_f32 v[56:57], v[52:53], v[60:61], v[56:57] op_sel:[1,1,0] op_sel_hi:[1,0,1] neg_hi:[1,0,0]
    v_pk_mul_f32 v[78:79], v[72:73], v[50:51] op_sel:[0,0] op_sel_hi:[0,1]
    v_pk_fma_f32 v[78:79], v[72:73], v[50:51], v[78:79] op_sel:[1,1,0] op_sel_hi:[1,0,1] neg_lo:[1,0,0]
    v_cvt_pk_bf16_f32 v249, v76, v78
    v_cvt_pk_bf16_f32 v253, v77, v79
    v_pk_mul_f32 v[76:77], v[82:83], v[82:83] op_sel:[0,0] op_sel_hi:[0,1]
    v_pk_fma_f32 v[76:77], v[82:83], v[82:83], v[76:77] op_sel:[1,1,0] op_sel_hi:[1,0,1] neg_lo:[1,0,0]
    v_cvt_pk_bf16_f32 v194, v54, v56
    v_cvt_pk_bf16_f32 v198, v55, v57
    v_pk_mul_f32 v[58:59], v[52:53], v[54:55] op_sel:[0,0] op_sel_hi:[0,1]
    v_pk_fma_f32 v[58:59], v[52:53], v[54:55], v[58:59] op_sel:[1,1,0] op_sel_hi:[1,0,1] neg_hi:[1,0,0]
    v_pk_mul_f32 v[60:61], v[52:53], v[56:57] op_sel:[0,0] op_sel_hi:[0,1]
    v_pk_fma_f32 v[60:61], v[52:53], v[56:57], v[60:61] op_sel:[1,1,0] op_sel_hi:[1,0,1] neg_hi:[1,0,0]
    v_cvt_pk_bf16_f32 v250, v76, v76
    v_cvt_pk_bf16_f32 v254, v77, v77
    v_cvt_pk_bf16_f32 v251, v76, v76
    v_cvt_pk_bf16_f32 v255, v77, v77
    v_cvt_pk_bf16_f32 v195, v58, v60
    v_cvt_pk_bf16_f32 v199, v59, v61
    v_pk_mul_f32 v[54:55], v[52:53], v[58:59] op_sel:[0,0] op_sel_hi:[0,1]
    v_pk_fma_f32 v[54:55], v[52:53], v[58:59], v[54:55] op_sel:[1,1,0] op_sel_hi:[1,0,1] neg_hi:[1,0,0]
    v_pk_mul_f32 v[56:57], v[52:53], v[60:61] op_sel:[0,0] op_sel_hi:[0,1]
    v_pk_fma_f32 v[56:57], v[52:53], v[60:61], v[56:57] op_sel:[1,1,0] op_sel_hi:[1,0,1] neg_hi:[1,0,0]
    v_cvt_pk_bf16_f32 v200, v54, v56
    v_cvt_pk_bf16_f32 v204, v55, v57
    v_pk_mul_f32 v[58:59], v[52:53], v[54:55] op_sel:[0,0] op_sel_hi:[0,1]
    v_pk_fma_f32 v[58:59], v[52:53], v[54:55], v[58:59] op_sel:[1,1,0] op_sel_hi:[1,0,1] neg_hi:[1,0,0]
    v_pk_mul_f32 v[60:61], v[52:53], v[56:57] op_sel:[0,0] op_sel_hi:[0,1]
    v_pk_fma_f32 v[60:61], v[52:53], v[56:57], v[60:61] op_sel:[1,1,0] op_sel_hi:[1,0,1] neg_hi:[1,0,0]
    v_cvt_pk_bf16_f32 v201, v58, v60
    v_cvt_pk_bf16_f32 v205, v59, v61
    v_pk_mul_f32 v[54:55], v[52:53], v[58:59] op_sel:[0,0] op_sel_hi:[0,1]
    v_pk_fma_f32 v[54:55], v[52:53], v[58:59], v[54:55] op_sel:[1,1,0] op_sel_hi:[1,0,1] neg_hi:[1,0,0]
    v_pk_mul_f32 v[56:57], v[52:53], v[60:61] op_sel:[0,0] op_sel_hi:[0,1]
    v_pk_fma_f32 v[56:57], v[52:53], v[60:61], v[56:57] op_sel:[1,1,0] op_sel_hi:[1,0,1] neg_hi:[1,0,0]
    v_cvt_pk_bf16_f32 v202, v54, v56
    v_cvt_pk_bf16_f32 v206, v55, v57
    v_pk_mul_f32 v[58:59], v[52:53], v[54:55] op_sel:[0,0] op_sel_hi:[0,1]
    v_pk_fma_f32 v[58:59], v[52:53], v[54:55], v[58:59] op_sel:[1,1,0] op_sel_hi:[1,0,1] neg_hi:[1,0,0]
    v_pk_mul_f32 v[60:61], v[52:53], v[56:57] op_sel:[0,0] op_sel_hi:[0,1]
    v_pk_fma_f32 v[60:61], v[52:53], v[56:57], v[60:61] op_sel:[1,1,0] op_sel_hi:[1,0,1] neg_hi:[1,0,0]
    v_cvt_pk_bf16_f32 v203, v58, v60
    v_cvt_pk_bf16_f32 v207, v59, v61
    ds_write_b128 v104, v[144:147] offset:0
    ds_write_b128 v104, v[148:151] offset:4096
    ds_write_b128 v105, v[152:155] offset:0
    ds_write_b128 v105, v[156:159] offset:4096
    ds_write_b128 v106, v[160:163] offset:0
    ds_write_b128 v106, v[164:167] offset:4096
    ds_write_b128 v107, v[168:171] offset:0
    ds_write_b128 v107, v[172:175] offset:4096
    ds_write_b128 v104, v[208:211] offset:8192
    ds_write_b128 v104, v[212:215] offset:12288
    ds_write_b128 v105, v[216:219] offset:8192
    ds_write_b128 v105, v[220:223] offset:12288
    ds_write_b128 v106, v[224:227] offset:8192
    ds_write_b128 v106, v[228:231] offset:12288
    s_waitcnt lgkmcnt(0)
    ds_read_b64_tr_b16 v[128:129], v108 offset:8192
    ds_read_b64_tr_b16 v[130:131], v108 offset:12288
    ds_read_b64_tr_b16 v[136:137], v108 offset:0
    ds_read_b64_tr_b16 v[138:139], v108 offset:4096
    ds_read_b64_tr_b16 v[132:133], v108 offset:8704
    ds_read_b64_tr_b16 v[134:135], v108 offset:12800
    ds_read_b64_tr_b16 v[140:141], v108 offset:512
    ds_read_b64_tr_b16 v[142:143], v108 offset:4608
    s_waitcnt lgkmcnt(4)
    v_mfma_f32_32x32x16_bf16 v[112:127], v[128:131], v[136:139], 0
    ds_read_b64_tr_b16 v[128:129], v108 offset:9216
    ds_read_b64_tr_b16 v[130:131], v108 offset:13312
    ds_read_b64_tr_b16 v[136:137], v108 offset:1024
    ds_read_b64_tr_b16 v[138:139], v108 offset:5120
    s_waitcnt lgkmcnt(4)
    v_mfma_f32_32x32x16_bf16 v[112:127], v[132:135], v[140:143], v[112:127]
    ds_read_b64_tr_b16 v[132:133], v108 offset:9728
    ds_read_b64_tr_b16 v[134:135], v108 offset:13824
    ds_read_b64_tr_b16 v[140:141], v108 offset:1536
    ds_read_b64_tr_b16 v[142:143], v108 offset:5632
    s_waitcnt lgkmcnt(4)
    v_mfma_f32_32x32x16_bf16 v[112:127], v[128:131], v[136:139], v[112:127]
    ds_read_b64_tr_b16 v[128:129], v108 offset:10240
    ds_read_b64_tr_b16 v[130:131], v108 offset:14336
    ds_read_b64_tr_b16 v[136:137], v108 offset:2048
    ds_read_b64_tr_b16 v[138:139], v108 offset:6144
    s_waitcnt lgkmcnt(4)
    v_mfma_f32_32x32x16_bf16 v[112:127], v[132:135], v[140:143], v[112:127]
    ds_read_b64_tr_b16 v[132:133], v108 offset:10752
    ds_read_b64_tr_b16 v[134:135], v108 offset:14848
    ds_read_b64_tr_b16 v[140:141], v108 offset:2560
    ds_read_b64_tr_b16 v[142:143], v108 offset:6656
    s_waitcnt lgkmcnt(4)
    v_mfma_f32_32x32x16_bf16 v[112:127], v[128:131], v[136:139], v[112:127]
    ds_read_b64_tr_b16 v[128:129], v108 offset:11264
    ds_read_b64_tr_b16 v[130:131], v108 offset:15360
    ds_read_b64_tr_b16 v[136:137], v108 offset:3072
    ds_read_b64_tr_b16 v[138:139], v108 offset:7168
    s_waitcnt lgkmcnt(4)
    v_mfma_f32_32x32x16_bf16 v[112:127], v[132:135], v[140:143], v[112:127]
    ds_read_b64_tr_b16 v[132:133], v108 offset:11776
    ds_read_b64_tr_b16 v[134:135], v108 offset:15872
    ds_read_b64_tr_b16 v[140:141], v108 offset:3584
    ds_read_b64_tr_b16 v[142:143], v108 offset:7680
    s_waitcnt lgkmcnt(4)
    v_mfma_f32_32x32x16_bf16 v[112:127], v[128:131], v[136:139], v[112:127]
    s_waitcnt lgkmcnt(0)
    v_mfma_f32_32x32x16_bf16 v[112:127], v[132:135], v[140:143], v[112:127]
    s_waitcnt lgkmcnt(0)
    ds_write_b128 v104, v[176:179] offset:0
    ds_write_b128 v104, v[180:183] offset:4096
    ds_write_b128 v105, v[184:187] offset:0
    ds_write_b128 v105, v[188:191] offset:4096
    ds_write_b128 v106, v[192:195] offset:0
    ds_write_b128 v106, v[196:199] offset:4096
    ds_write_b128 v107, v[200:203] offset:0
    ds_write_b128 v107, v[204:207] offset:4096
    ds_write_b128 v104, v[232:235] offset:8192
    ds_write_b128 v104, v[236:239] offset:12288
    ds_write_b128 v105, v[240:243] offset:8192
    ds_write_b128 v105, v[244:247] offset:12288
    ds_write_b128 v106, v[248:251] offset:8192
    ds_write_b128 v106, v[252:255] offset:12288
    s_waitcnt lgkmcnt(0)
    ds_read_b64_tr_b16 v[128:129], v108 offset:8192
    ds_read_b64_tr_b16 v[130:131], v108 offset:12288
    ds_read_b64_tr_b16 v[136:137], v108 offset:0
    ds_read_b64_tr_b16 v[138:139], v108 offset:4096
    ds_read_b64_tr_b16 v[132:133], v108 offset:8704
    ds_read_b64_tr_b16 v[134:135], v108 offset:12800
    ds_read_b64_tr_b16 v[140:141], v108 offset:512
    ds_read_b64_tr_b16 v[142:143], v108 offset:4608
    s_waitcnt lgkmcnt(4)
    v_mfma_f32_32x32x16_bf16 v[112:127], v[128:131], v[136:139], v[112:127]
    ds_read_b64_tr_b16 v[128:129], v108 offset:9216
    ds_read_b64_tr_b16 v[130:131], v108 offset:13312
    ds_read_b64_tr_b16 v[136:137], v108 offset:1024
    ds_read_b64_tr_b16 v[138:139], v108 offset:5120
    s_waitcnt lgkmcnt(4)
    v_mfma_f32_32x32x16_bf16 v[112:127], v[132:135], v[140:143], v[112:127]
    ds_read_b64_tr_b16 v[132:133], v108 offset:9728
    ds_read_b64_tr_b16 v[134:135], v108 offset:13824
    ds_read_b64_tr_b16 v[140:141], v108 offset:1536
    ds_read_b64_tr_b16 v[142:143], v108 offset:5632
    s_waitcnt lgkmcnt(4)
    v_mfma_f32_32x32x16_bf16 v[112:127], v[128:131], v[136:139], v[112:127]
    ds_read_b64_tr_b16 v[128:129], v108 offset:10240
    ds_read_b64_tr_b16 v[130:131], v108 offset:14336
    ds_read_b64_tr_b16 v[136:137], v108 offset:2048
    ds_read_b64_tr_b16 v[138:139], v108 offset:6144
    s_waitcnt lgkmcnt(4)
    v_mfma_f32_32x32x16_bf16 v[112:127], v[132:135], v[140:143], v[112:127]
    ds_read_b64_tr_b16 v[132:133], v108 offset:10752
    ds_read_b64_tr_b16 v[134:135], v108 offset:14848
    ds_read_b64_tr_b16 v[140:141], v108 offset:2560
    ds_read_b64_tr_b16 v[142:143], v108 offset:6656
    s_waitcnt lgkmcnt(4)
    v_mfma_f32_32x32x16_bf16 v[112:127], v[128:131], v[136:139], v[112:127]
    ds_read_b64_tr_b16 v[128:129], v108 offset:11264
    ds_read_b64_tr_b16 v[130:131], v108 offset:15360
    ds_read_b64_tr_b16 v[136:137], v108 offset:3072
    ds_read_b64_tr_b16 v[138:139], v108 offset:7168
    s_waitcnt lgkmcnt(4)
    v_mfma_f32_32x32x16_bf16 v[112:127], v[132:135], v[140:143], v[112:127]
    ds_read_b64_tr_b16 v[132:133], v108 offset:11776
    ds_read_b64_tr_b16 v[134:135], v108 offset:15872
    ds_read_b64_tr_b16 v[140:141], v108 offset:3584
    ds_read_b64_tr_b16 v[142:143], v108 offset:7680
    s_waitcnt lgkmcnt(4)
    v_mfma_f32_32x32x16_bf16 v[112:127], v[128:131], v[136:139], v[112:127]
    s_waitcnt lgkmcnt(0)
    v_mfma_f32_32x32x16_bf16 v[112:127], v[132:135], v[140:143], v[112:127]
    s_mul_i32 s55, s53, 205
    s_lshr_b32 s55, s55, 14
    s_lshl_b32 s55, s55, 7
    v_and_b32 v19, 31, v1
    v_lshlrev_b32 v19, 2, v19
    v_add_u32 v19, s55, v19
    buffer_load_dword v18, v19, s[44:47], 0 offen sc1
    s_nop 15
    s_add_u32 s15, s57, 21248
    v_and_b32 v144, 31, v1
    v_lshrrev_b32 v145, 5, v1
    v_lshlrev_b32 v2, 5, v144
    v_lshlrev_b32 v3, 4, v145
    v_add3_u32 v2, v2, v3, s15
    ds_write_b128 v2, v[112:115]
    v_lshlrev_b32 v2, 3, v144
    v_lshlrev_b32 v3, 8, v145
    v_add3_u32 v2, v2, v3, s15
    ds_write_b64 v2, v[116:117] offset:1536
    v_lshlrev_b32 v2, 2, v144
    v_add3_u32 v2, v2, v3, s15
    ds_write_b32 v2, v118 offset:2048
    ds_write_b32 v2, v119 offset:2176
    v_lshlrev_b32 v2, 4, v144
    v_add_u32 v2, s15, v2
    s_mov_b32 exec_hi, 0
    ds_write_b128 v2, v[120:123] offset:1024
    s_mov_b32 exec_lo, 0
    s_mov_b32 exec_hi, 1
    ds_write_b32 v2, v120 offset:2560
    s_mov_b64 exec, -1
    v_and_b32 v173, 1, v1
    v_cmp_eq_u32 s[16:17], 1, v173
    v_cmp_lt_u32 s[18:19], 31, v1
    v_lshlrev_b32 v2, 2, v1
    v_add_u32 v2, s15, v2
    v_lshlrev_b32 v3, 3, v1
    v_add_u32 v3, s15, v3
    v_sub_u32 v172, 63, v1
    v_lshlrev_b32 v172, 4, v172
    v_add_u32 v172, s57, v172
    v_add_u32 v4, 2304, v2
    v_add_u32 v5, 2048, v2
    v_add_u32 v6, 1536, v3
    s_waitcnt lgkmcnt(0)
    ds_read2_b32 v[148:149], v4 offset0:0 offset1:1
    ds_read2_b32 v[150:151], v5 offset0:0 offset1:1
    ds_read_b64 v[152:153], v6
    ds_read_b32 v154, v6 offset:8
    v_lshlrev_b32 v4, 5, v1
    v_lshlrev_b32 v5, 4, v1
    v_add_u32 v5, 512, v5
    v_cndmask_b32 v4, v4, v5, s[18:19]
    v_add_u32 v4, s15, v4
    s_waitcnt lgkmcnt(0)
    v_cvt_pk_bf16_f32 v156, v149, v149
    v_cvt_pk_bf16_f32 v7, v149, v148
    v_cvt_pk_bf16_f32 v158, v148, v148
    v_cndmask_b32 v157, v7, v156, s[16:17]
    v_mov_b32 v159, v158
    v_cvt_pk_bf16_f32 v160, v151, v151
    v_cvt_pk_bf16_f32 v7, v151, v150
    v_cvt_pk_bf16_f32 v162, v150, v150
    v_cndmask_b32 v161, v7, v160, s[16:17]
    v_mov_b32 v163, v162
    v_cvt_pk_bf16_f32 v164, v154, v154
    v_cvt_pk_bf16_f32 v165, v153, v153
    v_cvt_pk_bf16_f32 v166, v153, v152
    v_cvt_pk_bf16_f32 v167, v152, v152
    ds_read_b128 v[148:151], v4
    ds_read_b128 v[152:155], v4 offset:16
    s_waitcnt lgkmcnt(0)
    v_cndmask_b32 v6, v155, v152, s[18:19]
    v_cndmask_b32 v7, v154, v151, s[18:19]
    v_cvt_pk_bf16_f32 v168, v6, v7
    v_cndmask_b32 v6, v153, v150, s[18:19]
    v_cndmask_b32 v7, v152, v150, s[18:19]
    v_cvt_pk_bf16_f32 v169, v6, v7
    v_cndmask_b32 v6, v151, v150, s[18:19]
    v_cndmask_b32 v7, v150, v149, s[18:19]
    v_cvt_pk_bf16_f32 v170, v6, v7
    v_cndmask_b32 v6, v149, v148, s[18:19]
    v_cndmask_b32 v7, v148, v148, s[18:19]
    v_cvt_pk_bf16_f32 v171, v6, v7
    ds_write_b128 v172, v[156:159] offset:0
    ds_write_b128 v172, v[160:163] offset:1024
    ds_write_b128 v172, v[164:167] offset:2048
    ds_write_b128 v172, v[168:171] offset:3072
    v_mov_b32 v4, 0
    v_mov_b32 v5, 0
    v_lshlrev_b32 v6, 3, v1
    v_add_u32 v6, s57, v6
    ds_write_b64 v6, v[4:5] offset:16640
    v_lshrrev_b32 v7, 3, v1
    v_and_b32 v7, 3, v7
    v_mul_u32_u24 v7, 4160, v7
    v_and_b32 v8, 7, v1
    v_lshlrev_b32 v8, 3, v8
    v_add3_u32 v7, v7, v8, s57
    ds_write_b64 v7, v[4:5] offset:4096
    s_waitcnt lgkmcnt(0)
    ds_read_b64 v[174:175], v172 offset:16
    ds_read_b64 v[176:177], v172 offset:1040
    ds_read_b64 v[178:179], v172 offset:2064
    ds_read_b64 v[180:181], v172 offset:3088
    s_mov_b32 s63, 0
    s_waitcnt vmcnt(0)
fp_3:
    v_cmp_eq_u32 vcc, s62, v18
    s_nop 4
    s_cmp_eq_u64 vcc, -1
    s_cbranch_scc1 fok_4
    s_sleep 4
    buffer_load_dword v18, v19, s[44:47], 0 offen sc1
    s_add_u32 s63, s63, 1
    s_waitcnt vmcnt(0)
    s_cmp_lt_u32 s63, 100000
    s_cbranch_scc1 fp_3
fok_4:
    s_lshl_b32 s20, s53, 12
    buffer_load_dwordx4 v[20:23], v10, s[40:43], s20 offen offset:0 sc1
    buffer_load_dwordx4 v[24:27], v10, s[40:43], s20 offen offset:1024 sc1
    buffer_load_dwordx4 v[28:31], v10, s[40:43], s20 offen offset:2048 sc1
    buffer_load_dwordx4 v[32:35], v10, s[40:43], s20 offen offset:3072 sc1
    s_waitcnt lgkmcnt(0)
    v_alignbit_b32 v184, v157, v156, 16
    v_mov_b32 v188, v157
    v_alignbit_b32 v192, v158, v157, 16
    v_alignbit_b32 v185, v158, v157, 16
    v_mov_b32 v189, v158
    v_alignbit_b32 v193, v159, v158, 16
    v_alignbit_b32 v186, v159, v158, 16
    v_mov_b32 v190, v159
    v_alignbit_b32 v194, v174, v159, 16
    v_alignbit_b32 v187, v174, v159, 16
    v_mov_b32 v191, v174
    v_alignbit_b32 v195, v175, v174, 16
    ds_write_b128 v172, v[184:187] offset:4160
    ds_write_b128 v172, v[188:191] offset:8320
    ds_write_b128 v172, v[192:195] offset:12480
    s_nop 1
    v_alignbit_b32 v184, v161, v160, 16
    v_mov_b32 v188, v161
    v_alignbit_b32 v192, v162, v161, 16
    v_alignbit_b32 v185, v162, v161, 16
    v_mov_b32 v189, v162
    v_alignbit_b32 v193, v163, v162, 16
    v_alignbit_b32 v186, v163, v162, 16
    v_mov_b32 v190, v163
    v_alignbit_b32 v194, v176, v163, 16
    v_alignbit_b32 v187, v176, v163, 16
    v_mov_b32 v191, v176
    v_alignbit_b32 v195, v177, v176, 16
    ds_write_b128 v172, v[184:187] offset:5184
    ds_write_b128 v172, v[188:191] offset:9344
    ds_write_b128 v172, v[192:195] offset:13504
    s_nop 1
    v_alignbit_b32 v184, v165, v164, 16
    v_mov_b32 v188, v165
    v_alignbit_b32 v192, v166, v165, 16
    v_alignbit_b32 v185, v166, v165, 16
    v_mov_b32 v189, v166
    v_alignbit_b32 v193, v167, v166, 16
    v_alignbit_b32 v186, v167, v166, 16
    v_mov_b32 v190, v167
    v_alignbit_b32 v194, v178, v167, 16
    v_alignbit_b32 v187, v178, v167, 16
    v_mov_b32 v191, v178
    v_alignbit_b32 v195, v179, v178, 16
    ds_write_b128 v172, v[184:187] offset:6208
    ds_write_b128 v172, v[188:191] offset:10368
    ds_write_b128 v172, v[192:195] offset:14528
    s_nop 1
    v_alignbit_b32 v184, v169, v168, 16
    v_mov_b32 v188, v169
    v_alignbit_b32 v192, v170, v169, 16
    v_alignbit_b32 v185, v170, v169, 16
    v_mov_b32 v189, v170
    v_alignbit_b32 v193, v171, v170, 16
    v_alignbit_b32 v186, v171, v170, 16
    v_mov_b32 v190, v171
    v_alignbit_b32 v194, v180, v171, 16
    v_alignbit_b32 v187, v180, v171, 16
    v_mov_b32 v191, v180
    v_alignbit_b32 v195, v181, v180, 16
    ds_write_b128 v172, v[184:187] offset:7232
    ds_write_b128 v172, v[188:191] offset:11392
    ds_write_b128 v172, v[192:195] offset:15552
    v_add_u32 v2, s57, v10
    s_waitcnt vmcnt(0)
    ds_write_b128 v2, v[20:23] offset:17152
    ds_write_b128 v2, v[24:27] offset:18176
    ds_write_b128 v2, v[28:31] offset:19200
    ds_write_b128 v2, v[32:35] offset:20224
    v_and_b32 v36, 15, v1
    v_lshrrev_b32 v37, 4, v1
    v_sub_u32 v2, 3, v36
    v_and_b32 v2, 3, v2
    v_lshlrev_b32 v3, 3, v37
    v_sub_u32 v3, v3, v36
    v_sub_u32 v3, v3, v2
    v_add_u32 v3, 15, v3
    v_lshlrev_b32 v3, 1, v3
    v_mul_u32_u24 v2, 4160, v2
    v_add3_u32 v38, v2, v3, s57
    v_lshlrev_b32 v2, 5, v36
    v_lshlrev_b32 v3, 4, v37
    v_add3_u32 v39, v2, v3, s57
    v_add_u32 v39, 16672, v39
    s_waitcnt lgkmcnt(0)
    ds_read_b128 v[136:139], v39 offset:448
    ds_read_b64 v[72:73], v38 offset:4032
    ds_read_b64 v[74:75], v38 offset:4040
    ds_read_b128 v[140:143], v39 offset:960
    ds_read_b64 v[76:77], v38 offset:3520
    ds_read_b64 v[78:79], v38 offset:3528
    ds_read_b128 v[144:147], v39 offset:1472
    ds_read_b64 v[80:81], v38 offset:3008
    ds_read_b64 v[82:83], v38 offset:3016
    ds_read_b128 v[148:151], v39 offset:1984
    ds_read_b64 v[84:85], v38 offset:2496
    ds_read_b64 v[86:87], v38 offset:2504
    ds_read_b128 v[152:155], v39 offset:2496
    ds_read_b64 v[88:89], v38 offset:1984
    ds_read_b64 v[90:91], v38 offset:1992
    ds_read_b128 v[156:159], v39 offset:3008
    ds_read_b64 v[92:93], v38 offset:1472
    ds_read_b64 v[94:95], v38 offset:1480
    ds_read_b128 v[160:163], v39 offset:3520
    ds_read_b64 v[96:97], v38 offset:960
    ds_read_b64 v[98:99], v38 offset:968
    ds_read_b128 v[164:167], v39 offset:4032
    ds_read_b64 v[100:101], v38 offset:448
    ds_read_b64 v[102:103], v38 offset:456
    s_waitcnt lgkmcnt(0)
    v_mfma_f32_16x16x32_bf16 v[40:43], v[72:75], v[136:139], 0
    ds_read_b128 v[168:171], v39 offset:384
    v_mfma_f32_16x16x32_bf16 v[44:47], v[72:75], v[140:143], 0
    ds_read_b64 v[104:105], v38 offset:3968
    v_mfma_f32_16x16x32_bf16 v[48:51], v[72:75], v[144:147], 0
    ds_read_b64 v[106:107], v38 offset:3976
    v_mfma_f32_16x16x32_bf16 v[52:55], v[72:75], v[148:151], 0
    ds_read_b128 v[172:175], v39 offset:896
    v_mfma_f32_16x16x32_bf16 v[56:59], v[72:75], v[152:155], 0
    ds_read_b64 v[108:109], v38 offset:3456
    v_mfma_f32_16x16x32_bf16 v[60:63], v[72:75], v[156:159], 0
    ds_read_b64 v[110:111], v38 offset:3464
    v_mfma_f32_16x16x32_bf16 v[64:67], v[72:75], v[160:163], 0
    ds_read_b128 v[176:179], v39 offset:1408
    v_mfma_f32_16x16x32_bf16 v[68:71], v[72:75], v[164:167], 0
    ds_read_b64 v[112:113], v38 offset:2944
    v_mfma_f32_16x16x32_bf16 v[44:47], v[76:79], v[136:139], v[44:47]
    ds_read_b64 v[114:115], v38 offset:2952
    v_mfma_f32_16x16x32_bf16 v[48:51], v[76:79], v[140:143], v[48:51]
    ds_read_b128 v[180:183], v39 offset:1920
    v_mfma_f32_16x16x32_bf16 v[52:55], v[76:79], v[144:147], v[52:55]
    ds_read_b64 v[116:117], v38 offset:2432
    v_mfma_f32_16x16x32_bf16 v[56:59], v[76:79], v[148:151], v[56:59]
    ds_read_b64 v[118:119], v38 offset:2440
    v_mfma_f32_16x16x32_bf16 v[60:63], v[76:79], v[152:155], v[60:63]
    ds_read_b128 v[184:187], v39 offset:2432
    v_mfma_f32_16x16x32_bf16 v[64:67], v[76:79], v[156:159], v[64:67]
    ds_read_b64 v[120:121], v38 offset:1920
    v_mfma_f32_16x16x32_bf16 v[68:71], v[76:79], v[160:163], v[68:71]
    ds_read_b64 v[122:123], v38 offset:1928
    v_mfma_f32_16x16x32_bf16 v[48:51], v[80:83], v[136:139], v[48:51]
    ds_read_b128 v[188:191], v39 offset:2944
    v_mfma_f32_16x16x32_bf16 v[52:55], v[80:83], v[140:143], v[52:55]
    ds_read_b64 v[124:125], v38 offset:1408
    v_mfma_f32_16x16x32_bf16 v[56:59], v[80:83], v[144:147], v[56:59]
    ds_read_b64 v[126:127], v38 offset:1416
    v_mfma_f32_16x16x32_bf16 v[60:63], v[80:83], v[148:151], v[60:63]
    ds_read_b128 v[192:195], v39 offset:3456
    v_mfma_f32_16x16x32_bf16 v[64:67], v[80:83], v[152:155], v[64:67]
    ds_read_b64 v[128:129], v38 offset:896
    v_mfma_f32_16x16x32_bf16 v[68:71], v[80:83], v[156:159], v[68:71]
    ds_read_b64 v[130:131], v38 offset:904
    v_mfma_f32_16x16x32_bf16 v[52:55], v[84:87], v[136:139], v[52:55]
    ds_read_b128 v[196:199], v39 offset:3968
    v_mfma_f32_16x16x32_bf16 v[56:59], v[84:87], v[140:143], v[56:59]
    ds_read_b64 v[132:133], v38 offset:384
    v_mfma_f32_16x16x32_bf16 v[60:63], v[84:87], v[144:147], v[60:63]
    ds_read_b64 v[134:135], v38 offset:392
    v_mfma_f32_16x16x32_bf16 v[64:67], v[84:87], v[148:151], v[64:67]
    v_mfma_f32_16x16x32_bf16 v[68:71], v[84:87], v[152:155], v[68:71]
    v_mfma_f32_16x16x32_bf16 v[56:59], v[88:91], v[136:139], v[56:59]
    v_mfma_f32_16x16x32_bf16 v[60:63], v[88:91], v[140:143], v[60:63]
    v_mfma_f32_16x16x32_bf16 v[64:67], v[88:91], v[144:147], v[64:67]
    v_mfma_f32_16x16x32_bf16 v[68:71], v[88:91], v[148:151], v[68:71]
    v_mfma_f32_16x16x32_bf16 v[60:63], v[92:95], v[136:139], v[60:63]
    v_mfma_f32_16x16x32_bf16 v[64:67], v[92:95], v[140:143], v[64:67]
    v_mfma_f32_16x16x32_bf16 v[68:71], v[92:95], v[144:147], v[68:71]
    v_mfma_f32_16x16x32_bf16 v[64:67], v[96:99], v[136:139], v[64:67]
    v_mfma_f32_16x16x32_bf16 v[68:71], v[96:99], v[140:143], v[68:71]
    v_mfma_f32_16x16x32_bf16 v[68:71], v[100:103], v[136:139], v[68:71]
    s_waitcnt lgkmcnt(0)
    v_mfma_f32_16x16x32_bf16 v[40:43], v[104:107], v[168:171], v[40:43]
    ds_read_b128 v[136:139], v39 offset:320
    v_mfma_f32_16x16x32_bf16 v[44:47], v[104:107], v[172:175], v[44:47]
    ds_read_b64 v[72:73], v38 offset:3904
    v_mfma_f32_16x16x32_bf16 v[48:51], v[104:107], v[176:179], v[48:51]
    ds_read_b64 v[74:75], v38 offset:3912
    v_mfma_f32_16x16x32_bf16 v[52:55], v[104:107], v[180:183], v[52:55]
    ds_read_b128 v[140:143], v39 offset:832
    v_mfma_f32_16x16x32_bf16 v[56:59], v[104:107], v[184:187], v[56:59]
    ds_read_b64 v[76:77], v38 offset:3392
    v_mfma_f32_16x16x32_bf16 v[60:63], v[104:107], v[188:191], v[60:63]
    ds_read_b64 v[78:79], v38 offset:3400
    v_mfma_f32_16x16x32_bf16 v[64:67], v[104:107], v[192:195], v[64:67]
    ds_read_b128 v[144:147], v39 offset:1344
    v_mfma_f32_16x16x32_bf16 v[68:71], v[104:107], v[196:199], v[68:71]
    ds_read_b64 v[80:81], v38 offset:2880
    v_mfma_f32_16x16x32_bf16 v[44:47], v[108:111], v[168:171], v[44:47]
    ds_read_b64 v[82:83], v38 offset:2888
    v_mfma_f32_16x16x32_bf16 v[48:51], v[108:111], v[172:175], v[48:51]
    ds_read_b128 v[148:151], v39 offset:1856
    v_mfma_f32_16x16x32_bf16 v[52:55], v[108:111], v[176:179], v[52:55]
    ds_read_b64 v[84:85], v38 offset:2368
    v_mfma_f32_16x16x32_bf16 v[56:59], v[108:111], v[180:183], v[56:59]
    ds_read_b64 v[86:87], v38 offset:2376
    v_mfma_f32_16x16x32_bf16 v[60:63], v[108:111], v[184:187], v[60:63]
    ds_read_b128 v[152:155], v39 offset:2368
    v_mfma_f32_16x16x32_bf16 v[64:67], v[108:111], v[188:191], v[64:67]
    ds_read_b64 v[88:89], v38 offset:1856
    v_mfma_f32_16x16x32_bf16 v[68:71], v[108:111], v[192:195], v[68:71]
    ds_read_b64 v[90:91], v38 offset:1864
    v_mfma_f32_16x16x32_bf16 v[48:51], v[112:115], v[168:171], v[48:51]
    ds_read_b128 v[156:159], v39 offset:2880
    v_mfma_f32_16x16x32_bf16 v[52:55], v[112:115], v[172:175], v[52:55]
    ds_read_b64 v[92:93], v38 offset:1344
    v_mfma_f32_16x16x32_bf16 v[56:59], v[112:115], v[176:179], v[56:59]
    ds_read_b64 v[94:95], v38 offset:1352
    v_mfma_f32_16x16x32_bf16 v[60:63], v[112:115], v[180:183], v[60:63]
    ds_read_b128 v[160:163], v39 offset:3392
    v_mfma_f32_16x16x32_bf16 v[64:67], v[112:115], v[184:187], v[64:67]
    ds_read_b64 v[96:97], v38 offset:832
    v_mfma_f32_16x16x32_bf16 v[68:71], v[112:115], v[188:191], v[68:71]
    ds_read_b64 v[98:99], v38 offset:840
    v_mfma_f32_16x16x32_bf16 v[52:55], v[116:119], v[168:171], v[52:55]
    ds_read_b128 v[164:167], v39 offset:3904
    v_mfma_f32_16x16x32_bf16 v[56:59], v[116:119], v[172:175], v[56:59]
    ds_read_b64 v[100:101], v38 offset:320
    v_mfma_f32_16x16x32_bf16 v[60:63], v[116:119], v[176:179], v[60:63]
    ds_read_b64 v[102:103], v38 offset:328
    v_mfma_f32_16x16x32_bf16 v[64:67], v[116:119], v[180:183], v[64:67]
    v_mfma_f32_16x16x32_bf16 v[68:71], v[116:119], v[184:187], v[68:71]
    v_mfma_f32_16x16x32_bf16 v[56:59], v[120:123], v[168:171], v[56:59]
    v_mfma_f32_16x16x32_bf16 v[60:63], v[120:123], v[172:175], v[60:63]
    v_mfma_f32_16x16x32_bf16 v[64:67], v[120:123], v[176:179], v[64:67]
    v_mfma_f32_16x16x32_bf16 v[68:71], v[120:123], v[180:183], v[68:71]
    v_mfma_f32_16x16x32_bf16 v[60:63], v[124:127], v[168:171], v[60:63]
    v_mfma_f32_16x16x32_bf16 v[64:67], v[124:127], v[172:175], v[64:67]
    v_mfma_f32_16x16x32_bf16 v[68:71], v[124:127], v[176:179], v[68:71]
    v_mfma_f32_16x16x32_bf16 v[64:67], v[128:131], v[168:171], v[64:67]
    v_mfma_f32_16x16x32_bf16 v[68:71], v[128:131], v[172:175], v[68:71]
    v_mfma_f32_16x16x32_bf16 v[68:71], v[132:135], v[168:171], v[68:71]
    s_waitcnt lgkmcnt(0)
    v_mfma_f32_16x16x32_bf16 v[40:43], v[72:75], v[136:139], v[40:43]
    ds_read_b128 v[168:171], v39 offset:256
    v_mfma_f32_16x16x32_bf16 v[44:47], v[72:75], v[140:143], v[44:47]
    ds_read_b64 v[104:105], v38 offset:3840
    v_mfma_f32_16x16x32_bf16 v[48:51], v[72:75], v[144:147], v[48:51]
    ds_read_b64 v[106:107], v38 offset:3848
    v_mfma_f32_16x16x32_bf16 v[52:55], v[72:75], v[148:151], v[52:55]
    ds_read_b128 v[172:175], v39 offset:768
    v_mfma_f32_16x16x32_bf16 v[56:59], v[72:75], v[152:155], v[56:59]
    ds_read_b64 v[108:109], v38 offset:3328
    v_mfma_f32_16x16x32_bf16 v[60:63], v[72:75], v[156:159], v[60:63]
    ds_read_b64 v[110:111], v38 offset:3336
    v_mfma_f32_16x16x32_bf16 v[64:67], v[72:75], v[160:163], v[64:67]
    ds_read_b128 v[176:179], v39 offset:1280
    v_mfma_f32_16x16x32_bf16 v[68:71], v[72:75], v[164:167], v[68:71]
    ds_read_b64 v[112:113], v38 offset:2816
    v_mfma_f32_16x16x32_bf16 v[44:47], v[76:79], v[136:139], v[44:47]
    ds_read_b64 v[114:115], v38 offset:2824
    v_mfma_f32_16x16x32_bf16 v[48:51], v[76:79], v[140:143], v[48:51]
    ds_read_b128 v[180:183], v39 offset:1792
    v_mfma_f32_16x16x32_bf16 v[52:55], v[76:79], v[144:147], v[52:55]
    ds_read_b64 v[116:117], v38 offset:2304
    v_mfma_f32_16x16x32_bf16 v[56:59], v[76:79], v[148:151], v[56:59]
    ds_read_b64 v[118:119], v38 offset:2312
    v_mfma_f32_16x16x32_bf16 v[60:63], v[76:79], v[152:155], v[60:63]
    ds_read_b128 v[184:187], v39 offset:2304
    v_mfma_f32_16x16x32_bf16 v[64:67], v[76:79], v[156:159], v[64:67]
    ds_read_b64 v[120:121], v38 offset:1792
    v_mfma_f32_16x16x32_bf16 v[68:71], v[76:79], v[160:163], v[68:71]
    ds_read_b64 v[122:123], v38 offset:1800
    v_mfma_f32_16x16x32_bf16 v[48:51], v[80:83], v[136:139], v[48:51]
    ds_read_b128 v[188:191], v39 offset:2816
    v_mfma_f32_16x16x32_bf16 v[52:55], v[80:83], v[140:143], v[52:55]
    ds_read_b64 v[124:125], v38 offset:1280
    v_mfma_f32_16x16x32_bf16 v[56:59], v[80:83], v[144:147], v[56:59]
    ds_read_b64 v[126:127], v38 offset:1288
    v_mfma_f32_16x16x32_bf16 v[60:63], v[80:83], v[148:151], v[60:63]
    ds_read_b128 v[192:195], v39 offset:3328
    v_mfma_f32_16x16x32_bf16 v[64:67], v[80:83], v[152:155], v[64:67]
    ds_read_b64 v[128:129], v38 offset:768
    v_mfma_f32_16x16x32_bf16 v[68:71], v[80:83], v[156:159], v[68:71]
    ds_read_b64 v[130:131], v38 offset:776
    v_mfma_f32_16x16x32_bf16 v[52:55], v[84:87], v[136:139], v[52:55]
    ds_read_b128 v[196:199], v39 offset:3840
    v_mfma_f32_16x16x32_bf16 v[56:59], v[84:87], v[140:143], v[56:59]
    ds_read_b64 v[132:133], v38 offset:256
    v_mfma_f32_16x16x32_bf16 v[60:63], v[84:87], v[144:147], v[60:63]
    ds_read_b64 v[134:135], v38 offset:264
    v_mfma_f32_16x16x32_bf16 v[64:67], v[84:87], v[148:151], v[64:67]
    v_mfma_f32_16x16x32_bf16 v[68:71], v[84:87], v[152:155], v[68:71]
    v_mfma_f32_16x16x32_bf16 v[56:59], v[88:91], v[136:139], v[56:59]
    v_mfma_f32_16x16x32_bf16 v[60:63], v[88:91], v[140:143], v[60:63]
    v_mfma_f32_16x16x32_bf16 v[64:67], v[88:91], v[144:147], v[64:67]
    v_mfma_f32_16x16x32_bf16 v[68:71], v[88:91], v[148:151], v[68:71]
    v_mfma_f32_16x16x32_bf16 v[60:63], v[92:95], v[136:139], v[60:63]
    v_mfma_f32_16x16x32_bf16 v[64:67], v[92:95], v[140:143], v[64:67]
    v_mfma_f32_16x16x32_bf16 v[68:71], v[92:95], v[144:147], v[68:71]
    v_mfma_f32_16x16x32_bf16 v[64:67], v[96:99], v[136:139], v[64:67]
    v_mfma_f32_16x16x32_bf16 v[68:71], v[96:99], v[140:143], v[68:71]
    v_mfma_f32_16x16x32_bf16 v[68:71], v[100:103], v[136:139], v[68:71]
    s_waitcnt lgkmcnt(0)
    v_mfma_f32_16x16x32_bf16 v[40:43], v[104:107], v[168:171], v[40:43]
    ds_read_b128 v[136:139], v39 offset:192
    v_mfma_f32_16x16x32_bf16 v[44:47], v[104:107], v[172:175], v[44:47]
    ds_read_b64 v[72:73], v38 offset:3776
    v_mfma_f32_16x16x32_bf16 v[48:51], v[104:107], v[176:179], v[48:51]
    ds_read_b64 v[74:75], v38 offset:3784
    v_mfma_f32_16x16x32_bf16 v[52:55], v[104:107], v[180:183], v[52:55]
    ds_read_b128 v[140:143], v39 offset:704
    v_mfma_f32_16x16x32_bf16 v[56:59], v[104:107], v[184:187], v[56:59]
    ds_read_b64 v[76:77], v38 offset:3264
    v_mfma_f32_16x16x32_bf16 v[60:63], v[104:107], v[188:191], v[60:63]
    ds_read_b64 v[78:79], v38 offset:3272
    v_mfma_f32_16x16x32_bf16 v[64:67], v[104:107], v[192:195], v[64:67]
    ds_read_b128 v[144:147], v39 offset:1216
    v_mfma_f32_16x16x32_bf16 v[68:71], v[104:107], v[196:199], v[68:71]
    ds_read_b64 v[80:81], v38 offset:2752
    v_mfma_f32_16x16x32_bf16 v[44:47], v[108:111], v[168:171], v[44:47]
    ds_read_b64 v[82:83], v38 offset:2760
    v_mfma_f32_16x16x32_bf16 v[48:51], v[108:111], v[172:175], v[48:51]
    ds_read_b128 v[148:151], v39 offset:1728
    v_mfma_f32_16x16x32_bf16 v[52:55], v[108:111], v[176:179], v[52:55]
    ds_read_b64 v[84:85], v38 offset:2240
    v_mfma_f32_16x16x32_bf16 v[56:59], v[108:111], v[180:183], v[56:59]
    ds_read_b64 v[86:87], v38 offset:2248
    v_mfma_f32_16x16x32_bf16 v[60:63], v[108:111], v[184:187], v[60:63]
    ds_read_b128 v[152:155], v39 offset:2240
    v_mfma_f32_16x16x32_bf16 v[64:67], v[108:111], v[188:191], v[64:67]
    ds_read_b64 v[88:89], v38 offset:1728
    v_mfma_f32_16x16x32_bf16 v[68:71], v[108:111], v[192:195], v[68:71]
    ds_read_b64 v[90:91], v38 offset:1736
    v_mfma_f32_16x16x32_bf16 v[48:51], v[112:115], v[168:171], v[48:51]
    ds_read_b128 v[156:159], v39 offset:2752
    v_mfma_f32_16x16x32_bf16 v[52:55], v[112:115], v[172:175], v[52:55]
    ds_read_b64 v[92:93], v38 offset:1216
    v_mfma_f32_16x16x32_bf16 v[56:59], v[112:115], v[176:179], v[56:59]
    ds_read_b64 v[94:95], v38 offset:1224
    v_mfma_f32_16x16x32_bf16 v[60:63], v[112:115], v[180:183], v[60:63]
    ds_read_b128 v[160:163], v39 offset:3264
    v_mfma_f32_16x16x32_bf16 v[64:67], v[112:115], v[184:187], v[64:67]
    ds_read_b64 v[96:97], v38 offset:704
    v_mfma_f32_16x16x32_bf16 v[68:71], v[112:115], v[188:191], v[68:71]
    ds_read_b64 v[98:99], v38 offset:712
    v_mfma_f32_16x16x32_bf16 v[52:55], v[116:119], v[168:171], v[52:55]
    ds_read_b128 v[164:167], v39 offset:3776
    v_mfma_f32_16x16x32_bf16 v[56:59], v[116:119], v[172:175], v[56:59]
    ds_read_b64 v[100:101], v38 offset:192
    v_mfma_f32_16x16x32_bf16 v[60:63], v[116:119], v[176:179], v[60:63]
    ds_read_b64 v[102:103], v38 offset:200
    v_mfma_f32_16x16x32_bf16 v[64:67], v[116:119], v[180:183], v[64:67]
    v_mfma_f32_16x16x32_bf16 v[68:71], v[116:119], v[184:187], v[68:71]
    v_mfma_f32_16x16x32_bf16 v[56:59], v[120:123], v[168:171], v[56:59]
    v_mfma_f32_16x16x32_bf16 v[60:63], v[120:123], v[172:175], v[60:63]
    v_mfma_f32_16x16x32_bf16 v[64:67], v[120:123], v[176:179], v[64:67]
    v_mfma_f32_16x16x32_bf16 v[68:71], v[120:123], v[180:183], v[68:71]
    v_mfma_f32_16x16x32_bf16 v[60:63], v[124:127], v[168:171], v[60:63]
    v_mfma_f32_16x16x32_bf16 v[64:67], v[124:127], v[172:175], v[64:67]
    v_mfma_f32_16x16x32_bf16 v[68:71], v[124:127], v[176:179], v[68:71]
    v_mfma_f32_16x16x32_bf16 v[64:67], v[128:131], v[168:171], v[64:67]
    v_mfma_f32_16x16x32_bf16 v[68:71], v[128:131], v[172:175], v[68:71]
    v_mfma_f32_16x16x32_bf16 v[68:71], v[132:135], v[168:171], v[68:71]
    s_waitcnt lgkmcnt(0)
    v_mfma_f32_16x16x32_bf16 v[40:43], v[72:75], v[136:139], v[40:43]
    ds_read_b128 v[168:171], v39 offset:128
    v_mfma_f32_16x16x32_bf16 v[44:47], v[72:75], v[140:143], v[44:47]
    ds_read_b64 v[104:105], v38 offset:3712
    v_mfma_f32_16x16x32_bf16 v[48:51], v[72:75], v[144:147], v[48:51]
    ds_read_b64 v[106:107], v38 offset:3720
    v_mfma_f32_16x16x32_bf16 v[52:55], v[72:75], v[148:151], v[52:55]
    ds_read_b128 v[172:175], v39 offset:640
    v_mfma_f32_16x16x32_bf16 v[56:59], v[72:75], v[152:155], v[56:59]
    ds_read_b64 v[108:109], v38 offset:3200
    v_mfma_f32_16x16x32_bf16 v[60:63], v[72:75], v[156:159], v[60:63]
    ds_read_b64 v[110:111], v38 offset:3208
    v_mfma_f32_16x16x32_bf16 v[64:67], v[72:75], v[160:163], v[64:67]
    ds_read_b128 v[176:179], v39 offset:1152
    v_mfma_f32_16x16x32_bf16 v[68:71], v[72:75], v[164:167], v[68:71]
    ds_read_b64 v[112:113], v38 offset:2688
    v_mfma_f32_16x16x32_bf16 v[44:47], v[76:79], v[136:139], v[44:47]
    ds_read_b64 v[114:115], v38 offset:2696
    v_mfma_f32_16x16x32_bf16 v[48:51], v[76:79], v[140:143], v[48:51]
    ds_read_b128 v[180:183], v39 offset:1664
    v_mfma_f32_16x16x32_bf16 v[52:55], v[76:79], v[144:147], v[52:55]
    ds_read_b64 v[116:117], v38 offset:2176
    v_mfma_f32_16x16x32_bf16 v[56:59], v[76:79], v[148:151], v[56:59]
    ds_read_b64 v[118:119], v38 offset:2184
    v_mfma_f32_16x16x32_bf16 v[60:63], v[76:79], v[152:155], v[60:63]
    ds_read_b128 v[184:187], v39 offset:2176
    v_mfma_f32_16x16x32_bf16 v[64:67], v[76:79], v[156:159], v[64:67]
    ds_read_b64 v[120:121], v38 offset:1664
    v_mfma_f32_16x16x32_bf16 v[68:71], v[76:79], v[160:163], v[68:71]
    ds_read_b64 v[122:123], v38 offset:1672
    v_mfma_f32_16x16x32_bf16 v[48:51], v[80:83], v[136:139], v[48:51]
    ds_read_b128 v[188:191], v39 offset:2688
    v_mfma_f32_16x16x32_bf16 v[52:55], v[80:83], v[140:143], v[52:55]
    ds_read_b64 v[124:125], v38 offset:1152
    v_mfma_f32_16x16x32_bf16 v[56:59], v[80:83], v[144:147], v[56:59]
    ds_read_b64 v[126:127], v38 offset:1160
    v_mfma_f32_16x16x32_bf16 v[60:63], v[80:83], v[148:151], v[60:63]
    ds_read_b128 v[192:195], v39 offset:3200
    v_mfma_f32_16x16x32_bf16 v[64:67], v[80:83], v[152:155], v[64:67]
    ds_read_b64 v[128:129], v38 offset:640
    v_mfma_f32_16x16x32_bf16 v[68:71], v[80:83], v[156:159], v[68:71]
    ds_read_b64 v[130:131], v38 offset:648
    v_mfma_f32_16x16x32_bf16 v[52:55], v[84:87], v[136:139], v[52:55]
    ds_read_b128 v[196:199], v39 offset:3712
    v_mfma_f32_16x16x32_bf16 v[56:59], v[84:87], v[140:143], v[56:59]
    ds_read_b64 v[132:133], v38 offset:128
    v_mfma_f32_16x16x32_bf16 v[60:63], v[84:87], v[144:147], v[60:63]
    ds_read_b64 v[134:135], v38 offset:136
    v_mfma_f32_16x16x32_bf16 v[64:67], v[84:87], v[148:151], v[64:67]
    v_mfma_f32_16x16x32_bf16 v[68:71], v[84:87], v[152:155], v[68:71]
    v_mfma_f32_16x16x32_bf16 v[56:59], v[88:91], v[136:139], v[56:59]
    v_mfma_f32_16x16x32_bf16 v[60:63], v[88:91], v[140:143], v[60:63]
    v_mfma_f32_16x16x32_bf16 v[64:67], v[88:91], v[144:147], v[64:67]
    v_mfma_f32_16x16x32_bf16 v[68:71], v[88:91], v[148:151], v[68:71]
    v_mfma_f32_16x16x32_bf16 v[60:63], v[92:95], v[136:139], v[60:63]
    v_mfma_f32_16x16x32_bf16 v[64:67], v[92:95], v[140:143], v[64:67]
    v_mfma_f32_16x16x32_bf16 v[68:71], v[92:95], v[144:147], v[68:71]
    v_mfma_f32_16x16x32_bf16 v[64:67], v[96:99], v[136:139], v[64:67]
    v_mfma_f32_16x16x32_bf16 v[68:71], v[96:99], v[140:143], v[68:71]
    v_mfma_f32_16x16x32_bf16 v[68:71], v[100:103], v[136:139], v[68:71]
    s_waitcnt lgkmcnt(0)
    v_mfma_f32_16x16x32_bf16 v[40:43], v[104:107], v[168:171], v[40:43]
    ds_read_b128 v[136:139], v39 offset:64
    v_mfma_f32_16x16x32_bf16 v[44:47], v[104:107], v[172:175], v[44:47]
    ds_read_b64 v[72:73], v38 offset:3648
    v_mfma_f32_16x16x32_bf16 v[48:51], v[104:107], v[176:179], v[48:51]
    ds_read_b64 v[74:75], v38 offset:3656
    v_mfma_f32_16x16x32_bf16 v[52:55], v[104:107], v[180:183], v[52:55]
    ds_read_b128 v[140:143], v39 offset:576
    v_mfma_f32_16x16x32_bf16 v[56:59], v[104:107], v[184:187], v[56:59]
    ds_read_b64 v[76:77], v38 offset:3136
    v_mfma_f32_16x16x32_bf16 v[60:63], v[104:107], v[188:191], v[60:63]
    ds_read_b64 v[78:79], v38 offset:3144
    v_mfma_f32_16x16x32_bf16 v[64:67], v[104:107], v[192:195], v[64:67]
    ds_read_b128 v[144:147], v39 offset:1088
    v_mfma_f32_16x16x32_bf16 v[68:71], v[104:107], v[196:199], v[68:71]
    ds_read_b64 v[80:81], v38 offset:2624
    v_mfma_f32_16x16x32_bf16 v[44:47], v[108:111], v[168:171], v[44:47]
    ds_read_b64 v[82:83], v38 offset:2632
    v_mfma_f32_16x16x32_bf16 v[48:51], v[108:111], v[172:175], v[48:51]
    ds_read_b128 v[148:151], v39 offset:1600
    v_mfma_f32_16x16x32_bf16 v[52:55], v[108:111], v[176:179], v[52:55]
    ds_read_b64 v[84:85], v38 offset:2112
    v_mfma_f32_16x16x32_bf16 v[56:59], v[108:111], v[180:183], v[56:59]
    ds_read_b64 v[86:87], v38 offset:2120
    v_mfma_f32_16x16x32_bf16 v[60:63], v[108:111], v[184:187], v[60:63]
    ds_read_b128 v[152:155], v39 offset:2112
    v_mfma_f32_16x16x32_bf16 v[64:67], v[108:111], v[188:191], v[64:67]
    ds_read_b64 v[88:89], v38 offset:1600
    v_mfma_f32_16x16x32_bf16 v[68:71], v[108:111], v[192:195], v[68:71]
    ds_read_b64 v[90:91], v38 offset:1608
    v_mfma_f32_16x16x32_bf16 v[48:51], v[112:115], v[168:171], v[48:51]
    ds_read_b128 v[156:159], v39 offset:2624
    v_mfma_f32_16x16x32_bf16 v[52:55], v[112:115], v[172:175], v[52:55]
    ds_read_b64 v[92:93], v38 offset:1088
    v_mfma_f32_16x16x32_bf16 v[56:59], v[112:115], v[176:179], v[56:59]
    ds_read_b64 v[94:95], v38 offset:1096
    v_mfma_f32_16x16x32_bf16 v[60:63], v[112:115], v[180:183], v[60:63]
    ds_read_b128 v[160:163], v39 offset:3136
    v_mfma_f32_16x16x32_bf16 v[64:67], v[112:115], v[184:187], v[64:67]
    ds_read_b64 v[96:97], v38 offset:576
    v_mfma_f32_16x16x32_bf16 v[68:71], v[112:115], v[188:191], v[68:71]
    ds_read_b64 v[98:99], v38 offset:584
    v_mfma_f32_16x16x32_bf16 v[52:55], v[116:119], v[168:171], v[52:55]
    ds_read_b128 v[164:167], v39 offset:3648
    v_mfma_f32_16x16x32_bf16 v[56:59], v[116:119], v[172:175], v[56:59]
    ds_read_b64 v[100:101], v38 offset:64
    v_mfma_f32_16x16x32_bf16 v[60:63], v[116:119], v[176:179], v[60:63]
    ds_read_b64 v[102:103], v38 offset:72
    v_mfma_f32_16x16x32_bf16 v[64:67], v[116:119], v[180:183], v[64:67]
    v_mfma_f32_16x16x32_bf16 v[68:71], v[116:119], v[184:187], v[68:71]
    v_mfma_f32_16x16x32_bf16 v[56:59], v[120:123], v[168:171], v[56:59]
    v_mfma_f32_16x16x32_bf16 v[60:63], v[120:123], v[172:175], v[60:63]
    v_mfma_f32_16x16x32_bf16 v[64:67], v[120:123], v[176:179], v[64:67]
    v_mfma_f32_16x16x32_bf16 v[68:71], v[120:123], v[180:183], v[68:71]
    v_mfma_f32_16x16x32_bf16 v[60:63], v[124:127], v[168:171], v[60:63]
    v_mfma_f32_16x16x32_bf16 v[64:67], v[124:127], v[172:175], v[64:67]
    v_mfma_f32_16x16x32_bf16 v[68:71], v[124:127], v[176:179], v[68:71]
    v_mfma_f32_16x16x32_bf16 v[64:67], v[128:131], v[168:171], v[64:67]
    v_mfma_f32_16x16x32_bf16 v[68:71], v[128:131], v[172:175], v[68:71]
    v_mfma_f32_16x16x32_bf16 v[68:71], v[132:135], v[168:171], v[68:71]
    s_waitcnt lgkmcnt(0)
    v_mfma_f32_16x16x32_bf16 v[40:43], v[72:75], v[136:139], v[40:43]
    ds_read_b128 v[168:171], v39 offset:0
    v_mfma_f32_16x16x32_bf16 v[44:47], v[72:75], v[140:143], v[44:47]
    ds_read_b64 v[104:105], v38 offset:3584
    v_mfma_f32_16x16x32_bf16 v[48:51], v[72:75], v[144:147], v[48:51]
    ds_read_b64 v[106:107], v38 offset:3592
    v_mfma_f32_16x16x32_bf16 v[52:55], v[72:75], v[148:151], v[52:55]
    ds_read_b128 v[172:175], v39 offset:512
    v_mfma_f32_16x16x32_bf16 v[56:59], v[72:75], v[152:155], v[56:59]
    ds_read_b64 v[108:109], v38 offset:3072
    v_mfma_f32_16x16x32_bf16 v[60:63], v[72:75], v[156:159], v[60:63]
    ds_read_b64 v[110:111], v38 offset:3080
    v_mfma_f32_16x16x32_bf16 v[64:67], v[72:75], v[160:163], v[64:67]
    ds_read_b128 v[176:179], v39 offset:1024
    v_mfma_f32_16x16x32_bf16 v[68:71], v[72:75], v[164:167], v[68:71]
    ds_read_b64 v[112:113], v38 offset:2560
    v_mfma_f32_16x16x32_bf16 v[44:47], v[76:79], v[136:139], v[44:47]
    ds_read_b64 v[114:115], v38 offset:2568
    v_mfma_f32_16x16x32_bf16 v[48:51], v[76:79], v[140:143], v[48:51]
    ds_read_b128 v[180:183], v39 offset:1536
    v_mfma_f32_16x16x32_bf16 v[52:55], v[76:79], v[144:147], v[52:55]
    ds_read_b64 v[116:117], v38 offset:2048
    v_mfma_f32_16x16x32_bf16 v[56:59], v[76:79], v[148:151], v[56:59]
    ds_read_b64 v[118:119], v38 offset:2056
    v_mfma_f32_16x16x32_bf16 v[60:63], v[76:79], v[152:155], v[60:63]
    ds_read_b128 v[184:187], v39 offset:2048
    v_mfma_f32_16x16x32_bf16 v[64:67], v[76:79], v[156:159], v[64:67]
    ds_read_b64 v[120:121], v38 offset:1536
    v_mfma_f32_16x16x32_bf16 v[68:71], v[76:79], v[160:163], v[68:71]
    ds_read_b64 v[122:123], v38 offset:1544
    v_mfma_f32_16x16x32_bf16 v[48:51], v[80:83], v[136:139], v[48:51]
    ds_read_b128 v[188:191], v39 offset:2560
    v_mfma_f32_16x16x32_bf16 v[52:55], v[80:83], v[140:143], v[52:55]
    ds_read_b64 v[124:125], v38 offset:1024
    v_mfma_f32_16x16x32_bf16 v[56:59], v[80:83], v[144:147], v[56:59]
    ds_read_b64 v[126:127], v38 offset:1032
    v_mfma_f32_16x16x32_bf16 v[60:63], v[80:83], v[148:151], v[60:63]
    ds_read_b128 v[192:195], v39 offset:3072
    v_mfma_f32_16x16x32_bf16 v[64:67], v[80:83], v[152:155], v[64:67]
    ds_read_b64 v[128:129], v38 offset:512
    v_mfma_f32_16x16x32_bf16 v[68:71], v[80:83], v[156:159], v[68:71]
    ds_read_b64 v[130:131], v38 offset:520
    v_mfma_f32_16x16x32_bf16 v[52:55], v[84:87], v[136:139], v[52:55]
    ds_read_b128 v[196:199], v39 offset:3584
    v_mfma_f32_16x16x32_bf16 v[56:59], v[84:87], v[140:143], v[56:59]
    ds_read_b64 v[132:133], v38 offset:0
    v_mfma_f32_16x16x32_bf16 v[60:63], v[84:87], v[144:147], v[60:63]
    ds_read_b64 v[134:135], v38 offset:8
    v_mfma_f32_16x16x32_bf16 v[64:67], v[84:87], v[148:151], v[64:67]
    v_mfma_f32_16x16x32_bf16 v[68:71], v[84:87], v[152:155], v[68:71]
    v_mfma_f32_16x16x32_bf16 v[56:59], v[88:91], v[136:139], v[56:59]
    v_mfma_f32_16x16x32_bf16 v[60:63], v[88:91], v[140:143], v[60:63]
    v_mfma_f32_16x16x32_bf16 v[64:67], v[88:91], v[144:147], v[64:67]
    v_mfma_f32_16x16x32_bf16 v[68:71], v[88:91], v[148:151], v[68:71]
    v_mfma_f32_16x16x32_bf16 v[60:63], v[92:95], v[136:139], v[60:63]
    v_mfma_f32_16x16x32_bf16 v[64:67], v[92:95], v[140:143], v[64:67]
    v_mfma_f32_16x16x32_bf16 v[68:71], v[92:95], v[144:147], v[68:71]
    v_mfma_f32_16x16x32_bf16 v[64:67], v[96:99], v[136:139], v[64:67]
    v_mfma_f32_16x16x32_bf16 v[68:71], v[96:99], v[140:143], v[68:71]
    v_mfma_f32_16x16x32_bf16 v[68:71], v[100:103], v[136:139], v[68:71]
    s_waitcnt lgkmcnt(0)
    v_mfma_f32_16x16x32_bf16 v[40:43], v[104:107], v[168:171], v[40:43]
    v_mfma_f32_16x16x32_bf16 v[44:47], v[104:107], v[172:175], v[44:47]
    v_mfma_f32_16x16x32_bf16 v[48:51], v[104:107], v[176:179], v[48:51]
    v_mfma_f32_16x16x32_bf16 v[52:55], v[104:107], v[180:183], v[52:55]
    v_mfma_f32_16x16x32_bf16 v[56:59], v[104:107], v[184:187], v[56:59]
    v_mfma_f32_16x16x32_bf16 v[60:63], v[104:107], v[188:191], v[60:63]
    v_mfma_f32_16x16x32_bf16 v[64:67], v[104:107], v[192:195], v[64:67]
    v_mfma_f32_16x16x32_bf16 v[68:71], v[104:107], v[196:199], v[68:71]
    v_mfma_f32_16x16x32_bf16 v[44:47], v[108:111], v[168:171], v[44:47]
    v_mfma_f32_16x16x32_bf16 v[48:51], v[108:111], v[172:175], v[48:51]
    v_mfma_f32_16x16x32_bf16 v[52:55], v[108:111], v[176:179], v[52:55]
    v_mfma_f32_16x16x32_bf16 v[56:59], v[108:111], v[180:183], v[56:59]
    v_mfma_f32_16x16x32_bf16 v[60:63], v[108:111], v[184:187], v[60:63]
    v_mfma_f32_16x16x32_bf16 v[64:67], v[108:111], v[188:191], v[64:67]
    v_mfma_f32_16x16x32_bf16 v[68:71], v[108:111], v[192:195], v[68:71]
    v_mfma_f32_16x16x32_bf16 v[48:51], v[112:115], v[168:171], v[48:51]
    v_mfma_f32_16x16x32_bf16 v[52:55], v[112:115], v[172:175], v[52:55]
    v_mfma_f32_16x16x32_bf16 v[56:59], v[112:115], v[176:179], v[56:59]
    v_mfma_f32_16x16x32_bf16 v[60:63], v[112:115], v[180:183], v[60:63]
    v_mfma_f32_16x16x32_bf16 v[64:67], v[112:115], v[184:187], v[64:67]
    v_mfma_f32_16x16x32_bf16 v[68:71], v[112:115], v[188:191], v[68:71]
    v_mfma_f32_16x16x32_bf16 v[52:55], v[116:119], v[168:171], v[52:55]
    v_mfma_f32_16x16x32_bf16 v[56:59], v[116:119], v[172:175], v[56:59]
    v_mfma_f32_16x16x32_bf16 v[60:63], v[116:119], v[176:179], v[60:63]
    v_mfma_f32_16x16x32_bf16 v[64:67], v[116:119], v[180:183], v[64:67]
    v_mfma_f32_16x16x32_bf16 v[68:71], v[116:119], v[184:187], v[68:71]
    v_mfma_f32_16x16x32_bf16 v[56:59], v[120:123], v[168:171], v[56:59]
    v_mfma_f32_16x16x32_bf16 v[60:63], v[120:123], v[172:175], v[60:63]
    v_mfma_f32_16x16x32_bf16 v[64:67], v[120:123], v[176:179], v[64:67]
    v_mfma_f32_16x16x32_bf16 v[68:71], v[120:123], v[180:183], v[68:71]
    v_mfma_f32_16x16x32_bf16 v[60:63], v[124:127], v[168:171], v[60:63]
    v_mfma_f32_16x16x32_bf16 v[64:67], v[124:127], v[172:175], v[64:67]
    v_mfma_f32_16x16x32_bf16 v[68:71], v[124:127], v[176:179], v[68:71]
    v_mfma_f32_16x16x32_bf16 v[64:67], v[128:131], v[168:171], v[64:67]
    v_mfma_f32_16x16x32_bf16 v[68:71], v[128:131], v[172:175], v[68:71]
    v_mfma_f32_16x16x32_bf16 v[68:71], v[132:135], v[168:171], v[68:71]
    s_add_u32 s32, s26, 10698752
    s_addc_u32 s33, s27, 0
    s_and_b32 s33, s33, 0xffff
    s_mov_b32 s34, 2621440
    s_mov_b32 s35, 0x00020000
    v_lshlrev_b32 v2, 5, v36
    v_lshlrev_b32 v3, 3, v37
    v_add_u32 v201, v2, v3
    v_add_u32 v200, s57, v201
    ds_read_b64 v[72:73], v200 offset:17152
    ds_read_b64 v[74:75], v200 offset:17664
    ds_read_b64 v[76:77], v200 offset:18176
    ds_read_b64 v[78:79], v200 offset:18688
    ds_read_b64 v[80:81], v200 offset:19200
    ds_read_b64 v[82:83], v200 offset:19712
    ds_read_b64 v[84:85], v200 offset:20224
    ds_read_b64 v[86:87], v200 offset:20736
    s_nop 4
    s_waitcnt lgkmcnt(0)
    v_lshlrev_b32 v2, 16, v72
    v_and_b32 v3, 0xffff0000, v72
    v_lshlrev_b32 v4, 16, v73
    v_and_b32 v5, 0xffff0000, v73
    v_fma_f32 v40, v2, v16, v40
    v_fma_f32 v41, v3, v16, v41
    v_fma_f32 v42, v4, v16, v42
    v_fma_f32 v43, v5, v16, v43
    v_cvt_pk_bf16_f32 v136, v40, v41
    v_cvt_pk_bf16_f32 v137, v42, v43
    buffer_store_dwordx2 v[136:137], v201, s[32:35], s20 offen offset:0 sc1
    v_lshlrev_b32 v2, 16, v74
    v_and_b32 v3, 0xffff0000, v74
    v_lshlrev_b32 v4, 16, v75
    v_and_b32 v5, 0xffff0000, v75
    v_fma_f32 v44, v2, v16, v44
    v_fma_f32 v45, v3, v16, v45
    v_fma_f32 v46, v4, v16, v46
    v_fma_f32 v47, v5, v16, v47
    v_cvt_pk_bf16_f32 v138, v44, v45
    v_cvt_pk_bf16_f32 v139, v46, v47
    buffer_store_dwordx2 v[138:139], v201, s[32:35], s20 offen offset:512 sc1
    v_lshlrev_b32 v2, 16, v76
    v_and_b32 v3, 0xffff0000, v76
    v_lshlrev_b32 v4, 16, v77
    v_and_b32 v5, 0xffff0000, v77
    v_fma_f32 v48, v2, v16, v48
    v_fma_f32 v49, v3, v16, v49
    v_fma_f32 v50, v4, v16, v50
    v_fma_f32 v51, v5, v16, v51
    v_cvt_pk_bf16_f32 v140, v48, v49
    v_cvt_pk_bf16_f32 v141, v50, v51
    buffer_store_dwordx2 v[140:141], v201, s[32:35], s20 offen offset:1024 sc1
    v_lshlrev_b32 v2, 16, v78
    v_and_b32 v3, 0xffff0000, v78
    v_lshlrev_b32 v4, 16, v79
    v_and_b32 v5, 0xffff0000, v79
    v_fma_f32 v52, v2, v16, v52
    v_fma_f32 v53, v3, v16, v53
    v_fma_f32 v54, v4, v16, v54
    v_fma_f32 v55, v5, v16, v55
    v_cvt_pk_bf16_f32 v142, v52, v53
    v_cvt_pk_bf16_f32 v143, v54, v55
    buffer_store_dwordx2 v[142:143], v201, s[32:35], s20 offen offset:1536 sc1
    v_lshlrev_b32 v2, 16, v80
    v_and_b32 v3, 0xffff0000, v80
    v_lshlrev_b32 v4, 16, v81
    v_and_b32 v5, 0xffff0000, v81
    v_fma_f32 v56, v2, v16, v56
    v_fma_f32 v57, v3, v16, v57
    v_fma_f32 v58, v4, v16, v58
    v_fma_f32 v59, v5, v16, v59
    v_cvt_pk_bf16_f32 v144, v56, v57
    v_cvt_pk_bf16_f32 v145, v58, v59
    buffer_store_dwordx2 v[144:145], v201, s[32:35], s20 offen offset:2048 sc1
    v_lshlrev_b32 v2, 16, v82
    v_and_b32 v3, 0xffff0000, v82
    v_lshlrev_b32 v4, 16, v83
    v_and_b32 v5, 0xffff0000, v83
    v_fma_f32 v60, v2, v16, v60
    v_fma_f32 v61, v3, v16, v61
    v_fma_f32 v62, v4, v16, v62
    v_fma_f32 v63, v5, v16, v63
    v_cvt_pk_bf16_f32 v146, v60, v61
    v_cvt_pk_bf16_f32 v147, v62, v63
    buffer_store_dwordx2 v[146:147], v201, s[32:35], s20 offen offset:2560 sc1
    v_lshlrev_b32 v2, 16, v84
    v_and_b32 v3, 0xffff0000, v84
    v_lshlrev_b32 v4, 16, v85
    v_and_b32 v5, 0xffff0000, v85
    v_fma_f32 v64, v2, v16, v64
    v_fma_f32 v65, v3, v16, v65
    v_fma_f32 v66, v4, v16, v66
    v_fma_f32 v67, v5, v16, v67
    v_cvt_pk_bf16_f32 v148, v64, v65
    v_cvt_pk_bf16_f32 v149, v66, v67
    buffer_store_dwordx2 v[148:149], v201, s[32:35], s20 offen offset:3072 sc1
    v_lshlrev_b32 v2, 16, v86
    v_and_b32 v3, 0xffff0000, v86
    v_lshlrev_b32 v4, 16, v87
    v_and_b32 v5, 0xffff0000, v87
    v_fma_f32 v68, v2, v16, v68
    v_fma_f32 v69, v3, v16, v69
    v_fma_f32 v70, v4, v16, v70
    v_fma_f32 v71, v5, v16, v71
    v_cvt_pk_bf16_f32 v150, v68, v69
    v_cvt_pk_bf16_f32 v151, v70, v71
    buffer_store_dwordx2 v[150:151], v201, s[32:35], s20 offen offset:3584 sc1
    s_mul_i32 s55, s53, 205
    s_lshr_b32 s55, s55, 14
    s_mul_i32 s55, s55, 64
    s_lshl_b32 s56, s53, 2
    s_add_u32 s55, s55, s56
    s_add_u32 s55, s55, 9216
    v_mov_b32 v6, s55
    v_mov_b32 v7, s62
    v_cmp_eq_u32 vcc, 0, v1
    s_waitcnt vmcnt(0)
    s_and_saveexec_b64 s[58:59], vcc
    buffer_store_dword v7, v6, s[44:47], 0 offen sc1
    s_mov_b64 exec, s[58:59]
aexit_1:
    s_endpgm
L_B:
    s_load_dwordx4 s[4:7], s[0:1], 80
    s_load_dwordx4 s[8:11], s[0:1], 64
    s_load_dwordx2 s[22:23], s[0:1], 0
    s_load_dwordx4 s[12:15], s[0:1], 96
    s_load_dwordx4 s[16:19], s[0:1], 112
    s_load_dwordx2 s[20:21], s[0:1], 136
    s_load_dwordx2 s[26:27], s[0:1], 152
    v_lshrrev_b32 v2, 6, v0
    v_and_b32 v1, 63, v0
    v_readfirstlane_b32 s52, v2
    s_and_b32 s55, s3, 7
    s_lshr_b32 s56, s3, 3
    s_lshr_b32 s53, s55, 1
    s_lshl_b32 s53, s53, 2
    s_and_b32 s54, s56, 3
    s_add_u32 s53, s53, s54
    s_lshr_b32 s76, s56, 2
    s_and_b32 s54, s55, 1
    s_lshl_b32 s54, s54, 3
    s_add_u32 s54, s54, s76
    s_lshl_b32 s75, s55, 2
    s_and_b32 s56, s56, 3
    s_add_u32 s75, s75, s56
    s_and_b32 s57, s52, 1
    s_lshr_b32 s58, s52, 1
    s_lshr_b32 s85, s3, 5
    s_mul_i32 s84, s85, 3
    s_bfe_u32 s85, s3, 0x20003
    s_mul_i32 s85, s85, 2
    s_add_u32 s84, s84, s85
    s_and_b32 s85, s3, 1
    s_mul_i32 s85, s85, 5
    s_add_u32 s84, s84, s85
    s_bfe_u32 s85, s3, 0x20001
    s_mul_i32 s85, s85, 1
    s_add_u32 s84, s84, s85
    s_cmp_ge_u32 s84, 10
    s_cselect_b32 s85, 10, 0
    s_sub_u32 s84, s84, s85
    s_cmp_ge_u32 s84, 10
    s_cselect_b32 s85, 10, 0
    s_sub_u32 s84, s84, s85
    s_cmp_ge_u32 s84, 10
    s_cselect_b32 s85, 10, 0
    s_sub_u32 s84, s84, s85
    s_lshr_b32 s85, s3, 5
    s_mul_i32 s24, s85, 3
    s_bfe_u32 s85, s3, 0x20003
    s_lshl_b32 s85, s85, 1
    s_add_u32 s24, s24, s85
    s_and_b32 s85, s3, 7
    s_add_u32 s24, s24, s85
    s_cmp_ge_u32 s24, 10
    s_cselect_b32 s85, 10, 0
    s_sub_u32 s24, s24, s85
    s_cmp_ge_u32 s24, 10
    s_cselect_b32 s85, 10, 0
    s_sub_u32 s24, s24, s85
    s_cmp_ge_u32 s24, 10
    s_cselect_b32 s85, 10, 0
    s_sub_u32 s24, s24, s85
    v_lshrrev_b32 v2, 3, v1
    v_and_b32 v3, 7, v1
    v_xor_b32 v4, v2, v3
    v_lshlrev_b32 v4, 4, v4
    v_mul_u32_u24 v12, 1280, v2
    v_add_u32 v12, v12, v4
    v_lshrrev_b32 v5, 2, v2
    v_lshlrev_b32 v5, 3, v5
    v_and_b32 v6, 3, v2
    v_add_u32 v5, v5, v6
    v_mul_u32_u24 v10, 1280, v5
    v_add_u32 v10, v10, v4
    v_and_b32 v5, 6, v2
    v_or_b32 v5, s57, v5
    v_xor_b32 v5, v5, v3
    v_lshlrev_b32 v5, 4, v5
    v_mul_u32_u24 v11, 1280, v2
    v_add_u32 v11, v11, v5
    s_lshl_b32 s85, s84, 7
    v_add_u32 v10, s85, v10
    v_add_u32 v11, s85, v11
    s_lshl_b32 s85, s24, 7
    v_add_u32 v12, s85, v12
    s_mov_b32 s25, s24
    v_and_b32 v13, 15, v1
    v_lshrrev_b32 v14, 4, v1
    v_and_b32 v2, 7, v13
    v_xor_b32 v2, v2, v14
    v_lshlrev_b32 v2, 4, v2
    v_lshlrev_b32 v3, 7, v13
    v_add_u32 v2, v2, v3
    s_lshl_b32 s55, s52, 12
    v_add_u32 v16, s55, v2
    v_xor_b32 v17, 64, v16
    v_add_u32 v18, 53248, v16
    v_add_u32 v19, 53248, v17
    v_and_b32 v2, 1, v13
    v_cmp_eq_u32 s[72:73], 1, v2
    v_lshrrev_b32 v3, 1, v13
    v_lshlrev_b32 v4, 3, v2
    v_add_u32 v4, v4, v3
    v_and_b32 v5, 6, v3
    v_or_b32 v5, v5, v2
    v_xor_b32 v5, v5, v14
    v_lshlrev_b32 v5, 4, v5
    v_lshlrev_b32 v4, 7, v4
    v_add_u32 v4, v4, v5
    v_add_u32 v20, 16384, v4
    v_xor_b32 v21, 64, v20
    v_add_u32 v22, 53248, v20
    v_add_u32 v23, 53248, v21
    v_lshlrev_b32 v24, 2, v13
    s_waitcnt lgkmcnt(0)
    s_add_u32 s70, s26, 13320192
    s_addc_u32 s71, s27, 0
    s_load_dword s74, s[70:71], 0
    s_mov_b32 s28, s22
    s_and_b32 s29, s23, 0xffff
    s_mov_b32 s30, 2621440
    s_mov_b32 s31, 0x00020000
    s_cmp_eq_u32 s57, 0
    s_cselect_b32 s32, s4, s6
    s_cselect_b32 s33, s5, s7
    s_cselect_b32 s44, s12, s14
    s_cselect_b32 s45, s13, s15
    s_and_b32 s33, s33, 0xffff
    s_mov_b32 s34, 819200
    s_mov_b32 s35, 0x00020000
    s_and_b32 s45, s45, 0xffff
    s_mov_b32 s46, 819200
    s_mov_b32 s47, 0x00020000
    s_lshl_b32 s55, s53, 7
    s_lshl_b32 s56, s52, 5
    s_add_u32 s55, s55, s56
    s_mul_i32 s60, s55, 1280
    s_add_u32 s61, s60, 20480
    s_add_u32 s62, s60, 5120
    s_add_u32 s63, s60, 25600
    s_lshl_b32 s67, s52, 12
    s_mul_i32 s55, s54, 40
    s_lshl_b32 s56, s58, 3
    s_add_u32 s55, s55, s56
    s_mul_i32 s64, s55, 1280
    s_add_u32 s65, s64, 20480
    s_add_u32 s66, s64, 40960
    s_lshl_b32 s68, s58, 11
    s_lshl_b32 s56, s57, 10
    s_add_u32 s68, s68, s56
    s_add_u32 s68, s68, 16384
    s_mul_i32 s55, s76, 80
    s_lshl_b32 s56, s58, 3
    s_add_u32 s55, s55, s56
    s_mul_i32 s78, s55, 1280
    s_add_u32 s79, s78, 20480
    s_add_u32 s80, s79, 20480
    s_add_u32 s81, s80, 20480
    s_add_u32 s82, s81, 20480
    s_mul_i32 s83, s57, 10240
    s_lshl_b32 s56, s58, 10
    s_add_u32 s83, s83, s56
    v_lshrrev_b32 v170, 1, v13
    v_lshlrev_b32 v170, 4, v170
    v_add_u32 v170, 79872, v170
    v_bfrev_b32 v2, 1
    v_cndmask_b32 v168, v2, 0, s[72:73]
    v_cndmask_b32 v169, 0, v2, s[72:73]
    s_cmp_eq_u32 s58, 0
    s_cbranch_scc0 g1var1_5
    v_min_u32 v2, 39, v1
    v_lshlrev_b32 v2, 1, v2
    s_mul_i32 s55, s54, 80
    v_add_u32 v2, s55, v2
    s_mov_b32 s36, s8
    s_and_b32 s37, s9, 0xffff
    s_mov_b32 s38, 1280
    s_mov_b32 s39, 0x00020000
    buffer_load_ushort v36, v2, s[36:39], 0 offen
    s_mov_b32 s36, s10
    s_and_b32 s37, s11, 0xffff
    s_mov_b32 s38, 1280
    s_mov_b32 s39, 0x00020000
    buffer_load_ushort v37, v2, s[36:39], 0 offen
    s_mov_b32 s36, s16
    s_and_b32 s37, s17, 0xffff
    s_mov_b32 s38, 1280
    s_mov_b32 s39, 0x00020000
    buffer_load_ushort v38, v2, s[36:39], 0 offen
    s_add_u32 m0, s67, 0
    s_nop 0
    buffer_load_dwordx4 v10, s[28:31], s60 offen lds
    s_add_u32 m0, s67, 1024
    s_nop 0
    buffer_load_dwordx4 v10, s[28:31], s61 offen lds
    s_add_u32 m0, s67, 2048
    s_nop 0
    buffer_load_dwordx4 v10, s[28:31], s62 offen lds
    s_add_u32 m0, s67, 3072
    s_nop 0
    buffer_load_dwordx4 v10, s[28:31], s63 offen lds
    s_add_u32 m0, s68, 0
    s_nop 0
    buffer_load_dwordx4 v11, s[32:35], s64 offen lds
    s_add_u32 m0, s68, 4096
    s_nop 0
    buffer_load_dwordx4 v11, s[32:35], s65 offen lds
    s_add_u32 m0, s68, 8192
    s_nop 0
    buffer_load_dwordx4 v11, s[32:35], s66 offen lds
    s_add_u32 s84, s84, 1
    s_cmp_eq_u32 s84, 10
    s_cselect_b32 s85, 1280, 0
    s_cselect_b32 s84, 0, s84
    s_sub_u32 s85, 128, s85
    v_add_u32 v10, s85, v10
    v_add_u32 v11, s85, v11
    s_add_u32 m0, s67, 26624
    s_nop 0
    buffer_load_dwordx4 v10, s[28:31], s60 offen lds
    s_add_u32 m0, s67, 27648
    s_nop 0
    buffer_load_dwordx4 v10, s[28:31], s61 offen lds
    s_add_u32 m0, s67, 28672
    s_nop 0
    buffer_load_dwordx4 v10, s[28:31], s62 offen lds
    s_add_u32 m0, s67, 29696
    s_nop 0
    buffer_load_dwordx4 v10, s[28:31], s63 offen lds
    s_add_u32 m0, s68, 26624
    s_nop 0
    buffer_load_dwordx4 v11, s[32:35], s64 offen lds
    s_add_u32 m0, s68, 30720
    s_nop 0
    buffer_load_dwordx4 v11, s[32:35], s65 offen lds
    s_add_u32 m0, s68, 34816
    s_nop 0
    buffer_load_dwordx4 v11, s[32:35], s66 offen lds
    s_add_u32 s84, s84, 1
    s_cmp_eq_u32 s84, 10
    s_cselect_b32 s85, 1280, 0
    s_cselect_b32 s84, 0, s84
    s_sub_u32 s85, 128, s85
    v_add_u32 v10, s85, v10
    v_add_u32 v11, s85, v11
    s_waitcnt vmcnt(7)
    s_barrier
    ds_read_b128 v[92:95], v16 offset:0
    ds_read_b128 v[96:99], v16 offset:2048
    ds_read_b128 v[100:103], v20 offset:0
    ds_read_b128 v[104:107], v20 offset:2048
    ds_read_b128 v[108:111], v20 offset:4096
    ds_read_b128 v[112:115], v20 offset:6144
    ds_read_b128 v[116:119], v20 offset:8192
    s_waitcnt lgkmcnt(0)
    s_add_u32 s74, s74, 1
    v_mfma_f32_16x16x32_bf16 v[52:55], v[92:95], v[100:103], 0
    ds_read_b128 v[120:123], v17 offset:0
    v_lshlrev_b32 v36, 16, v36
    v_lshlrev_b32 v37, 16, v37
    v_mfma_f32_16x16x32_bf16 v[56:59], v[96:99], v[100:103], 0
    ds_read_b128 v[124:127], v17 offset:2048
    v_lshlrev_b32 v38, 16, v38
    v_mul_f32 v2, 0x3fb8aa3b, v38
    v_mfma_f32_16x16x32_bf16 v[60:63], v[92:95], v[104:107], 0
    ds_read_b128 v[128:131], v21 offset:0
    v_exp_f32 v2, v2
    s_nop 0
    v_mfma_f32_16x16x32_bf16 v[64:67], v[96:99], v[104:107], 0
    s_add_u32 m0, s67, 53248
    s_nop 0
    buffer_load_dwordx4 v10, s[28:31], s60 offen lds
    v_cvt_pk_bf16_f32 v2, v2, v2
    v_lshlrev_b32 v2, 16, v2
    v_mfma_f32_16x16x32_bf16 v[68:71], v[92:95], v[108:111], 0
    s_add_u32 m0, s67, 54272
    s_nop 0
    buffer_load_dwordx4 v10, s[28:31], s61 offen lds
    v_mul_f32 v3, v2, v36
    v_mul_f32 v4, v2, v37
    v_mfma_f32_16x16x32_bf16 v[72:75], v[96:99], v[108:111], 0
    s_add_u32 m0, s67, 55296
    s_nop 0
    buffer_load_dwordx4 v10, s[28:31], s62 offen lds
    v_mul_f32 v3, 0x3fb8aa3b, v3
    v_mul_f32 v4, 0x3e22f983, v4
    v_mfma_f32_16x16x32_bf16 v[76:79], v[92:95], v[112:115], 0
    s_add_u32 m0, s67, 56320
    s_nop 0
    buffer_load_dwordx4 v10, s[28:31], s63 offen lds
    v_exp_f32 v3, v3
    v_fract_f32 v4, v4
    v_mfma_f32_16x16x32_bf16 v[80:83], v[96:99], v[112:115], 0
    s_add_u32 m0, s68, 53248
    s_nop 0
    buffer_load_dwordx4 v11, s[32:35], s64 offen lds
    v_cos_f32 v5, v4
    v_sin_f32 v6, v4
    v_mfma_f32_16x16x32_bf16 v[84:87], v[92:95], v[116:119], 0
    s_add_u32 m0, s68, 57344
    s_nop 0
    buffer_load_dwordx4 v11, s[32:35], s65 offen lds
    s_nop 0
    v_mul_f32 v48, v3, v5
    v_mfma_f32_16x16x32_bf16 v[88:91], v[96:99], v[116:119], 0
    s_add_u32 m0, s68, 61440
    s_nop 0
    buffer_load_dwordx4 v11, s[32:35], s66 offen lds
    v_mul_f32 v49, v3, v6
    v_add_f32 v5, -1.0, v48
    s_add_u32 s84, s84, 1
    s_cmp_eq_u32 s84, 10
    s_cselect_b32 s85, 1280, 0
    s_cselect_b32 s84, 0, s84
    s_sub_u32 s85, 128, s85
    v_add_u32 v10, s85, v10
    v_add_u32 v11, s85, v11
    ds_read_b128 v[132:135], v21 offset:2048
    ds_read_b128 v[136:139], v21 offset:4096
    ds_read_b128 v[140:143], v21 offset:6144
    ds_read_b128 v[144:147], v21 offset:8192
    s_waitcnt lgkmcnt(0)
    s_waitcnt vmcnt(7)
    s_barrier
    ds_read_b128 v[92:95], v16 offset:26624
    ds_read_b128 v[96:99], v16 offset:28672
    ds_read_b128 v[100:103], v20 offset:26624
    v_mfma_f32_16x16x32_bf16 v[52:55], v[120:123], v[128:131], v[52:55]
    ds_read_b128 v[104:107], v20 offset:28672
    v_mul_f32 v7, v36, v36
    v_fma_f32 v7, v37, v37, v7
    v_mfma_f32_16x16x32_bf16 v[56:59], v[124:127], v[128:131], v[56:59]
    ds_read_b128 v[108:111], v20 offset:30720
    v_rcp_f32 v7, v7
    v_mul_f32 v8, v5, v36
    v_mfma_f32_16x16x32_bf16 v[60:63], v[120:123], v[132:135], v[60:63]
    ds_read_b128 v[112:115], v20 offset:32768
    v_fma_f32 v8, v49, v37, v8
    v_mul_f32 v9, v49, v36
    v_mfma_f32_16x16x32_bf16 v[64:67], v[124:127], v[132:135], v[64:67]
    ds_read_b128 v[116:119], v20 offset:34816
    v_fma_f32 v9, -v5, v37, v9
    v_mul_f32 v8, v8, v7
    v_mfma_f32_16x16x32_bf16 v[68:71], v[120:123], v[136:139], v[68:71]
    s_add_u32 m0, s67, 0
    s_nop 0
    buffer_load_dwordx4 v10, s[28:31], s60 offen lds
    v_mul_f32 v9, v9, v7
    v_add_f32 v50, v8, v8
    v_mfma_f32_16x16x32_bf16 v[72:75], v[124:127], v[136:139], v[72:75]
    s_add_u32 m0, s67, 1024
    s_nop 0
    buffer_load_dwordx4 v10, s[28:31], s61 offen lds
    v_mul_f32 v51, -2.0, v9
    v_lshlrev_b32 v2, 4, v1
    v_mfma_f32_16x16x32_bf16 v[76:79], v[120:123], v[140:143], v[76:79]
    s_add_u32 m0, s67, 2048
    s_nop 0
    buffer_load_dwordx4 v10, s[28:31], s62 offen lds
    v_min_u32 v2, 1008, v2
    v_add_u32 v2, 79872, v2
    v_mfma_f32_16x16x32_bf16 v[80:83], v[124:127], v[140:143], v[80:83]
    s_add_u32 m0, s67, 3072
    s_nop 0
    buffer_load_dwordx4 v10, s[28:31], s63 offen lds
    ds_write_b128 v2, v[48:51]
    v_mfma_f32_16x16x32_bf16 v[84:87], v[120:123], v[144:147], v[84:87]
    s_add_u32 m0, s68, 0
    s_nop 0
    buffer_load_dwordx4 v11, s[32:35], s64 offen lds
    v_mfma_f32_16x16x32_bf16 v[88:91], v[124:127], v[144:147], v[88:91]
    s_add_u32 m0, s68, 4096
    s_nop 0
    buffer_load_dwordx4 v11, s[32:35], s65 offen lds
    s_add_u32 m0, s68, 8192
    s_nop 0
    buffer_load_dwordx4 v11, s[32:35], s66 offen lds
    s_add_u32 s84, s84, 1
    s_cmp_eq_u32 s84, 10
    s_cselect_b32 s85, 1280, 0
    s_cselect_b32 s84, 0, s84
    s_sub_u32 s85, 128, s85
    v_add_u32 v10, s85, v10
    v_add_u32 v11, s85, v11
    s_waitcnt lgkmcnt(0)
    v_mfma_f32_16x16x32_bf16 v[52:55], v[92:95], v[100:103], v[52:55]
    ds_read_b128 v[120:123], v17 offset:26624
    v_mov_b32 v40, v48
    v_mov_b32 v41, v49
    v_mfma_f32_16x16x32_bf16 v[56:59], v[96:99], v[100:103], v[56:59]
    ds_read_b128 v[124:127], v17 offset:28672
    v_mov_b32 v46, v50
    v_mov_b32 v47, v51
    v_mfma_f32_16x16x32_bf16 v[60:63], v[92:95], v[104:107], v[60:63]
    ds_read_b128 v[128:131], v21 offset:26624
    v_add_f32 v2, v40, v40
    v_mul_f32 v3, v41, v41
    v_mfma_f32_16x16x32_bf16 v[64:67], v[96:99], v[104:107], v[64:67]
    ds_read_b128 v[132:135], v21 offset:28672
    v_mul_f32 v41, v2, v41
    v_fma_f32 v40, v40, v40, -v3
    v_mfma_f32_16x16x32_bf16 v[68:71], v[92:95], v[108:111], v[68:71]
    ds_read_b128 v[136:139], v21 offset:30720
    v_add_f32 v2, v40, v40
    v_mul_f32 v3, v41, v41
    v_mfma_f32_16x16x32_bf16 v[72:75], v[96:99], v[108:111], v[72:75]
    ds_read_b128 v[140:143], v21 offset:32768
    v_mul_f32 v41, v2, v41
    v_fma_f32 v40, v40, v40, -v3
    v_mfma_f32_16x16x32_bf16 v[76:79], v[92:95], v[112:115], v[76:79]
    ds_read_b128 v[144:147], v21 offset:34816
    v_add_f32 v2, v40, v40
    v_mul_f32 v3, v41, v41
    v_mfma_f32_16x16x32_bf16 v[80:83], v[96:99], v[112:115], v[80:83]
    v_mul_f32 v41, v2, v41
    v_fma_f32 v40, v40, v40, -v3
    v_mfma_f32_16x16x32_bf16 v[84:87], v[92:95], v[116:119], v[84:87]
    v_mov_b32 v42, v40
    v_mov_b32 v43, v41
    v_mfma_f32_16x16x32_bf16 v[88:91], v[96:99], v[116:119], v[88:91]
    v_add_f32 v2, v42, v42
    v_mul_f32 v3, v43, v43
    s_waitcnt lgkmcnt(0)
    s_waitcnt vmcnt(7)
    s_barrier
    ds_read_b128 v[92:95], v18 offset:0
    ds_read_b128 v[96:99], v18 offset:2048
    ds_read_b128 v[100:103], v22 offset:0
    v_mfma_f32_16x16x32_bf16 v[52:55], v[120:123], v[128:131], v[52:55]
    ds_read_b128 v[104:107], v22 offset:2048
    v_mul_f32 v43, v2, v43
    v_fma_f32 v42, v42, v42, -v3
    v_mfma_f32_16x16x32_bf16 v[56:59], v[124:127], v[128:131], v[56:59]
    ds_read_b128 v[108:111], v22 offset:4096
    v_add_f32 v2, v42, v42
    v_mul_f32 v3, v43, v43
    v_mfma_f32_16x16x32_bf16 v[60:63], v[120:123], v[132:135], v[60:63]
    ds_read_b128 v[112:115], v22 offset:6144
    v_mul_f32 v43, v2, v43
    v_fma_f32 v42, v42, v42, -v3
    v_mfma_f32_16x16x32_bf16 v[64:67], v[124:127], v[132:135], v[64:67]
    ds_read_b128 v[116:119], v22 offset:8192
    v_add_f32 v2, v42, v42
    v_mul_f32 v3, v43, v43
    v_mfma_f32_16x16x32_bf16 v[68:71], v[120:123], v[136:139], v[68:71]
    s_add_u32 m0, s67, 26624
    s_nop 0
    buffer_load_dwordx4 v10, s[28:31], s60 offen lds
    v_mul_f32 v43, v2, v43
    v_fma_f32 v42, v42, v42, -v3
    v_mfma_f32_16x16x32_bf16 v[72:75], v[124:127], v[136:139], v[72:75]
    s_add_u32 m0, s67, 27648
    s_nop 0
    buffer_load_dwordx4 v10, s[28:31], s61 offen lds
    v_mov_b32 v44, v42
    v_mov_b32 v45, v43
    v_mfma_f32_16x16x32_bf16 v[76:79], v[120:123], v[140:143], v[76:79]
    s_add_u32 m0, s67, 28672
    s_nop 0
    buffer_load_dwordx4 v10, s[28:31], s62 offen lds
    v_add_f32 v2, v44, v44
    v_mul_f32 v3, v45, v45
    v_mfma_f32_16x16x32_bf16 v[80:83], v[124:127], v[140:143], v[80:83]
    s_add_u32 m0, s67, 29696
    s_nop 0
    buffer_load_dwordx4 v10, s[28:31], s63 offen lds
    v_mul_f32 v45, v2, v45
    v_fma_f32 v44, v44, v44, -v3
    v_mfma_f32_16x16x32_bf16 v[84:87], v[120:123], v[144:147], v[84:87]
    s_add_u32 m0, s68, 26624
    s_nop 0
    buffer_load_dwordx4 v11, s[32:35], s64 offen lds
    v_mfma_f32_16x16x32_bf16 v[88:91], v[124:127], v[144:147], v[88:91]
    s_add_u32 m0, s68, 30720
    s_nop 0
    buffer_load_dwordx4 v11, s[32:35], s65 offen lds
    s_add_u32 m0, s68, 34816
    s_nop 0
    buffer_load_dwordx4 v11, s[32:35], s66 offen lds
    s_add_u32 s84, s84, 1
    s_cmp_eq_u32 s84, 10
    s_cselect_b32 s85, 1280, 0
    s_cselect_b32 s84, 0, s84
    s_sub_u32 s85, 128, s85
    v_add_u32 v10, s85, v10
    v_add_u32 v11, s85, v11
    s_waitcnt lgkmcnt(0)
    v_mfma_f32_16x16x32_bf16 v[52:55], v[92:95], v[100:103], v[52:55]
    ds_read_b128 v[120:123], v19 offset:0
    v_mfma_f32_16x16x32_bf16 v[56:59], v[96:99], v[100:103], v[56:59]
    ds_read_b128 v[124:127], v19 offset:2048
    v_mfma_f32_16x16x32_bf16 v[60:63], v[92:95], v[104:107], v[60:63]
    ds_read_b128 v[128:131], v23 offset:0
    v_mfma_f32_16x16x32_bf16 v[64:67], v[96:99], v[104:107], v[64:67]
    ds_read_b128 v[132:135], v23 offset:2048
    v_mfma_f32_16x16x32_bf16 v[68:71], v[92:95], v[108:111], v[68:71]
    ds_read_b128 v[136:139], v23 offset:4096
    v_mfma_f32_16x16x32_bf16 v[72:75], v[96:99], v[108:111], v[72:75]
    ds_read_b128 v[140:143], v23 offset:6144
    v_mfma_f32_16x16x32_bf16 v[76:79], v[92:95], v[112:115], v[76:79]
    ds_read_b128 v[144:147], v23 offset:8192
    v_mfma_f32_16x16x32_bf16 v[80:83], v[96:99], v[112:115], v[80:83]
    ds_read_b128 v[148:151], v170 offset:0
    v_mfma_f32_16x16x32_bf16 v[84:87], v[92:95], v[116:119], v[84:87]
    ds_read_b128 v[152:155], v170 offset:128
    v_mfma_f32_16x16x32_bf16 v[88:91], v[96:99], v[116:119], v[88:91]
    ds_read_b128 v[156:159], v170 offset:256
    ds_read_b128 v[160:163], v170 offset:384
    ds_read_b128 v[164:167], v170 offset:512
    s_waitcnt lgkmcnt(0)
    s_waitcnt vmcnt(7)
    s_barrier
    ds_read_b128 v[92:95], v16 offset:0
    ds_read_b128 v[96:99], v16 offset:2048
    ds_read_b128 v[100:103], v20 offset:0
    v_mfma_f32_16x16x32_bf16 v[52:55], v[120:123], v[128:131], v[52:55]
    ds_read_b128 v[104:107], v20 offset:2048
    v_mfma_f32_16x16x32_bf16 v[56:59], v[124:127], v[128:131], v[56:59]
    ds_read_b128 v[108:111], v20 offset:4096
    v_mfma_f32_16x16x32_bf16 v[60:63], v[120:123], v[132:135], v[60:63]
    ds_read_b128 v[112:115], v20 offset:6144
    v_mfma_f32_16x16x32_bf16 v[64:67], v[124:127], v[132:135], v[64:67]
    ds_read_b128 v[116:119], v20 offset:8192
    v_mfma_f32_16x16x32_bf16 v[68:71], v[120:123], v[136:139], v[68:71]
    s_add_u32 m0, s67, 53248
    s_nop 0
    buffer_load_dwordx4 v10, s[28:31], s60 offen lds
    v_mfma_f32_16x16x32_bf16 v[72:75], v[124:127], v[136:139], v[72:75]
    s_add_u32 m0, s67, 54272
    s_nop 0
    buffer_load_dwordx4 v10, s[28:31], s61 offen lds
    v_mfma_f32_16x16x32_bf16 v[76:79], v[120:123], v[140:143], v[76:79]
    s_add_u32 m0, s67, 55296
    s_nop 0
    buffer_load_dwordx4 v10, s[28:31], s62 offen lds
    v_mfma_f32_16x16x32_bf16 v[80:83], v[124:127], v[140:143], v[80:83]
    s_add_u32 m0, s67, 56320
    s_nop 0
    buffer_load_dwordx4 v10, s[28:31], s63 offen lds
    v_mfma_f32_16x16x32_bf16 v[84:87], v[120:123], v[144:147], v[84:87]
    s_add_u32 m0, s68, 53248
    s_nop 0
    buffer_load_dwordx4 v11, s[32:35], s64 offen lds
    v_mfma_f32_16x16x32_bf16 v[88:91], v[124:127], v[144:147], v[88:91]
    s_add_u32 m0, s68, 57344
    s_nop 0
    buffer_load_dwordx4 v11, s[32:35], s65 offen lds
    s_add_u32 m0, s68, 61440
    s_nop 0
    buffer_load_dwordx4 v11, s[32:35], s66 offen lds
    s_add_u32 s84, s84, 1
    s_cmp_eq_u32 s84, 10
    s_cselect_b32 s85, 1280, 0
    s_cselect_b32 s84, 0, s84
    s_sub_u32 s85, 128, s85
    v_add_u32 v10, s85, v10
    v_add_u32 v11, s85, v11
    s_waitcnt lgkmcnt(0)
    v_mfma_f32_16x16x32_bf16 v[52:55], v[92:95], v[100:103], v[52:55]
    ds_read_b128 v[120:123], v17 offset:0
    v_xor_b32 v149, v168, v149
    v_xor_b32 v150, v169, v150
    v_mfma_f32_16x16x32_bf16 v[56:59], v[96:99], v[100:103], v[56:59]
    ds_read_b128 v[124:127], v17 offset:2048
    v_xor_b32 v153, v168, v153
    v_xor_b32 v154, v169, v154
    v_mfma_f32_16x16x32_bf16 v[60:63], v[92:95], v[104:107], v[60:63]
    ds_read_b128 v[128:131], v21 offset:0
    v_xor_b32 v157, v168, v157
    v_xor_b32 v158, v169, v158
    v_mfma_f32_16x16x32_bf16 v[64:67], v[96:99], v[104:107], v[64:67]
    ds_read_b128 v[132:135], v21 offset:2048
    v_xor_b32 v161, v168, v161
    v_xor_b32 v162, v169, v162
    v_mfma_f32_16x16x32_bf16 v[68:71], v[92:95], v[108:111], v[68:71]
    ds_read_b128 v[136:139], v21 offset:4096
    v_xor_b32 v165, v168, v165
    v_xor_b32 v166, v169, v166
    v_mfma_f32_16x16x32_bf16 v[72:75], v[96:99], v[108:111], v[72:75]
    ds_read_b128 v[140:143], v21 offset:6144
    v_mfma_f32_16x16x32_bf16 v[76:79], v[92:95], v[112:115], v[76:79]
    ds_read_b128 v[144:147], v21 offset:8192
    v_mfma_f32_16x16x32_bf16 v[80:83], v[96:99], v[112:115], v[80:83]
    v_mfma_f32_16x16x32_bf16 v[84:87], v[92:95], v[116:119], v[84:87]
    v_mfma_f32_16x16x32_bf16 v[88:91], v[96:99], v[116:119], v[88:91]
    s_waitcnt lgkmcnt(0)
    s_waitcnt vmcnt(7)
    s_barrier
    ds_read_b128 v[92:95], v16 offset:26624
    ds_read_b128 v[96:99], v16 offset:28672
    ds_read_b128 v[100:103], v20 offset:26624
    v_mfma_f32_16x16x32_bf16 v[52:55], v[120:123], v[128:131], v[52:55]
    ds_read_b128 v[104:107], v20 offset:28672
    v_mfma_f32_16x16x32_bf16 v[56:59], v[124:127], v[128:131], v[56:59]
    ds_read_b128 v[108:111], v20 offset:30720
    v_mfma_f32_16x16x32_bf16 v[60:63], v[120:123], v[132:135], v[60:63]
    ds_read_b128 v[112:115], v20 offset:32768
    v_mfma_f32_16x16x32_bf16 v[64:67], v[124:127], v[132:135], v[64:67]
    ds_read_b128 v[116:119], v20 offset:34816
    v_mfma_f32_16x16x32_bf16 v[68:71], v[120:123], v[136:139], v[68:71]
    s_add_u32 m0, s67, 0
    s_nop 0
    buffer_load_dwordx4 v10, s[28:31], s60 offen lds
    v_mfma_f32_16x16x32_bf16 v[72:75], v[124:127], v[136:139], v[72:75]
    s_add_u32 m0, s67, 1024
    s_nop 0
    buffer_load_dwordx4 v10, s[28:31], s61 offen lds
    v_mfma_f32_16x16x32_bf16 v[76:79], v[120:123], v[140:143], v[76:79]
    s_add_u32 m0, s67, 2048
    s_nop 0
    buffer_load_dwordx4 v10, s[28:31], s62 offen lds
    v_mfma_f32_16x16x32_bf16 v[80:83], v[124:127], v[140:143], v[80:83]
    s_add_u32 m0, s67, 3072
    s_nop 0
    buffer_load_dwordx4 v10, s[28:31], s63 offen lds
    v_mfma_f32_16x16x32_bf16 v[84:87], v[120:123], v[144:147], v[84:87]
    s_add_u32 m0, s68, 0
    s_nop 0
    buffer_load_dwordx4 v11, s[32:35], s64 offen lds
    v_mfma_f32_16x16x32_bf16 v[88:91], v[124:127], v[144:147], v[88:91]
    s_add_u32 m0, s68, 4096
    s_nop 0
    buffer_load_dwordx4 v11, s[32:35], s65 offen lds
    s_add_u32 m0, s68, 8192
    s_nop 0
    buffer_load_dwordx4 v11, s[32:35], s66 offen lds
    s_add_u32 s84, s84, 1
    s_cmp_eq_u32 s84, 10
    s_cselect_b32 s85, 1280, 0
    s_cselect_b32 s84, 0, s84
    s_sub_u32 s85, 128, s85
    v_add_u32 v10, s85, v10
    v_add_u32 v11, s85, v11
    s_waitcnt lgkmcnt(0)
    v_mfma_f32_16x16x32_bf16 v[52:55], v[92:95], v[100:103], v[52:55]
    ds_read_b128 v[120:123], v17 offset:26624
    v_mfma_f32_16x16x32_bf16 v[56:59], v[96:99], v[100:103], v[56:59]
    ds_read_b128 v[124:127], v17 offset:28672
    v_mfma_f32_16x16x32_bf16 v[60:63], v[92:95], v[104:107], v[60:63]
    ds_read_b128 v[128:131], v21 offset:26624
    v_mfma_f32_16x16x32_bf16 v[64:67], v[96:99], v[104:107], v[64:67]
    ds_read_b128 v[132:135], v21 offset:28672
    v_mfma_f32_16x16x32_bf16 v[68:71], v[92:95], v[108:111], v[68:71]
    ds_read_b128 v[136:139], v21 offset:30720
    v_mfma_f32_16x16x32_bf16 v[72:75], v[96:99], v[108:111], v[72:75]
    ds_read_b128 v[140:143], v21 offset:32768
    v_mfma_f32_16x16x32_bf16 v[76:79], v[92:95], v[112:115], v[76:79]
    ds_read_b128 v[144:147], v21 offset:34816
    v_mfma_f32_16x16x32_bf16 v[80:83], v[96:99], v[112:115], v[80:83]
    v_mfma_f32_16x16x32_bf16 v[84:87], v[92:95], v[116:119], v[84:87]
    v_mfma_f32_16x16x32_bf16 v[88:91], v[96:99], v[116:119], v[88:91]
    s_waitcnt lgkmcnt(0)
    s_waitcnt vmcnt(7)
    s_barrier
    ds_read_b128 v[92:95], v18 offset:0
    ds_read_b128 v[96:99], v18 offset:2048
    ds_read_b128 v[100:103], v22 offset:0
    v_mfma_f32_16x16x32_bf16 v[52:55], v[120:123], v[128:131], v[52:55]
    ds_read_b128 v[104:107], v22 offset:2048
    v_mfma_f32_16x16x32_bf16 v[56:59], v[124:127], v[128:131], v[56:59]
    ds_read_b128 v[108:111], v22 offset:4096
    v_mfma_f32_16x16x32_bf16 v[60:63], v[120:123], v[132:135], v[60:63]
    ds_read_b128 v[112:115], v22 offset:6144
    v_mfma_f32_16x16x32_bf16 v[64:67], v[124:127], v[132:135], v[64:67]
    ds_read_b128 v[116:119], v22 offset:8192
    v_mfma_f32_16x16x32_bf16 v[68:71], v[120:123], v[136:139], v[68:71]
    s_add_u32 m0, s67, 26624
    s_nop 0
    buffer_load_dwordx4 v10, s[28:31], s60 offen lds
    v_mfma_f32_16x16x32_bf16 v[72:75], v[124:127], v[136:139], v[72:75]
    s_add_u32 m0, s67, 27648
    s_nop 0
    buffer_load_dwordx4 v10, s[28:31], s61 offen lds
    v_mfma_f32_16x16x32_bf16 v[76:79], v[120:123], v[140:143], v[76:79]
    s_add_u32 m0, s67, 28672
    s_nop 0
    buffer_load_dwordx4 v10, s[28:31], s62 offen lds
    v_mfma_f32_16x16x32_bf16 v[80:83], v[124:127], v[140:143], v[80:83]
    s_add_u32 m0, s67, 29696
    s_nop 0
    buffer_load_dwordx4 v10, s[28:31], s63 offen lds
    v_mfma_f32_16x16x32_bf16 v[84:87], v[120:123], v[144:147], v[84:87]
    s_add_u32 m0, s68, 26624
    s_nop 0
    buffer_load_dwordx4 v11, s[32:35], s64 offen lds
    v_mfma_f32_16x16x32_bf16 v[88:91], v[124:127], v[144:147], v[88:91]
    s_add_u32 m0, s68, 30720
    s_nop 0
    buffer_load_dwordx4 v11, s[32:35], s65 offen lds
    s_add_u32 m0, s68, 34816
    s_nop 0
    buffer_load_dwordx4 v11, s[32:35], s66 offen lds
    s_add_u32 s84, s84, 1
    s_cmp_eq_u32 s84, 10
    s_cselect_b32 s85, 1280, 0
    s_cselect_b32 s84, 0, s84
    s_sub_u32 s85, 128, s85
    v_add_u32 v10, s85, v10
    v_add_u32 v11, s85, v11
    s_waitcnt lgkmcnt(0)
    v_mfma_f32_16x16x32_bf16 v[52:55], v[92:95], v[100:103], v[52:55]
    ds_read_b128 v[120:123], v19 offset:0
    v_mfma_f32_16x16x32_bf16 v[56:59], v[96:99], v[100:103], v[56:59]
    ds_read_b128 v[124:127], v19 offset:2048
    v_mfma_f32_16x16x32_bf16 v[60:63], v[92:95], v[104:107], v[60:63]
    ds_read_b128 v[128:131], v23 offset:0
    v_mfma_f32_16x16x32_bf16 v[64:67], v[96:99], v[104:107], v[64:67]
    ds_read_b128 v[132:135], v23 offset:2048
    v_mfma_f32_16x16x32_bf16 v[68:71], v[92:95], v[108:111], v[68:71]
    ds_read_b128 v[136:139], v23 offset:4096
    v_mfma_f32_16x16x32_bf16 v[72:75], v[96:99], v[108:111], v[72:75]
    ds_read_b128 v[140:143], v23 offset:6144
    v_mfma_f32_16x16x32_bf16 v[76:79], v[92:95], v[112:115], v[76:79]
    ds_read_b128 v[144:147], v23 offset:8192
    v_mfma_f32_16x16x32_bf16 v[80:83], v[96:99], v[112:115], v[80:83]
    v_mfma_f32_16x16x32_bf16 v[84:87], v[92:95], v[116:119], v[84:87]
    v_mfma_f32_16x16x32_bf16 v[88:91], v[96:99], v[116:119], v[88:91]
    s_waitcnt lgkmcnt(0)
    s_waitcnt vmcnt(7)
    s_barrier
    ds_read_b128 v[92:95], v16 offset:0
    ds_read_b128 v[96:99], v16 offset:2048
    ds_read_b128 v[100:103], v20 offset:0
    v_mfma_f32_16x16x32_bf16 v[52:55], v[120:123], v[128:131], v[52:55]
    ds_read_b128 v[104:107], v20 offset:2048
    v_mfma_f32_16x16x32_bf16 v[56:59], v[124:127], v[128:131], v[56:59]
    ds_read_b128 v[108:111], v20 offset:4096
    v_mfma_f32_16x16x32_bf16 v[60:63], v[120:123], v[132:135], v[60:63]
    ds_read_b128 v[112:115], v20 offset:6144
    v_mfma_f32_16x16x32_bf16 v[64:67], v[124:127], v[132:135], v[64:67]
    ds_read_b128 v[116:119], v20 offset:8192
    v_mfma_f32_16x16x32_bf16 v[68:71], v[120:123], v[136:139], v[68:71]
    s_add_u32 m0, s67, 53248
    s_nop 0
    buffer_load_dwordx4 v10, s[28:31], s60 offen lds
    v_mfma_f32_16x16x32_bf16 v[72:75], v[124:127], v[136:139], v[72:75]
    s_add_u32 m0, s67, 54272
    s_nop 0
    buffer_load_dwordx4 v10, s[28:31], s61 offen lds
    v_mfma_f32_16x16x32_bf16 v[76:79], v[120:123], v[140:143], v[76:79]
    s_add_u32 m0, s67, 55296
    s_nop 0
    buffer_load_dwordx4 v10, s[28:31], s62 offen lds
    v_mfma_f32_16x16x32_bf16 v[80:83], v[124:127], v[140:143], v[80:83]
    s_add_u32 m0, s67, 56320
    s_nop 0
    buffer_load_dwordx4 v10, s[28:31], s63 offen lds
    v_mfma_f32_16x16x32_bf16 v[84:87], v[120:123], v[144:147], v[84:87]
    s_add_u32 m0, s68, 53248
    s_nop 0
    buffer_load_dwordx4 v11, s[32:35], s64 offen lds
    v_mfma_f32_16x16x32_bf16 v[88:91], v[124:127], v[144:147], v[88:91]
    s_add_u32 m0, s68, 57344
    s_nop 0
    buffer_load_dwordx4 v11, s[32:35], s65 offen lds
    s_add_u32 m0, s68, 61440
    s_nop 0
    buffer_load_dwordx4 v11, s[32:35], s66 offen lds
    s_add_u32 s84, s84, 1
    s_cmp_eq_u32 s84, 10
    s_cselect_b32 s85, 1280, 0
    s_cselect_b32 s84, 0, s84
    s_sub_u32 s85, 128, s85
    v_add_u32 v10, s85, v10
    v_add_u32 v11, s85, v11
    s_waitcnt lgkmcnt(0)
    v_mfma_f32_16x16x32_bf16 v[52:55], v[92:95], v[100:103], v[52:55]
    ds_read_b128 v[120:123], v17 offset:0
    v_mfma_f32_16x16x32_bf16 v[56:59], v[96:99], v[100:103], v[56:59]
    ds_read_b128 v[124:127], v17 offset:2048
    v_mfma_f32_16x16x32_bf16 v[60:63], v[92:95], v[104:107], v[60:63]
    ds_read_b128 v[128:131], v21 offset:0
    v_mfma_f32_16x16x32_bf16 v[64:67], v[96:99], v[104:107], v[64:67]
    ds_read_b128 v[132:135], v21 offset:2048
    v_mfma_f32_16x16x32_bf16 v[68:71], v[92:95], v[108:111], v[68:71]
    ds_read_b128 v[136:139], v21 offset:4096
    v_mfma_f32_16x16x32_bf16 v[72:75], v[96:99], v[108:111], v[72:75]
    ds_read_b128 v[140:143], v21 offset:6144
    v_mfma_f32_16x16x32_bf16 v[76:79], v[92:95], v[112:115], v[76:79]
    ds_read_b128 v[144:147], v21 offset:8192
    v_mfma_f32_16x16x32_bf16 v[80:83], v[96:99], v[112:115], v[80:83]
    v_mfma_f32_16x16x32_bf16 v[84:87], v[92:95], v[116:119], v[84:87]
    v_mfma_f32_16x16x32_bf16 v[88:91], v[96:99], v[116:119], v[88:91]
    s_waitcnt lgkmcnt(0)
    s_waitcnt vmcnt(7)
    s_barrier
    ds_read_b128 v[92:95], v16 offset:26624
    ds_read_b128 v[96:99], v16 offset:28672
    ds_read_b128 v[100:103], v20 offset:26624
    v_mfma_f32_16x16x32_bf16 v[52:55], v[120:123], v[128:131], v[52:55]
    ds_read_b128 v[104:107], v20 offset:28672
    v_mfma_f32_16x16x32_bf16 v[56:59], v[124:127], v[128:131], v[56:59]
    ds_read_b128 v[108:111], v20 offset:30720
    v_mfma_f32_16x16x32_bf16 v[60:63], v[120:123], v[132:135], v[60:63]
    ds_read_b128 v[112:115], v20 offset:32768
    v_mfma_f32_16x16x32_bf16 v[64:67], v[124:127], v[132:135], v[64:67]
    ds_read_b128 v[116:119], v20 offset:34816
    v_mfma_f32_16x16x32_bf16 v[68:71], v[120:123], v[136:139], v[68:71]
    s_add_u32 m0, s67, 0
    s_nop 0
    buffer_load_dwordx4 v10, s[28:31], s60 offen lds
    v_mfma_f32_16x16x32_bf16 v[72:75], v[124:127], v[136:139], v[72:75]
    s_add_u32 m0, s67, 1024
    s_nop 0
    buffer_load_dwordx4 v10, s[28:31], s61 offen lds
    v_mfma_f32_16x16x32_bf16 v[76:79], v[120:123], v[140:143], v[76:79]
    s_add_u32 m0, s67, 2048
    s_nop 0
    buffer_load_dwordx4 v10, s[28:31], s62 offen lds
    v_mfma_f32_16x16x32_bf16 v[80:83], v[124:127], v[140:143], v[80:83]
    s_add_u32 m0, s67, 3072
    s_nop 0
    buffer_load_dwordx4 v10, s[28:31], s63 offen lds
    v_mfma_f32_16x16x32_bf16 v[84:87], v[120:123], v[144:147], v[84:87]
    s_add_u32 m0, s68, 0
    s_nop 0
    buffer_load_dwordx4 v11, s[32:35], s64 offen lds
    v_mfma_f32_16x16x32_bf16 v[88:91], v[124:127], v[144:147], v[88:91]
    s_add_u32 m0, s68, 4096
    s_nop 0
    buffer_load_dwordx4 v11, s[32:35], s65 offen lds
    s_add_u32 m0, s68, 8192
    s_nop 0
    buffer_load_dwordx4 v11, s[32:35], s66 offen lds
    s_add_u32 s84, s84, 1
    s_cmp_eq_u32 s84, 10
    s_cselect_b32 s85, 1280, 0
    s_cselect_b32 s84, 0, s84
    s_sub_u32 s85, 128, s85
    v_add_u32 v10, s85, v10
    v_add_u32 v11, s85, v11
    s_cmp_eq_u32 s52, 0
    s_cbranch_scc1 cpf_7
    s_lshr_b32 s55, s3, 3
    s_mul_i32 s55, s55, 3
    s_add_u32 s55, s55, s52
    s_sub_u32 s55, s55, 1
    s_mul_i32 s55, s55, 8576
    v_lshlrev_b32 v2, 7, v1
    v_add_u32 v2, s55, v2
    v_add_u32 v3, 8192, v2
    v_cmp_gt_u32 vcc, 3, v1
    v_mov_b32 v4, 0x7ff00000
    s_nop 0
    v_cndmask_b32 v3, v4, v3, vcc
    s_mov_b32 s36, s12
    s_and_b32 s37, s13, 0xffff
    s_mov_b32 s38, 819200
    s_mov_b32 s39, 0x00020000
    buffer_load_dword v0, v2, s[36:39], 0 offen
    buffer_load_dword v0, v3, s[36:39], 0 offen
    s_mov_b32 s36, s14
    s_and_b32 s37, s15, 0xffff
    s_mov_b32 s38, 819200
    s_mov_b32 s39, 0x00020000
    buffer_load_dword v0, v2, s[36:39], 0 offen
    buffer_load_dword v0, v3, s[36:39], 0 offen
cpf_7:
    s_waitcnt lgkmcnt(0)
    v_mfma_f32_16x16x32_bf16 v[52:55], v[92:95], v[100:103], v[52:55]
    ds_read_b128 v[120:123], v17 offset:26624
    v_mfma_f32_16x16x32_bf16 v[56:59], v[96:99], v[100:103], v[56:59]
    ds_read_b128 v[124:127], v17 offset:28672
    v_mfma_f32_16x16x32_bf16 v[60:63], v[92:95], v[104:107], v[60:63]
    ds_read_b128 v[128:131], v21 offset:26624
    v_mfma_f32_16x16x32_bf16 v[64:67], v[96:99], v[104:107], v[64:67]
    ds_read_b128 v[132:135], v21 offset:28672
    v_mfma_f32_16x16x32_bf16 v[68:71], v[92:95], v[108:111], v[68:71]
    ds_read_b128 v[136:139], v21 offset:30720
    v_mfma_f32_16x16x32_bf16 v[72:75], v[96:99], v[108:111], v[72:75]
    ds_read_b128 v[140:143], v21 offset:32768
    v_mfma_f32_16x16x32_bf16 v[76:79], v[92:95], v[112:115], v[76:79]
    ds_read_b128 v[144:147], v21 offset:34816
    v_mfma_f32_16x16x32_bf16 v[80:83], v[96:99], v[112:115], v[80:83]
    v_mfma_f32_16x16x32_bf16 v[84:87], v[92:95], v[116:119], v[84:87]
    v_mfma_f32_16x16x32_bf16 v[88:91], v[96:99], v[116:119], v[88:91]
    s_waitcnt lgkmcnt(0)
    s_cmp_eq_u32 s52, 0
    s_cbranch_scc1 ws0_8
    s_waitcnt vmcnt(11)
    s_branch ws1_9
ws0_8:
    s_waitcnt vmcnt(7)
ws1_9:
    s_barrier
    ds_read_b128 v[92:95], v18 offset:0
    ds_read_b128 v[96:99], v18 offset:2048
    ds_read_b128 v[100:103], v22 offset:0
    v_mfma_f32_16x16x32_bf16 v[52:55], v[120:123], v[128:131], v[52:55]
    ds_read_b128 v[104:107], v22 offset:2048
    v_mfma_f32_16x16x32_bf16 v[56:59], v[124:127], v[128:131], v[56:59]
    ds_read_b128 v[108:111], v22 offset:4096
    v_mfma_f32_16x16x32_bf16 v[60:63], v[120:123], v[132:135], v[60:63]
    ds_read_b128 v[112:115], v22 offset:6144
    v_mfma_f32_16x16x32_bf16 v[64:67], v[124:127], v[132:135], v[64:67]
    ds_read_b128 v[116:119], v22 offset:8192
    v_mfma_f32_16x16x32_bf16 v[68:71], v[120:123], v[136:139], v[68:71]
    v_mfma_f32_16x16x32_bf16 v[72:75], v[124:127], v[136:139], v[72:75]
    v_mfma_f32_16x16x32_bf16 v[76:79], v[120:123], v[140:143], v[76:79]
    v_mfma_f32_16x16x32_bf16 v[80:83], v[124:127], v[140:143], v[80:83]
    v_mfma_f32_16x16x32_bf16 v[84:87], v[120:123], v[144:147], v[84:87]
    v_mfma_f32_16x16x32_bf16 v[88:91], v[124:127], v[144:147], v[88:91]
    s_waitcnt lgkmcnt(0)
    v_mfma_f32_16x16x32_bf16 v[52:55], v[92:95], v[100:103], v[52:55]
    ds_read_b128 v[120:123], v19 offset:0
    v_mfma_f32_16x16x32_bf16 v[56:59], v[96:99], v[100:103], v[56:59]
    ds_read_b128 v[124:127], v19 offset:2048
    v_mfma_f32_16x16x32_bf16 v[60:63], v[92:95], v[104:107], v[60:63]
    ds_read_b128 v[128:131], v23 offset:0
    v_mfma_f32_16x16x32_bf16 v[64:67], v[96:99], v[104:107], v[64:67]
    ds_read_b128 v[132:135], v23 offset:2048
    v_mfma_f32_16x16x32_bf16 v[68:71], v[92:95], v[108:111], v[68:71]
    ds_read_b128 v[136:139], v23 offset:4096
    v_mfma_f32_16x16x32_bf16 v[72:75], v[96:99], v[108:111], v[72:75]
    ds_read_b128 v[140:143], v23 offset:6144
    v_mfma_f32_16x16x32_bf16 v[76:79], v[92:95], v[112:115], v[76:79]
    ds_read_b128 v[144:147], v23 offset:8192
    v_mfma_f32_16x16x32_bf16 v[80:83], v[96:99], v[112:115], v[80:83]
    v_mfma_f32_16x16x32_bf16 v[84:87], v[92:95], v[116:119], v[84:87]
    v_mfma_f32_16x16x32_bf16 v[88:91], v[96:99], v[116:119], v[88:91]
    s_waitcnt lgkmcnt(0)
    s_cmp_eq_u32 s52, 0
    s_cbranch_scc1 ws0_10
    s_waitcnt vmcnt(4)
    s_branch ws1_11
ws0_10:
    s_waitcnt vmcnt(0)
ws1_11:
    s_barrier
    ds_read_b128 v[92:95], v16 offset:0
    ds_read_b128 v[96:99], v16 offset:2048
    ds_read_b128 v[100:103], v20 offset:0
    v_mfma_f32_16x16x32_bf16 v[52:55], v[120:123], v[128:131], v[52:55]
    ds_read_b128 v[104:107], v20 offset:2048
    v_mfma_f32_16x16x32_bf16 v[56:59], v[124:127], v[128:131], v[56:59]
    ds_read_b128 v[108:111], v20 offset:4096
    v_mfma_f32_16x16x32_bf16 v[60:63], v[120:123], v[132:135], v[60:63]
    ds_read_b128 v[112:115], v20 offset:6144
    v_mfma_f32_16x16x32_bf16 v[64:67], v[124:127], v[132:135], v[64:67]
    ds_read_b128 v[116:119], v20 offset:8192
    v_mfma_f32_16x16x32_bf16 v[68:71], v[120:123], v[136:139], v[68:71]
    v_mfma_f32_16x16x32_bf16 v[72:75], v[124:127], v[136:139], v[72:75]
    v_mfma_f32_16x16x32_bf16 v[76:79], v[120:123], v[140:143], v[76:79]
    v_mfma_f32_16x16x32_bf16 v[80:83], v[124:127], v[140:143], v[80:83]
    v_mfma_f32_16x16x32_bf16 v[84:87], v[120:123], v[144:147], v[84:87]
    v_mfma_f32_16x16x32_bf16 v[88:91], v[124:127], v[144:147], v[88:91]
    s_waitcnt lgkmcnt(0)
    v_mfma_f32_16x16x32_bf16 v[52:55], v[92:95], v[100:103], v[52:55]
    ds_read_b128 v[120:123], v17 offset:0
    v_mfma_f32_16x16x32_bf16 v[56:59], v[96:99], v[100:103], v[56:59]
    ds_read_b128 v[124:127], v17 offset:2048
    v_mfma_f32_16x16x32_bf16 v[60:63], v[92:95], v[104:107], v[60:63]
    ds_read_b128 v[128:131], v21 offset:0
    v_mfma_f32_16x16x32_bf16 v[64:67], v[96:99], v[104:107], v[64:67]
    ds_read_b128 v[132:135], v21 offset:2048
    v_mfma_f32_16x16x32_bf16 v[68:71], v[92:95], v[108:111], v[68:71]
    ds_read_b128 v[136:139], v21 offset:4096
    v_mfma_f32_16x16x32_bf16 v[72:75], v[96:99], v[108:111], v[72:75]
    ds_read_b128 v[140:143], v21 offset:6144
    v_mfma_f32_16x16x32_bf16 v[76:79], v[92:95], v[112:115], v[76:79]
    ds_read_b128 v[144:147], v21 offset:8192
    v_mfma_f32_16x16x32_bf16 v[80:83], v[96:99], v[112:115], v[80:83]
    v_mfma_f32_16x16x32_bf16 v[84:87], v[92:95], v[116:119], v[84:87]
    v_mfma_f32_16x16x32_bf16 v[88:91], v[96:99], v[116:119], v[88:91]
    s_waitcnt lgkmcnt(0)
    v_mfma_f32_16x16x32_bf16 v[52:55], v[120:123], v[128:131], v[52:55]
    v_mfma_f32_16x16x32_bf16 v[56:59], v[124:127], v[128:131], v[56:59]
    v_mfma_f32_16x16x32_bf16 v[60:63], v[120:123], v[132:135], v[60:63]
    v_mfma_f32_16x16x32_bf16 v[64:67], v[124:127], v[132:135], v[64:67]
    v_mfma_f32_16x16x32_bf16 v[68:71], v[120:123], v[136:139], v[68:71]
    v_mfma_f32_16x16x32_bf16 v[72:75], v[124:127], v[136:139], v[72:75]
    v_mfma_f32_16x16x32_bf16 v[76:79], v[120:123], v[140:143], v[76:79]
    v_mfma_f32_16x16x32_bf16 v[80:83], v[124:127], v[140:143], v[80:83]
    v_mfma_f32_16x16x32_bf16 v[84:87], v[120:123], v[144:147], v[84:87]
    v_mfma_f32_16x16x32_bf16 v[88:91], v[124:127], v[144:147], v[88:91]
    s_branch g1loopend_6
g1var1_5:
    s_add_u32 m0, s67, 0
    s_nop 0
    buffer_load_dwordx4 v10, s[28:31], s60 offen lds
    s_add_u32 m0, s67, 1024
    s_nop 0
    buffer_load_dwordx4 v10, s[28:31], s61 offen lds
    s_add_u32 m0, s67, 2048
    s_nop 0
    buffer_load_dwordx4 v10, s[28:31], s62 offen lds
    s_add_u32 m0, s67, 3072
    s_nop 0
    buffer_load_dwordx4 v10, s[28:31], s63 offen lds
    s_add_u32 m0, s68, 0
    s_nop 0
    buffer_load_dwordx4 v11, s[32:35], s64 offen lds
    s_add_u32 m0, s68, 4096
    s_nop 0
    buffer_load_dwordx4 v11, s[32:35], s65 offen lds
    s_add_u32 s84, s84, 1
    s_cmp_eq_u32 s84, 10
    s_cselect_b32 s85, 1280, 0
    s_cselect_b32 s84, 0, s84
    s_sub_u32 s85, 128, s85
    v_add_u32 v10, s85, v10
    v_add_u32 v11, s85, v11
    s_add_u32 m0, s67, 26624
    s_nop 0
    buffer_load_dwordx4 v10, s[28:31], s60 offen lds
    s_add_u32 m0, s67, 27648
    s_nop 0
    buffer_load_dwordx4 v10, s[28:31], s61 offen lds
    s_add_u32 m0, s67, 28672
    s_nop 0
    buffer_load_dwordx4 v10, s[28:31], s62 offen lds
    s_add_u32 m0, s67, 29696
    s_nop 0
    buffer_load_dwordx4 v10, s[28:31], s63 offen lds
    s_add_u32 m0, s68, 26624
    s_nop 0
    buffer_load_dwordx4 v11, s[32:35], s64 offen lds
    s_add_u32 m0, s68, 30720
    s_nop 0
    buffer_load_dwordx4 v11, s[32:35], s65 offen lds
    s_add_u32 s84, s84, 1
    s_cmp_eq_u32 s84, 10
    s_cselect_b32 s85, 1280, 0
    s_cselect_b32 s84, 0, s84
    s_sub_u32 s85, 128, s85
    v_add_u32 v10, s85, v10
    v_add_u32 v11, s85, v11
    s_waitcnt vmcnt(6)
    s_barrier
    ds_read_b128 v[92:95], v16 offset:0
    ds_read_b128 v[96:99], v16 offset:2048
    ds_read_b128 v[100:103], v20 offset:0
    ds_read_b128 v[104:107], v20 offset:2048
    ds_read_b128 v[108:111], v20 offset:4096
    ds_read_b128 v[112:115], v20 offset:6144
    ds_read_b128 v[116:119], v20 offset:8192
    s_waitcnt lgkmcnt(0)
    s_add_u32 s74, s74, 1
    v_mfma_f32_16x16x32_bf16 v[52:55], v[92:95], v[100:103], 0
    ds_read_b128 v[120:123], v17 offset:0
    v_mfma_f32_16x16x32_bf16 v[56:59], v[96:99], v[100:103], 0
    ds_read_b128 v[124:127], v17 offset:2048
    v_mfma_f32_16x16x32_bf16 v[60:63], v[92:95], v[104:107], 0
    ds_read_b128 v[128:131], v21 offset:0
    v_mfma_f32_16x16x32_bf16 v[64:67], v[96:99], v[104:107], 0
    s_add_u32 m0, s67, 53248
    s_nop 0
    buffer_load_dwordx4 v10, s[28:31], s60 offen lds
    v_mfma_f32_16x16x32_bf16 v[68:71], v[92:95], v[108:111], 0
    s_add_u32 m0, s67, 54272
    s_nop 0
    buffer_load_dwordx4 v10, s[28:31], s61 offen lds
    v_mfma_f32_16x16x32_bf16 v[72:75], v[96:99], v[108:111], 0
    s_add_u32 m0, s67, 55296
    s_nop 0
    buffer_load_dwordx4 v10, s[28:31], s62 offen lds
    v_mfma_f32_16x16x32_bf16 v[76:79], v[92:95], v[112:115], 0
    s_add_u32 m0, s67, 56320
    s_nop 0
    buffer_load_dwordx4 v10, s[28:31], s63 offen lds
    v_mfma_f32_16x16x32_bf16 v[80:83], v[96:99], v[112:115], 0
    s_add_u32 m0, s68, 53248
    s_nop 0
    buffer_load_dwordx4 v11, s[32:35], s64 offen lds
    v_mfma_f32_16x16x32_bf16 v[84:87], v[92:95], v[116:119], 0
    s_add_u32 m0, s68, 57344
    s_nop 0
    buffer_load_dwordx4 v11, s[32:35], s65 offen lds
    v_mfma_f32_16x16x32_bf16 v[88:91], v[96:99], v[116:119], 0
    s_add_u32 s84, s84, 1
    s_cmp_eq_u32 s84, 10
    s_cselect_b32 s85, 1280, 0
    s_cselect_b32 s84, 0, s84
    s_sub_u32 s85, 128, s85
    v_add_u32 v10, s85, v10
    v_add_u32 v11, s85, v11
    ds_read_b128 v[132:135], v21 offset:2048
    ds_read_b128 v[136:139], v21 offset:4096
    ds_read_b128 v[140:143], v21 offset:6144
    ds_read_b128 v[144:147], v21 offset:8192
    s_waitcnt lgkmcnt(0)
    s_waitcnt vmcnt(6)
    s_barrier
    ds_read_b128 v[92:95], v16 offset:26624
    ds_read_b128 v[96:99], v16 offset:28672
    ds_read_b128 v[100:103], v20 offset:26624
    v_mfma_f32_16x16x32_bf16 v[52:55], v[120:123], v[128:131], v[52:55]
    ds_read_b128 v[104:107], v20 offset:28672
    v_mfma_f32_16x16x32_bf16 v[56:59], v[124:127], v[128:131], v[56:59]
    ds_read_b128 v[108:111], v20 offset:30720
    v_mfma_f32_16x16x32_bf16 v[60:63], v[120:123], v[132:135], v[60:63]
    ds_read_b128 v[112:115], v20 offset:32768
    v_mfma_f32_16x16x32_bf16 v[64:67], v[124:127], v[132:135], v[64:67]
    ds_read_b128 v[116:119], v20 offset:34816
    v_mfma_f32_16x16x32_bf16 v[68:71], v[120:123], v[136:139], v[68:71]
    s_add_u32 m0, s67, 0
    s_nop 0
    buffer_load_dwordx4 v10, s[28:31], s60 offen lds
    v_mfma_f32_16x16x32_bf16 v[72:75], v[124:127], v[136:139], v[72:75]
    s_add_u32 m0, s67, 1024
    s_nop 0
    buffer_load_dwordx4 v10, s[28:31], s61 offen lds
    v_mfma_f32_16x16x32_bf16 v[76:79], v[120:123], v[140:143], v[76:79]
    s_add_u32 m0, s67, 2048
    s_nop 0
    buffer_load_dwordx4 v10, s[28:31], s62 offen lds
    v_mfma_f32_16x16x32_bf16 v[80:83], v[124:127], v[140:143], v[80:83]
    s_add_u32 m0, s67, 3072
    s_nop 0
    buffer_load_dwordx4 v10, s[28:31], s63 offen lds
    v_mfma_f32_16x16x32_bf16 v[84:87], v[120:123], v[144:147], v[84:87]
    s_add_u32 m0, s68, 0
    s_nop 0
    buffer_load_dwordx4 v11, s[32:35], s64 offen lds
    v_mfma_f32_16x16x32_bf16 v[88:91], v[124:127], v[144:147], v[88:91]
    s_add_u32 m0, s68, 4096
    s_nop 0
    buffer_load_dwordx4 v11, s[32:35], s65 offen lds
    s_add_u32 s84, s84, 1
    s_cmp_eq_u32 s84, 10
    s_cselect_b32 s85, 1280, 0
    s_cselect_b32 s84, 0, s84
    s_sub_u32 s85, 128, s85
    v_add_u32 v10, s85, v10
    v_add_u32 v11, s85, v11
    s_waitcnt lgkmcnt(0)
    v_mfma_f32_16x16x32_bf16 v[52:55], v[92:95], v[100:103], v[52:55]
    ds_read_b128 v[120:123], v17 offset:26624
    v_mfma_f32_16x16x32_bf16 v[56:59], v[96:99], v[100:103], v[56:59]
    ds_read_b128 v[124:127], v17 offset:28672
    v_mfma_f32_16x16x32_bf16 v[60:63], v[92:95], v[104:107], v[60:63]
    ds_read_b128 v[128:131], v21 offset:26624
    v_mfma_f32_16x16x32_bf16 v[64:67], v[96:99], v[104:107], v[64:67]
    ds_read_b128 v[132:135], v21 offset:28672
    v_mfma_f32_16x16x32_bf16 v[68:71], v[92:95], v[108:111], v[68:71]
    ds_read_b128 v[136:139], v21 offset:30720
    v_mfma_f32_16x16x32_bf16 v[72:75], v[96:99], v[108:111], v[72:75]
    ds_read_b128 v[140:143], v21 offset:32768
    v_mfma_f32_16x16x32_bf16 v[76:79], v[92:95], v[112:115], v[76:79]
    ds_read_b128 v[144:147], v21 offset:34816
    v_mfma_f32_16x16x32_bf16 v[80:83], v[96:99], v[112:115], v[80:83]
    v_mfma_f32_16x16x32_bf16 v[84:87], v[92:95], v[116:119], v[84:87]
    v_mfma_f32_16x16x32_bf16 v[88:91], v[96:99], v[116:119], v[88:91]
    s_waitcnt lgkmcnt(0)
    s_waitcnt vmcnt(6)
    s_barrier
    ds_read_b128 v[92:95], v18 offset:0
    ds_read_b128 v[96:99], v18 offset:2048
    ds_read_b128 v[100:103], v22 offset:0
    v_mfma_f32_16x16x32_bf16 v[52:55], v[120:123], v[128:131], v[52:55]
    ds_read_b128 v[104:107], v22 offset:2048
    v_mfma_f32_16x16x32_bf16 v[56:59], v[124:127], v[128:131], v[56:59]
    ds_read_b128 v[108:111], v22 offset:4096
    v_mfma_f32_16x16x32_bf16 v[60:63], v[120:123], v[132:135], v[60:63]
    ds_read_b128 v[112:115], v22 offset:6144
    v_mfma_f32_16x16x32_bf16 v[64:67], v[124:127], v[132:135], v[64:67]
    ds_read_b128 v[116:119], v22 offset:8192
    v_mfma_f32_16x16x32_bf16 v[68:71], v[120:123], v[136:139], v[68:71]
    s_add_u32 m0, s67, 26624
    s_nop 0
    buffer_load_dwordx4 v10, s[28:31], s60 offen lds
    v_mfma_f32_16x16x32_bf16 v[72:75], v[124:127], v[136:139], v[72:75]
    s_add_u32 m0, s67, 27648
    s_nop 0
    buffer_load_dwordx4 v10, s[28:31], s61 offen lds
    v_mfma_f32_16x16x32_bf16 v[76:79], v[120:123], v[140:143], v[76:79]
    s_add_u32 m0, s67, 28672
    s_nop 0
    buffer_load_dwordx4 v10, s[28:31], s62 offen lds
    v_mfma_f32_16x16x32_bf16 v[80:83], v[124:127], v[140:143], v[80:83]
    s_add_u32 m0, s67, 29696
    s_nop 0
    buffer_load_dwordx4 v10, s[28:31], s63 offen lds
    v_mfma_f32_16x16x32_bf16 v[84:87], v[120:123], v[144:147], v[84:87]
    s_add_u32 m0, s68, 26624
    s_nop 0
    buffer_load_dwordx4 v11, s[32:35], s64 offen lds
    v_mfma_f32_16x16x32_bf16 v[88:91], v[124:127], v[144:147], v[88:91]
    s_add_u32 m0, s68, 30720
    s_nop 0
    buffer_load_dwordx4 v11, s[32:35], s65 offen lds
    s_add_u32 s84, s84, 1
    s_cmp_eq_u32 s84, 10
    s_cselect_b32 s85, 1280, 0
    s_cselect_b32 s84, 0, s84
    s_sub_u32 s85, 128, s85
    v_add_u32 v10, s85, v10
    v_add_u32 v11, s85, v11
    s_waitcnt lgkmcnt(0)
    v_mfma_f32_16x16x32_bf16 v[52:55], v[92:95], v[100:103], v[52:55]
    ds_read_b128 v[120:123], v19 offset:0
    v_mfma_f32_16x16x32_bf16 v[56:59], v[96:99], v[100:103], v[56:59]
    ds_read_b128 v[124:127], v19 offset:2048
    v_mfma_f32_16x16x32_bf16 v[60:63], v[92:95], v[104:107], v[60:63]
    ds_read_b128 v[128:131], v23 offset:0
    v_mfma_f32_16x16x32_bf16 v[64:67], v[96:99], v[104:107], v[64:67]
    ds_read_b128 v[132:135], v23 offset:2048
    v_mfma_f32_16x16x32_bf16 v[68:71], v[92:95], v[108:111], v[68:71]
    ds_read_b128 v[136:139], v23 offset:4096
    v_mfma_f32_16x16x32_bf16 v[72:75], v[96:99], v[108:111], v[72:75]
    ds_read_b128 v[140:143], v23 offset:6144
    v_mfma_f32_16x16x32_bf16 v[76:79], v[92:95], v[112:115], v[76:79]
    ds_read_b128 v[144:147], v23 offset:8192
    v_mfma_f32_16x16x32_bf16 v[80:83], v[96:99], v[112:115], v[80:83]
    ds_read_b128 v[148:151], v170 offset:0
    v_mfma_f32_16x16x32_bf16 v[84:87], v[92:95], v[116:119], v[84:87]
    ds_read_b128 v[152:155], v170 offset:128
    v_mfma_f32_16x16x32_bf16 v[88:91], v[96:99], v[116:119], v[88:91]
    ds_read_b128 v[156:159], v170 offset:256
    ds_read_b128 v[160:163], v170 offset:384
    ds_read_b128 v[164:167], v170 offset:512
    s_waitcnt lgkmcnt(0)
    s_waitcnt vmcnt(6)
    s_barrier
    ds_read_b128 v[92:95], v16 offset:0
    ds_read_b128 v[96:99], v16 offset:2048
    ds_read_b128 v[100:103], v20 offset:0
    v_mfma_f32_16x16x32_bf16 v[52:55], v[120:123], v[128:131], v[52:55]
    ds_read_b128 v[104:107], v20 offset:2048
    v_mfma_f32_16x16x32_bf16 v[56:59], v[124:127], v[128:131], v[56:59]
    ds_read_b128 v[108:111], v20 offset:4096
    v_mfma_f32_16x16x32_bf16 v[60:63], v[120:123], v[132:135], v[60:63]
    ds_read_b128 v[112:115], v20 offset:6144
    v_mfma_f32_16x16x32_bf16 v[64:67], v[124:127], v[132:135], v[64:67]
    ds_read_b128 v[116:119], v20 offset:8192
    v_mfma_f32_16x16x32_bf16 v[68:71], v[120:123], v[136:139], v[68:71]
    s_add_u32 m0, s67, 53248
    s_nop 0
    buffer_load_dwordx4 v10, s[28:31], s60 offen lds
    v_mfma_f32_16x16x32_bf16 v[72:75], v[124:127], v[136:139], v[72:75]
    s_add_u32 m0, s67, 54272
    s_nop 0
    buffer_load_dwordx4 v10, s[28:31], s61 offen lds
    v_mfma_f32_16x16x32_bf16 v[76:79], v[120:123], v[140:143], v[76:79]
    s_add_u32 m0, s67, 55296
    s_nop 0
    buffer_load_dwordx4 v10, s[28:31], s62 offen lds
    v_mfma_f32_16x16x32_bf16 v[80:83], v[124:127], v[140:143], v[80:83]
    s_add_u32 m0, s67, 56320
    s_nop 0
    buffer_load_dwordx4 v10, s[28:31], s63 offen lds
    v_mfma_f32_16x16x32_bf16 v[84:87], v[120:123], v[144:147], v[84:87]
    s_add_u32 m0, s68, 53248
    s_nop 0
    buffer_load_dwordx4 v11, s[32:35], s64 offen lds
    v_mfma_f32_16x16x32_bf16 v[88:91], v[124:127], v[144:147], v[88:91]
    s_add_u32 m0, s68, 57344
    s_nop 0
    buffer_load_dwordx4 v11, s[32:35], s65 offen lds
    s_add_u32 s84, s84, 1
    s_cmp_eq_u32 s84, 10
    s_cselect_b32 s85, 1280, 0
    s_cselect_b32 s84, 0, s84
    s_sub_u32 s85, 128, s85
    v_add_u32 v10, s85, v10
    v_add_u32 v11, s85, v11
    s_waitcnt lgkmcnt(0)
    v_mfma_f32_16x16x32_bf16 v[52:55], v[92:95], v[100:103], v[52:55]
    ds_read_b128 v[120:123], v17 offset:0
    v_xor_b32 v149, v168, v149
    v_xor_b32 v150, v169, v150
    v_mfma_f32_16x16x32_bf16 v[56:59], v[96:99], v[100:103], v[56:59]
    ds_read_b128 v[124:127], v17 offset:2048
    v_xor_b32 v153, v168, v153
    v_xor_b32 v154, v169, v154
    v_mfma_f32_16x16x32_bf16 v[60:63], v[92:95], v[104:107], v[60:63]
    ds_read_b128 v[128:131], v21 offset:0
    v_xor_b32 v157, v168, v157
    v_xor_b32 v158, v169, v158
    v_mfma_f32_16x16x32_bf16 v[64:67], v[96:99], v[104:107], v[64:67]
    ds_read_b128 v[132:135], v21 offset:2048
    v_xor_b32 v161, v168, v161
    v_xor_b32 v162, v169, v162
    v_mfma_f32_16x16x32_bf16 v[68:71], v[92:95], v[108:111], v[68:71]
    ds_read_b128 v[136:139], v21 offset:4096
    v_xor_b32 v165, v168, v165
    v_xor_b32 v166, v169, v166
    v_mfma_f32_16x16x32_bf16 v[72:75], v[96:99], v[108:111], v[72:75]
    ds_read_b128 v[140:143], v21 offset:6144
    v_mfma_f32_16x16x32_bf16 v[76:79], v[92:95], v[112:115], v[76:79]
    ds_read_b128 v[144:147], v21 offset:8192
    v_mfma_f32_16x16x32_bf16 v[80:83], v[96:99], v[112:115], v[80:83]
    v_mfma_f32_16x16x32_bf16 v[84:87], v[92:95], v[116:119], v[84:87]
    v_mfma_f32_16x16x32_bf16 v[88:91], v[96:99], v[116:119], v[88:91]
    s_waitcnt lgkmcnt(0)
    s_waitcnt vmcnt(6)
    s_barrier
    ds_read_b128 v[92:95], v16 offset:26624
    ds_read_b128 v[96:99], v16 offset:28672
    ds_read_b128 v[100:103], v20 offset:26624
    v_mfma_f32_16x16x32_bf16 v[52:55], v[120:123], v[128:131], v[52:55]
    ds_read_b128 v[104:107], v20 offset:28672
    v_mfma_f32_16x16x32_bf16 v[56:59], v[124:127], v[128:131], v[56:59]
    ds_read_b128 v[108:111], v20 offset:30720
    v_mfma_f32_16x16x32_bf16 v[60:63], v[120:123], v[132:135], v[60:63]
    ds_read_b128 v[112:115], v20 offset:32768
    v_mfma_f32_16x16x32_bf16 v[64:67], v[124:127], v[132:135], v[64:67]
    ds_read_b128 v[116:119], v20 offset:34816
    v_mfma_f32_16x16x32_bf16 v[68:71], v[120:123], v[136:139], v[68:71]
    s_add_u32 m0, s67, 0
    s_nop 0
    buffer_load_dwordx4 v10, s[28:31], s60 offen lds
    v_mfma_f32_16x16x32_bf16 v[72:75], v[124:127], v[136:139], v[72:75]
    s_add_u32 m0, s67, 1024
    s_nop 0
    buffer_load_dwordx4 v10, s[28:31], s61 offen lds
    v_mfma_f32_16x16x32_bf16 v[76:79], v[120:123], v[140:143], v[76:79]
    s_add_u32 m0, s67, 2048
    s_nop 0
    buffer_load_dwordx4 v10, s[28:31], s62 offen lds
    v_mfma_f32_16x16x32_bf16 v[80:83], v[124:127], v[140:143], v[80:83]
    s_add_u32 m0, s67, 3072
    s_nop 0
    buffer_load_dwordx4 v10, s[28:31], s63 offen lds
    v_mfma_f32_16x16x32_bf16 v[84:87], v[120:123], v[144:147], v[84:87]
    s_add_u32 m0, s68, 0
    s_nop 0
    buffer_load_dwordx4 v11, s[32:35], s64 offen lds
    v_mfma_f32_16x16x32_bf16 v[88:91], v[124:127], v[144:147], v[88:91]
    s_add_u32 m0, s68, 4096
    s_nop 0
    buffer_load_dwordx4 v11, s[32:35], s65 offen lds
    s_add_u32 s84, s84, 1
    s_cmp_eq_u32 s84, 10
    s_cselect_b32 s85, 1280, 0
    s_cselect_b32 s84, 0, s84
    s_sub_u32 s85, 128, s85
    v_add_u32 v10, s85, v10
    v_add_u32 v11, s85, v11
    s_waitcnt lgkmcnt(0)
    v_mfma_f32_16x16x32_bf16 v[52:55], v[92:95], v[100:103], v[52:55]
    ds_read_b128 v[120:123], v17 offset:26624
    v_mfma_f32_16x16x32_bf16 v[56:59], v[96:99], v[100:103], v[56:59]
    ds_read_b128 v[124:127], v17 offset:28672
    v_mfma_f32_16x16x32_bf16 v[60:63], v[92:95], v[104:107], v[60:63]
    ds_read_b128 v[128:131], v21 offset:26624
    v_mfma_f32_16x16x32_bf16 v[64:67], v[96:99], v[104:107], v[64:67]
    ds_read_b128 v[132:135], v21 offset:28672
    v_mfma_f32_16x16x32_bf16 v[68:71], v[92:95], v[108:111], v[68:71]
    ds_read_b128 v[136:139], v21 offset:30720
    v_mfma_f32_16x16x32_bf16 v[72:75], v[96:99], v[108:111], v[72:75]
    ds_read_b128 v[140:143], v21 offset:32768
    v_mfma_f32_16x16x32_bf16 v[76:79], v[92:95], v[112:115], v[76:79]
    ds_read_b128 v[144:147], v21 offset:34816
    v_mfma_f32_16x16x32_bf16 v[80:83], v[96:99], v[112:115], v[80:83]
    v_mfma_f32_16x16x32_bf16 v[84:87], v[92:95], v[116:119], v[84:87]
    v_mfma_f32_16x16x32_bf16 v[88:91], v[96:99], v[116:119], v[88:91]
    s_waitcnt lgkmcnt(0)
    s_waitcnt vmcnt(6)
    s_barrier
    ds_read_b128 v[92:95], v18 offset:0
    ds_read_b128 v[96:99], v18 offset:2048
    ds_read_b128 v[100:103], v22 offset:0
    v_mfma_f32_16x16x32_bf16 v[52:55], v[120:123], v[128:131], v[52:55]
    ds_read_b128 v[104:107], v22 offset:2048
    v_mfma_f32_16x16x32_bf16 v[56:59], v[124:127], v[128:131], v[56:59]
    ds_read_b128 v[108:111], v22 offset:4096
    v_mfma_f32_16x16x32_bf16 v[60:63], v[120:123], v[132:135], v[60:63]
    ds_read_b128 v[112:115], v22 offset:6144
    v_mfma_f32_16x16x32_bf16 v[64:67], v[124:127], v[132:135], v[64:67]
    ds_read_b128 v[116:119], v22 offset:8192
    v_mfma_f32_16x16x32_bf16 v[68:71], v[120:123], v[136:139], v[68:71]
    s_add_u32 m0, s67, 26624
    s_nop 0
    buffer_load_dwordx4 v10, s[28:31], s60 offen lds
    v_mfma_f32_16x16x32_bf16 v[72:75], v[124:127], v[136:139], v[72:75]
    s_add_u32 m0, s67, 27648
    s_nop 0
    buffer_load_dwordx4 v10, s[28:31], s61 offen lds
    v_mfma_f32_16x16x32_bf16 v[76:79], v[120:123], v[140:143], v[76:79]
    s_add_u32 m0, s67, 28672
    s_nop 0
    buffer_load_dwordx4 v10, s[28:31], s62 offen lds
    v_mfma_f32_16x16x32_bf16 v[80:83], v[124:127], v[140:143], v[80:83]
    s_add_u32 m0, s67, 29696
    s_nop 0
    buffer_load_dwordx4 v10, s[28:31], s63 offen lds
    v_mfma_f32_16x16x32_bf16 v[84:87], v[120:123], v[144:147], v[84:87]
    s_add_u32 m0, s68, 26624
    s_nop 0
    buffer_load_dwordx4 v11, s[32:35], s64 offen lds
    v_mfma_f32_16x16x32_bf16 v[88:91], v[124:127], v[144:147], v[88:91]
    s_add_u32 m0, s68, 30720
    s_nop 0
    buffer_load_dwordx4 v11, s[32:35], s65 offen lds
    s_add_u32 s84, s84, 1
    s_cmp_eq_u32 s84, 10
    s_cselect_b32 s85, 1280, 0
    s_cselect_b32 s84, 0, s84
    s_sub_u32 s85, 128, s85
    v_add_u32 v10, s85, v10
    v_add_u32 v11, s85, v11
    s_waitcnt lgkmcnt(0)
    v_mfma_f32_16x16x32_bf16 v[52:55], v[92:95], v[100:103], v[52:55]
    ds_read_b128 v[120:123], v19 offset:0
    v_mfma_f32_16x16x32_bf16 v[56:59], v[96:99], v[100:103], v[56:59]
    ds_read_b128 v[124:127], v19 offset:2048
    v_mfma_f32_16x16x32_bf16 v[60:63], v[92:95], v[104:107], v[60:63]
    ds_read_b128 v[128:131], v23 offset:0
    v_mfma_f32_16x16x32_bf16 v[64:67], v[96:99], v[104:107], v[64:67]
    ds_read_b128 v[132:135], v23 offset:2048
    v_mfma_f32_16x16x32_bf16 v[68:71], v[92:95], v[108:111], v[68:71]
    ds_read_b128 v[136:139], v23 offset:4096
    v_mfma_f32_16x16x32_bf16 v[72:75], v[96:99], v[108:111], v[72:75]
    ds_read_b128 v[140:143], v23 offset:6144
    v_mfma_f32_16x16x32_bf16 v[76:79], v[92:95], v[112:115], v[76:79]
    ds_read_b128 v[144:147], v23 offset:8192
    v_mfma_f32_16x16x32_bf16 v[80:83], v[96:99], v[112:115], v[80:83]
    v_mfma_f32_16x16x32_bf16 v[84:87], v[92:95], v[116:119], v[84:87]
    v_mfma_f32_16x16x32_bf16 v[88:91], v[96:99], v[116:119], v[88:91]
    s_waitcnt lgkmcnt(0)
    s_waitcnt vmcnt(6)
    s_barrier
    ds_read_b128 v[92:95], v16 offset:0
    ds_read_b128 v[96:99], v16 offset:2048
    ds_read_b128 v[100:103], v20 offset:0
    v_mfma_f32_16x16x32_bf16 v[52:55], v[120:123], v[128:131], v[52:55]
    ds_read_b128 v[104:107], v20 offset:2048
    v_mfma_f32_16x16x32_bf16 v[56:59], v[124:127], v[128:131], v[56:59]
    ds_read_b128 v[108:111], v20 offset:4096
    v_mfma_f32_16x16x32_bf16 v[60:63], v[120:123], v[132:135], v[60:63]
    ds_read_b128 v[112:115], v20 offset:6144
    v_mfma_f32_16x16x32_bf16 v[64:67], v[124:127], v[132:135], v[64:67]
    ds_read_b128 v[116:119], v20 offset:8192
    v_mfma_f32_16x16x32_bf16 v[68:71], v[120:123], v[136:139], v[68:71]
    s_add_u32 m0, s67, 53248
    s_nop 0
    buffer_load_dwordx4 v10, s[28:31], s60 offen lds
    v_mfma_f32_16x16x32_bf16 v[72:75], v[124:127], v[136:139], v[72:75]
    s_add_u32 m0, s67, 54272
    s_nop 0
    buffer_load_dwordx4 v10, s[28:31], s61 offen lds
    v_mfma_f32_16x16x32_bf16 v[76:79], v[120:123], v[140:143], v[76:79]
    s_add_u32 m0, s67, 55296
    s_nop 0
    buffer_load_dwordx4 v10, s[28:31], s62 offen lds
    v_mfma_f32_16x16x32_bf16 v[80:83], v[124:127], v[140:143], v[80:83]
    s_add_u32 m0, s67, 56320
    s_nop 0
    buffer_load_dwordx4 v10, s[28:31], s63 offen lds
    v_mfma_f32_16x16x32_bf16 v[84:87], v[120:123], v[144:147], v[84:87]
    s_add_u32 m0, s68, 53248
    s_nop 0
    buffer_load_dwordx4 v11, s[32:35], s64 offen lds
    v_mfma_f32_16x16x32_bf16 v[88:91], v[124:127], v[144:147], v[88:91]
    s_add_u32 m0, s68, 57344
    s_nop 0
    buffer_load_dwordx4 v11, s[32:35], s65 offen lds
    s_add_u32 s84, s84, 1
    s_cmp_eq_u32 s84, 10
    s_cselect_b32 s85, 1280, 0
    s_cselect_b32 s84, 0, s84
    s_sub_u32 s85, 128, s85
    v_add_u32 v10, s85, v10
    v_add_u32 v11, s85, v11
    s_waitcnt lgkmcnt(0)
    v_mfma_f32_16x16x32_bf16 v[52:55], v[92:95], v[100:103], v[52:55]
    ds_read_b128 v[120:123], v17 offset:0
    v_mfma_f32_16x16x32_bf16 v[56:59], v[96:99], v[100:103], v[56:59]
    ds_read_b128 v[124:127], v17 offset:2048
    v_mfma_f32_16x16x32_bf16 v[60:63], v[92:95], v[104:107], v[60:63]
    ds_read_b128 v[128:131], v21 offset:0
    v_mfma_f32_16x16x32_bf16 v[64:67], v[96:99], v[104:107], v[64:67]
    ds_read_b128 v[132:135], v21 offset:2048
    v_mfma_f32_16x16x32_bf16 v[68:71], v[92:95], v[108:111], v[68:71]
    ds_read_b128 v[136:139], v21 offset:4096
    v_mfma_f32_16x16x32_bf16 v[72:75], v[96:99], v[108:111], v[72:75]
    ds_read_b128 v[140:143], v21 offset:6144
    v_mfma_f32_16x16x32_bf16 v[76:79], v[92:95], v[112:115], v[76:79]
    ds_read_b128 v[144:147], v21 offset:8192
    v_mfma_f32_16x16x32_bf16 v[80:83], v[96:99], v[112:115], v[80:83]
    v_mfma_f32_16x16x32_bf16 v[84:87], v[92:95], v[116:119], v[84:87]
    v_mfma_f32_16x16x32_bf16 v[88:91], v[96:99], v[116:119], v[88:91]
    s_waitcnt lgkmcnt(0)
    s_waitcnt vmcnt(6)
    s_barrier
    ds_read_b128 v[92:95], v16 offset:26624
    ds_read_b128 v[96:99], v16 offset:28672
    ds_read_b128 v[100:103], v20 offset:26624
    v_mfma_f32_16x16x32_bf16 v[52:55], v[120:123], v[128:131], v[52:55]
    ds_read_b128 v[104:107], v20 offset:28672
    v_mfma_f32_16x16x32_bf16 v[56:59], v[124:127], v[128:131], v[56:59]
    ds_read_b128 v[108:111], v20 offset:30720
    v_mfma_f32_16x16x32_bf16 v[60:63], v[120:123], v[132:135], v[60:63]
    ds_read_b128 v[112:115], v20 offset:32768
    v_mfma_f32_16x16x32_bf16 v[64:67], v[124:127], v[132:135], v[64:67]
    ds_read_b128 v[116:119], v20 offset:34816
    v_mfma_f32_16x16x32_bf16 v[68:71], v[120:123], v[136:139], v[68:71]
    s_add_u32 m0, s67, 0
    s_nop 0
    buffer_load_dwordx4 v10, s[28:31], s60 offen lds
    v_mfma_f32_16x16x32_bf16 v[72:75], v[124:127], v[136:139], v[72:75]
    s_add_u32 m0, s67, 1024
    s_nop 0
    buffer_load_dwordx4 v10, s[28:31], s61 offen lds
    v_mfma_f32_16x16x32_bf16 v[76:79], v[120:123], v[140:143], v[76:79]
    s_add_u32 m0, s67, 2048
    s_nop 0
    buffer_load_dwordx4 v10, s[28:31], s62 offen lds
    v_mfma_f32_16x16x32_bf16 v[80:83], v[124:127], v[140:143], v[80:83]
    s_add_u32 m0, s67, 3072
    s_nop 0
    buffer_load_dwordx4 v10, s[28:31], s63 offen lds
    v_mfma_f32_16x16x32_bf16 v[84:87], v[120:123], v[144:147], v[84:87]
    s_add_u32 m0, s68, 0
    s_nop 0
    buffer_load_dwordx4 v11, s[32:35], s64 offen lds
    v_mfma_f32_16x16x32_bf16 v[88:91], v[124:127], v[144:147], v[88:91]
    s_add_u32 m0, s68, 4096
    s_nop 0
    buffer_load_dwordx4 v11, s[32:35], s65 offen lds
    s_add_u32 s84, s84, 1
    s_cmp_eq_u32 s84, 10
    s_cselect_b32 s85, 1280, 0
    s_cselect_b32 s84, 0, s84
    s_sub_u32 s85, 128, s85
    v_add_u32 v10, s85, v10
    v_add_u32 v11, s85, v11
    s_cmp_eq_u32 s52, 0
    s_cbranch_scc1 cpf_12
    s_lshr_b32 s55, s3, 3
    s_mul_i32 s55, s55, 3
    s_add_u32 s55, s55, s52
    s_sub_u32 s55, s55, 1
    s_mul_i32 s55, s55, 8576
    v_lshlrev_b32 v2, 7, v1
    v_add_u32 v2, s55, v2
    v_add_u32 v3, 8192, v2
    v_cmp_gt_u32 vcc, 3, v1
    v_mov_b32 v4, 0x7ff00000
    s_nop 0
    v_cndmask_b32 v3, v4, v3, vcc
    s_mov_b32 s36, s12
    s_and_b32 s37, s13, 0xffff
    s_mov_b32 s38, 819200
    s_mov_b32 s39, 0x00020000
    buffer_load_dword v0, v2, s[36:39], 0 offen
    buffer_load_dword v0, v3, s[36:39], 0 offen
    s_mov_b32 s36, s14
    s_and_b32 s37, s15, 0xffff
    s_mov_b32 s38, 819200
    s_mov_b32 s39, 0x00020000
    buffer_load_dword v0, v2, s[36:39], 0 offen
    buffer_load_dword v0, v3, s[36:39], 0 offen
cpf_12:
    s_waitcnt lgkmcnt(0)
    v_mfma_f32_16x16x32_bf16 v[52:55], v[92:95], v[100:103], v[52:55]
    ds_read_b128 v[120:123], v17 offset:26624
    v_mfma_f32_16x16x32_bf16 v[56:59], v[96:99], v[100:103], v[56:59]
    ds_read_b128 v[124:127], v17 offset:28672
    v_mfma_f32_16x16x32_bf16 v[60:63], v[92:95], v[104:107], v[60:63]
    ds_read_b128 v[128:131], v21 offset:26624
    v_mfma_f32_16x16x32_bf16 v[64:67], v[96:99], v[104:107], v[64:67]
    ds_read_b128 v[132:135], v21 offset:28672
    v_mfma_f32_16x16x32_bf16 v[68:71], v[92:95], v[108:111], v[68:71]
    ds_read_b128 v[136:139], v21 offset:30720
    v_mfma_f32_16x16x32_bf16 v[72:75], v[96:99], v[108:111], v[72:75]
    ds_read_b128 v[140:143], v21 offset:32768
    v_mfma_f32_16x16x32_bf16 v[76:79], v[92:95], v[112:115], v[76:79]
    ds_read_b128 v[144:147], v21 offset:34816
    v_mfma_f32_16x16x32_bf16 v[80:83], v[96:99], v[112:115], v[80:83]
    v_mfma_f32_16x16x32_bf16 v[84:87], v[92:95], v[116:119], v[84:87]
    v_mfma_f32_16x16x32_bf16 v[88:91], v[96:99], v[116:119], v[88:91]
    s_waitcnt lgkmcnt(0)
    s_cmp_eq_u32 s52, 0
    s_cbranch_scc1 ws0_13
    s_waitcnt vmcnt(10)
    s_branch ws1_14
ws0_13:
    s_waitcnt vmcnt(6)
ws1_14:
    s_barrier
    ds_read_b128 v[92:95], v18 offset:0
    ds_read_b128 v[96:99], v18 offset:2048
    ds_read_b128 v[100:103], v22 offset:0
    v_mfma_f32_16x16x32_bf16 v[52:55], v[120:123], v[128:131], v[52:55]
    ds_read_b128 v[104:107], v22 offset:2048
    v_mfma_f32_16x16x32_bf16 v[56:59], v[124:127], v[128:131], v[56:59]
    ds_read_b128 v[108:111], v22 offset:4096
    v_mfma_f32_16x16x32_bf16 v[60:63], v[120:123], v[132:135], v[60:63]
    ds_read_b128 v[112:115], v22 offset:6144
    v_mfma_f32_16x16x32_bf16 v[64:67], v[124:127], v[132:135], v[64:67]
    ds_read_b128 v[116:119], v22 offset:8192
    v_mfma_f32_16x16x32_bf16 v[68:71], v[120:123], v[136:139], v[68:71]
    v_mfma_f32_16x16x32_bf16 v[72:75], v[124:127], v[136:139], v[72:75]
    v_mfma_f32_16x16x32_bf16 v[76:79], v[120:123], v[140:143], v[76:79]
    v_mfma_f32_16x16x32_bf16 v[80:83], v[124:127], v[140:143], v[80:83]
    v_mfma_f32_16x16x32_bf16 v[84:87], v[120:123], v[144:147], v[84:87]
    v_mfma_f32_16x16x32_bf16 v[88:91], v[124:127], v[144:147], v[88:91]
    s_waitcnt lgkmcnt(0)
    v_mfma_f32_16x16x32_bf16 v[52:55], v[92:95], v[100:103], v[52:55]
    ds_read_b128 v[120:123], v19 offset:0
    v_mfma_f32_16x16x32_bf16 v[56:59], v[96:99], v[100:103], v[56:59]
    ds_read_b128 v[124:127], v19 offset:2048
    v_mfma_f32_16x16x32_bf16 v[60:63], v[92:95], v[104:107], v[60:63]
    ds_read_b128 v[128:131], v23 offset:0
    v_mfma_f32_16x16x32_bf16 v[64:67], v[96:99], v[104:107], v[64:67]
    ds_read_b128 v[132:135], v23 offset:2048
    v_mfma_f32_16x16x32_bf16 v[68:71], v[92:95], v[108:111], v[68:71]
    ds_read_b128 v[136:139], v23 offset:4096
    v_mfma_f32_16x16x32_bf16 v[72:75], v[96:99], v[108:111], v[72:75]
    ds_read_b128 v[140:143], v23 offset:6144
    v_mfma_f32_16x16x32_bf16 v[76:79], v[92:95], v[112:115], v[76:79]
    ds_read_b128 v[144:147], v23 offset:8192
    v_mfma_f32_16x16x32_bf16 v[80:83], v[96:99], v[112:115], v[80:83]
    v_mfma_f32_16x16x32_bf16 v[84:87], v[92:95], v[116:119], v[84:87]
    v_mfma_f32_16x16x32_bf16 v[88:91], v[96:99], v[116:119], v[88:91]
    s_waitcnt lgkmcnt(0)
    s_cmp_eq_u32 s52, 0
    s_cbranch_scc1 ws0_15
    s_waitcnt vmcnt(4)
    s_branch ws1_16
ws0_15:
    s_waitcnt vmcnt(0)
ws1_16:
    s_barrier
    ds_read_b128 v[92:95], v16 offset:0
    ds_read_b128 v[96:99], v16 offset:2048
    ds_read_b128 v[100:103], v20 offset:0
    v_mfma_f32_16x16x32_bf16 v[52:55], v[120:123], v[128:131], v[52:55]
    ds_read_b128 v[104:107], v20 offset:2048
    v_mfma_f32_16x16x32_bf16 v[56:59], v[124:127], v[128:131], v[56:59]
    ds_read_b128 v[108:111], v20 offset:4096
    v_mfma_f32_16x16x32_bf16 v[60:63], v[120:123], v[132:135], v[60:63]
    ds_read_b128 v[112:115], v20 offset:6144
    v_mfma_f32_16x16x32_bf16 v[64:67], v[124:127], v[132:135], v[64:67]
    ds_read_b128 v[116:119], v20 offset:8192
    v_mfma_f32_16x16x32_bf16 v[68:71], v[120:123], v[136:139], v[68:71]
    v_mfma_f32_16x16x32_bf16 v[72:75], v[124:127], v[136:139], v[72:75]
    v_mfma_f32_16x16x32_bf16 v[76:79], v[120:123], v[140:143], v[76:79]
    v_mfma_f32_16x16x32_bf16 v[80:83], v[124:127], v[140:143], v[80:83]
    v_mfma_f32_16x16x32_bf16 v[84:87], v[120:123], v[144:147], v[84:87]
    v_mfma_f32_16x16x32_bf16 v[88:91], v[124:127], v[144:147], v[88:91]
    s_waitcnt lgkmcnt(0)
    v_mfma_f32_16x16x32_bf16 v[52:55], v[92:95], v[100:103], v[52:55]
    ds_read_b128 v[120:123], v17 offset:0
    v_mfma_f32_16x16x32_bf16 v[56:59], v[96:99], v[100:103], v[56:59]
    ds_read_b128 v[124:127], v17 offset:2048
    v_mfma_f32_16x16x32_bf16 v[60:63], v[92:95], v[104:107], v[60:63]
    ds_read_b128 v[128:131], v21 offset:0
    v_mfma_f32_16x16x32_bf16 v[64:67], v[96:99], v[104:107], v[64:67]
    ds_read_b128 v[132:135], v21 offset:2048
    v_mfma_f32_16x16x32_bf16 v[68:71], v[92:95], v[108:111], v[68:71]
    ds_read_b128 v[136:139], v21 offset:4096
    v_mfma_f32_16x16x32_bf16 v[72:75], v[96:99], v[108:111], v[72:75]
    ds_read_b128 v[140:143], v21 offset:6144
    v_mfma_f32_16x16x32_bf16 v[76:79], v[92:95], v[112:115], v[76:79]
    ds_read_b128 v[144:147], v21 offset:8192
    v_mfma_f32_16x16x32_bf16 v[80:83], v[96:99], v[112:115], v[80:83]
    v_mfma_f32_16x16x32_bf16 v[84:87], v[92:95], v[116:119], v[84:87]
    v_mfma_f32_16x16x32_bf16 v[88:91], v[96:99], v[116:119], v[88:91]
    s_waitcnt lgkmcnt(0)
    v_mfma_f32_16x16x32_bf16 v[52:55], v[120:123], v[128:131], v[52:55]
    v_mfma_f32_16x16x32_bf16 v[56:59], v[124:127], v[128:131], v[56:59]
    v_mfma_f32_16x16x32_bf16 v[60:63], v[120:123], v[132:135], v[60:63]
    v_mfma_f32_16x16x32_bf16 v[64:67], v[124:127], v[132:135], v[64:67]
    v_mfma_f32_16x16x32_bf16 v[68:71], v[120:123], v[136:139], v[68:71]
    v_mfma_f32_16x16x32_bf16 v[72:75], v[124:127], v[136:139], v[72:75]
    v_mfma_f32_16x16x32_bf16 v[76:79], v[120:123], v[140:143], v[76:79]
    v_mfma_f32_16x16x32_bf16 v[80:83], v[124:127], v[140:143], v[80:83]
    v_mfma_f32_16x16x32_bf16 v[84:87], v[120:123], v[144:147], v[84:87]
    v_mfma_f32_16x16x32_bf16 v[88:91], v[124:127], v[144:147], v[88:91]
g1loopend_6:
    s_lshl_b32 s55, s52, 2
    v_add_u32 v182, s55, v14
    v_mul_u32_u24 v182, 320, v182
    v_add_u32 v182, v182, v24
    s_nop 4
    v_fma_f32 v177, v148, v52, v53
    v_fma_f32 v178, v152, v60, v61
    v_fma_f32 v179, v156, v68, v69
    v_fma_f32 v180, v160, v76, v77
    v_fma_f32 v181, v164, v84, v85
    v_fmac_f32_dpp v177, v52, v149 quad_perm:[1,0,3,2] row_mask:0xf bank_mask:0xf
    v_fmac_f32_dpp v178, v60, v153 quad_perm:[1,0,3,2] row_mask:0xf bank_mask:0xf
    v_fmac_f32_dpp v179, v68, v157 quad_perm:[1,0,3,2] row_mask:0xf bank_mask:0xf
    v_fmac_f32_dpp v180, v76, v161 quad_perm:[1,0,3,2] row_mask:0xf bank_mask:0xf
    v_fmac_f32_dpp v181, v84, v165 quad_perm:[1,0,3,2] row_mask:0xf bank_mask:0xf
    v_fma_f32 v172, v148, v177, v54
    v_fma_f32 v173, v152, v178, v62
    v_fma_f32 v174, v156, v179, v70
    v_fma_f32 v175, v160, v180, v78
    v_fma_f32 v176, v164, v181, v86
    v_fmac_f32_dpp v172, v177, v149 quad_perm:[1,0,3,2] row_mask:0xf bank_mask:0xf
    v_fmac_f32_dpp v173, v178, v153 quad_perm:[1,0,3,2] row_mask:0xf bank_mask:0xf
    v_fmac_f32_dpp v174, v179, v157 quad_perm:[1,0,3,2] row_mask:0xf bank_mask:0xf
    v_fmac_f32_dpp v175, v180, v161 quad_perm:[1,0,3,2] row_mask:0xf bank_mask:0xf
    v_fmac_f32_dpp v176, v181, v165 quad_perm:[1,0,3,2] row_mask:0xf bank_mask:0xf
    v_fma_f32 v177, v148, v172, v55
    v_fma_f32 v178, v152, v173, v63
    v_fma_f32 v179, v156, v174, v71
    v_fma_f32 v180, v160, v175, v79
    v_fma_f32 v181, v164, v176, v87
    v_fmac_f32_dpp v177, v172, v149 quad_perm:[1,0,3,2] row_mask:0xf bank_mask:0xf
    v_fmac_f32_dpp v178, v173, v153 quad_perm:[1,0,3,2] row_mask:0xf bank_mask:0xf
    v_fmac_f32_dpp v179, v174, v157 quad_perm:[1,0,3,2] row_mask:0xf bank_mask:0xf
    v_fmac_f32_dpp v180, v175, v161 quad_perm:[1,0,3,2] row_mask:0xf bank_mask:0xf
    v_fmac_f32_dpp v181, v176, v165 quad_perm:[1,0,3,2] row_mask:0xf bank_mask:0xf
    v_fma_f32 v172, v148, v177, v56
    v_fma_f32 v173, v152, v178, v64
    v_fma_f32 v174, v156, v179, v72
    v_fma_f32 v175, v160, v180, v80
    v_fma_f32 v176, v164, v181, v88
    v_fmac_f32_dpp v172, v177, v149 quad_perm:[1,0,3,2] row_mask:0xf bank_mask:0xf
    v_fmac_f32_dpp v173, v178, v153 quad_perm:[1,0,3,2] row_mask:0xf bank_mask:0xf
    v_fmac_f32_dpp v174, v179, v157 quad_perm:[1,0,3,2] row_mask:0xf bank_mask:0xf
    v_fmac_f32_dpp v175, v180, v161 quad_perm:[1,0,3,2] row_mask:0xf bank_mask:0xf
    v_fmac_f32_dpp v176, v181, v165 quad_perm:[1,0,3,2] row_mask:0xf bank_mask:0xf
    v_fma_f32 v177, v148, v172, v57
    v_fma_f32 v178, v152, v173, v65
    v_fma_f32 v179, v156, v174, v73
    v_fma_f32 v180, v160, v175, v81
    v_fma_f32 v181, v164, v176, v89
    v_fmac_f32_dpp v177, v172, v149 quad_perm:[1,0,3,2] row_mask:0xf bank_mask:0xf
    v_fmac_f32_dpp v178, v173, v153 quad_perm:[1,0,3,2] row_mask:0xf bank_mask:0xf
    v_fmac_f32_dpp v179, v174, v157 quad_perm:[1,0,3,2] row_mask:0xf bank_mask:0xf
    v_fmac_f32_dpp v180, v175, v161 quad_perm:[1,0,3,2] row_mask:0xf bank_mask:0xf
    v_fmac_f32_dpp v181, v176, v165 quad_perm:[1,0,3,2] row_mask:0xf bank_mask:0xf
    v_fma_f32 v172, v148, v177, v58
    v_fma_f32 v173, v152, v178, v66
    v_fma_f32 v174, v156, v179, v74
    v_fma_f32 v175, v160, v180, v82
    v_fma_f32 v176, v164, v181, v90
    v_fmac_f32_dpp v172, v177, v149 quad_perm:[1,0,3,2] row_mask:0xf bank_mask:0xf
    v_fmac_f32_dpp v173, v178, v153 quad_perm:[1,0,3,2] row_mask:0xf bank_mask:0xf
    v_fmac_f32_dpp v174, v179, v157 quad_perm:[1,0,3,2] row_mask:0xf bank_mask:0xf
    v_fmac_f32_dpp v175, v180, v161 quad_perm:[1,0,3,2] row_mask:0xf bank_mask:0xf
    v_fmac_f32_dpp v176, v181, v165 quad_perm:[1,0,3,2] row_mask:0xf bank_mask:0xf
    v_fma_f32 v177, v148, v172, v59
    v_fma_f32 v178, v152, v173, v67
    v_fma_f32 v179, v156, v174, v75
    v_fma_f32 v180, v160, v175, v83
    v_fma_f32 v181, v164, v176, v91
    v_fmac_f32_dpp v177, v172, v149 quad_perm:[1,0,3,2] row_mask:0xf bank_mask:0xf
    v_fmac_f32_dpp v178, v173, v153 quad_perm:[1,0,3,2] row_mask:0xf bank_mask:0xf
    v_fmac_f32_dpp v179, v174, v157 quad_perm:[1,0,3,2] row_mask:0xf bank_mask:0xf
    v_fmac_f32_dpp v180, v175, v161 quad_perm:[1,0,3,2] row_mask:0xf bank_mask:0xf
    v_fmac_f32_dpp v181, v176, v165 quad_perm:[1,0,3,2] row_mask:0xf bank_mask:0xf
    ds_write_b32 v182, v177 offset:26624
    ds_write_b32 v182, v178 offset:26688
    ds_write_b32 v182, v179 offset:26752
    ds_write_b32 v182, v180 offset:26816
    ds_write_b32 v182, v181 offset:26880
    s_add_u32 s28, s26, 5242880
    s_addc_u32 s29, s27, 0
    s_and_b32 s29, s29, 0xffff
    s_mov_b32 s30, 163840
    s_mov_b32 s31, 0x00020000
    v_lshlrev_b32 v183, 3, v1
    v_lshlrev_b32 v184, 4, v1
    v_min_u32 v185, 39, v1
    v_lshlrev_b32 v185, 4, v185
    s_mul_i32 s9, s54, 10240
    s_waitcnt lgkmcnt(0)
    s_barrier
    s_cmp_lg_u32 s52, 0
    s_cbranch_scc1 g1nw0a_17
    ds_read_b64 v[92:93], v183 offset:26624
    ds_read_b64 v[94:95], v183 offset:26944
    ds_read_b64 v[96:97], v183 offset:27264
    ds_read_b64 v[98:99], v183 offset:27584
    ds_read_b64 v[100:101], v183 offset:27904
    ds_read_b64 v[102:103], v183 offset:28224
    ds_read_b64 v[104:105], v183 offset:28544
    ds_read_b64 v[106:107], v183 offset:28864
    ds_read_b64 v[108:109], v183 offset:29184
    ds_read_b64 v[110:111], v183 offset:29504
    ds_read_b64 v[112:113], v183 offset:29824
    ds_read_b64 v[114:115], v183 offset:30144
    ds_read_b64 v[116:117], v183 offset:30464
    ds_read_b64 v[118:119], v183 offset:30784
    ds_read_b64 v[120:121], v183 offset:31104
    ds_read_b64 v[122:123], v183 offset:31424
    s_lshl_b32 s55, s54, 4
    s_add_u32 s55, s55, s53
    s_mul_i32 s55, s55, 640
    v_mov_b32 v130, s74
    v_mov_b32 v131, s74
    s_waitcnt lgkmcnt(0)
    v_pk_fma_f32 v[126:127], v[40:41], v[92:93], v[94:95] op_sel:[0,0,0] op_sel_hi:[0,1,1]
    v_pk_fma_f32 v[126:127], v[40:41], v[92:93], v[126:127] op_sel:[1,1,0] op_sel_hi:[1,0,1] neg_lo:[1,0,0]
    v_pk_fma_f32 v[190:191], v[40:41], v[108:109], v[110:111] op_sel:[0,0,0] op_sel_hi:[0,1,1]
    v_pk_fma_f32 v[190:191], v[40:41], v[108:109], v[190:191] op_sel:[1,1,0] op_sel_hi:[1,0,1] neg_lo:[1,0,0]
    v_pk_fma_f32 v[124:125], v[40:41], v[126:127], v[96:97] op_sel:[0,0,0] op_sel_hi:[0,1,1]
    v_pk_fma_f32 v[124:125], v[40:41], v[126:127], v[124:125] op_sel:[1,1,0] op_sel_hi:[1,0,1] neg_lo:[1,0,0]
    v_pk_fma_f32 v[188:189], v[40:41], v[190:191], v[112:113] op_sel:[0,0,0] op_sel_hi:[0,1,1]
    v_pk_fma_f32 v[188:189], v[40:41], v[190:191], v[188:189] op_sel:[1,1,0] op_sel_hi:[1,0,1] neg_lo:[1,0,0]
    v_pk_fma_f32 v[126:127], v[40:41], v[124:125], v[98:99] op_sel:[0,0,0] op_sel_hi:[0,1,1]
    v_pk_fma_f32 v[126:127], v[40:41], v[124:125], v[126:127] op_sel:[1,1,0] op_sel_hi:[1,0,1] neg_lo:[1,0,0]
    v_pk_fma_f32 v[190:191], v[40:41], v[188:189], v[114:115] op_sel:[0,0,0] op_sel_hi:[0,1,1]
    v_pk_fma_f32 v[190:191], v[40:41], v[188:189], v[190:191] op_sel:[1,1,0] op_sel_hi:[1,0,1] neg_lo:[1,0,0]
    v_pk_fma_f32 v[124:125], v[40:41], v[126:127], v[100:101] op_sel:[0,0,0] op_sel_hi:[0,1,1]
    v_pk_fma_f32 v[124:125], v[40:41], v[126:127], v[124:125] op_sel:[1,1,0] op_sel_hi:[1,0,1] neg_lo:[1,0,0]
    v_pk_fma_f32 v[188:189], v[40:41], v[190:191], v[116:117] op_sel:[0,0,0] op_sel_hi:[0,1,1]
    v_pk_fma_f32 v[188:189], v[40:41], v[190:191], v[188:189] op_sel:[1,1,0] op_sel_hi:[1,0,1] neg_lo:[1,0,0]
    v_pk_fma_f32 v[126:127], v[40:41], v[124:125], v[102:103] op_sel:[0,0,0] op_sel_hi:[0,1,1]
    v_pk_fma_f32 v[126:127], v[40:41], v[124:125], v[126:127] op_sel:[1,1,0] op_sel_hi:[1,0,1] neg_lo:[1,0,0]
    v_pk_fma_f32 v[190:191], v[40:41], v[188:189], v[118:119] op_sel:[0,0,0] op_sel_hi:[0,1,1]
    v_pk_fma_f32 v[190:191], v[40:41], v[188:189], v[190:191] op_sel:[1,1,0] op_sel_hi:[1,0,1] neg_lo:[1,0,0]
    v_pk_fma_f32 v[124:125], v[40:41], v[126:127], v[104:105] op_sel:[0,0,0] op_sel_hi:[0,1,1]
    v_pk_fma_f32 v[124:125], v[40:41], v[126:127], v[124:125] op_sel:[1,1,0] op_sel_hi:[1,0,1] neg_lo:[1,0,0]
    v_pk_fma_f32 v[188:189], v[40:41], v[190:191], v[120:121] op_sel:[0,0,0] op_sel_hi:[0,1,1]
    v_pk_fma_f32 v[188:189], v[40:41], v[190:191], v[188:189] op_sel:[1,1,0] op_sel_hi:[1,0,1] neg_lo:[1,0,0]
    v_pk_fma_f32 v[126:127], v[40:41], v[124:125], v[106:107] op_sel:[0,0,0] op_sel_hi:[0,1,1]
    v_pk_fma_f32 v[126:127], v[40:41], v[124:125], v[126:127] op_sel:[1,1,0] op_sel_hi:[1,0,1] neg_lo:[1,0,0]
    v_pk_fma_f32 v[190:191], v[40:41], v[188:189], v[122:123] op_sel:[0,0,0] op_sel_hi:[0,1,1]
    v_pk_fma_f32 v[190:191], v[40:41], v[188:189], v[190:191] op_sel:[1,1,0] op_sel_hi:[1,0,1] neg_lo:[1,0,0]
    v_pk_fma_f32 v[128:129], v[42:43], v[126:127], v[190:191] op_sel:[0,0,0] op_sel_hi:[0,1,1]
    v_pk_fma_f32 v[128:129], v[42:43], v[126:127], v[128:129] op_sel:[1,1,0] op_sel_hi:[1,0,1] neg_lo:[1,0,0]
    v_cmp_gt_u32 vcc, 40, v1
    s_and_saveexec_b64 s[70:71], vcc
    buffer_store_dwordx4 v[128:131], v184, s[28:31], s55 offen sc1
    s_mov_b64 exec, s[70:71]
    v_mov_b32 v6, v46
    v_sub_f32 v7, 0, v46
    v_mov_b32 v8, v47
    v_mov_b32 v9, v47
    v_pk_mul_f32 v[124:125], v[6:7], v[92:93]
    v_pk_fma_f32 v[92:93], v[8:9], v[92:93], v[124:125] op_sel:[0,1,0] op_sel_hi:[1,0,1]
    v_pk_mul_f32 v[124:125], v[6:7], v[94:95]
    v_pk_fma_f32 v[94:95], v[8:9], v[94:95], v[124:125] op_sel:[0,1,0] op_sel_hi:[1,0,1]
    v_pk_mul_f32 v[124:125], v[6:7], v[96:97]
    v_pk_fma_f32 v[96:97], v[8:9], v[96:97], v[124:125] op_sel:[0,1,0] op_sel_hi:[1,0,1]
    v_pk_mul_f32 v[124:125], v[6:7], v[98:99]
    v_pk_fma_f32 v[98:99], v[8:9], v[98:99], v[124:125] op_sel:[0,1,0] op_sel_hi:[1,0,1]
    v_pk_mul_f32 v[124:125], v[6:7], v[100:101]
    v_pk_fma_f32 v[100:101], v[8:9], v[100:101], v[124:125] op_sel:[0,1,0] op_sel_hi:[1,0,1]
    v_pk_mul_f32 v[124:125], v[6:7], v[102:103]
    v_pk_fma_f32 v[102:103], v[8:9], v[102:103], v[124:125] op_sel:[0,1,0] op_sel_hi:[1,0,1]
    v_pk_mul_f32 v[124:125], v[6:7], v[104:105]
    v_pk_fma_f32 v[104:105], v[8:9], v[104:105], v[124:125] op_sel:[0,1,0] op_sel_hi:[1,0,1]
    v_pk_mul_f32 v[124:125], v[6:7], v[106:107]
    v_pk_fma_f32 v[106:107], v[8:9], v[106:107], v[124:125] op_sel:[0,1,0] op_sel_hi:[1,0,1]
    v_pk_mul_f32 v[124:125], v[6:7], v[108:109]
    v_pk_fma_f32 v[108:109], v[8:9], v[108:109], v[124:125] op_sel:[0,1,0] op_sel_hi:[1,0,1]
    v_pk_mul_f32 v[124:125], v[6:7], v[110:111]
    v_pk_fma_f32 v[110:111], v[8:9], v[110:111], v[124:125] op_sel:[0,1,0] op_sel_hi:[1,0,1]
    v_pk_mul_f32 v[124:125], v[6:7], v[112:113]
    v_pk_fma_f32 v[112:113], v[8:9], v[112:113], v[124:125] op_sel:[0,1,0] op_sel_hi:[1,0,1]
    v_pk_mul_f32 v[124:125], v[6:7], v[114:115]
    v_pk_fma_f32 v[114:115], v[8:9], v[114:115], v[124:125] op_sel:[0,1,0] op_sel_hi:[1,0,1]
    v_pk_mul_f32 v[124:125], v[6:7], v[116:117]
    v_pk_fma_f32 v[116:117], v[8:9], v[116:117], v[124:125] op_sel:[0,1,0] op_sel_hi:[1,0,1]
    v_pk_mul_f32 v[124:125], v[6:7], v[118:119]
    v_pk_fma_f32 v[118:119], v[8:9], v[118:119], v[124:125] op_sel:[0,1,0] op_sel_hi:[1,0,1]
    v_pk_mul_f32 v[124:125], v[6:7], v[120:121]
    v_pk_fma_f32 v[120:121], v[8:9], v[120:121], v[124:125] op_sel:[0,1,0] op_sel_hi:[1,0,1]
    v_pk_mul_f32 v[124:125], v[6:7], v[122:123]
    v_pk_fma_f32 v[122:123], v[8:9], v[122:123], v[124:125] op_sel:[0,1,0] op_sel_hi:[1,0,1]
    v_pk_fma_f32 v[126:127], v[40:41], v[92:93], v[94:95] op_sel:[0,0,0] op_sel_hi:[0,1,1]
    v_pk_fma_f32 v[126:127], v[40:41], v[92:93], v[126:127] op_sel:[1,1,0] op_sel_hi:[1,0,1] neg_hi:[1,0,0]
    v_pk_fma_f32 v[124:125], v[40:41], v[126:127], v[96:97] op_sel:[0,0,0] op_sel_hi:[0,1,1]
    v_pk_fma_f32 v[124:125], v[40:41], v[126:127], v[124:125] op_sel:[1,1,0] op_sel_hi:[1,0,1] neg_hi:[1,0,0]
    v_pk_fma_f32 v[126:127], v[40:41], v[124:125], v[98:99] op_sel:[0,0,0] op_sel_hi:[0,1,1]
    v_pk_fma_f32 v[126:127], v[40:41], v[124:125], v[126:127] op_sel:[1,1,0] op_sel_hi:[1,0,1] neg_hi:[1,0,0]
    v_pk_fma_f32 v[124:125], v[40:41], v[126:127], v[100:101] op_sel:[0,0,0] op_sel_hi:[0,1,1]
    v_pk_fma_f32 v[124:125], v[40:41], v[126:127], v[124:125] op_sel:[1,1,0] op_sel_hi:[1,0,1] neg_hi:[1,0,0]
    v_pk_fma_f32 v[126:127], v[40:41], v[124:125], v[102:103] op_sel:[0,0,0] op_sel_hi:[0,1,1]
    v_pk_fma_f32 v[126:127], v[40:41], v[124:125], v[126:127] op_sel:[1,1,0] op_sel_hi:[1,0,1] neg_hi:[1,0,0]
    v_pk_fma_f32 v[124:125], v[40:41], v[126:127], v[104:105] op_sel:[0,0,0] op_sel_hi:[0,1,1]
    v_pk_fma_f32 v[124:125], v[40:41], v[126:127], v[124:125] op_sel:[1,1,0] op_sel_hi:[1,0,1] neg_hi:[1,0,0]
    v_pk_fma_f32 v[36:37], v[40:41], v[124:125], v[106:107] op_sel:[0,0,0] op_sel_hi:[0,1,1]
    v_pk_fma_f32 v[36:37], v[40:41], v[124:125], v[36:37] op_sel:[1,1,0] op_sel_hi:[1,0,1] neg_hi:[1,0,0]
g1nw0a_17:
    v_mul_f32 v28, v150, v52
    v_mul_f32 v29, v150, v53
    v_mul_f32 v30, v150, v54
    v_mul_f32 v31, v150, v55
    v_mul_f32 v32, v150, v56
    v_mul_f32 v33, v150, v57
    v_mul_f32 v34, v150, v58
    v_mul_f32 v35, v150, v59
    v_fmac_f32_dpp v28, v52, v151 quad_perm:[1,0,3,2] row_mask:0xf bank_mask:0xf
    v_fmac_f32_dpp v29, v53, v151 quad_perm:[1,0,3,2] row_mask:0xf bank_mask:0xf
    v_fmac_f32_dpp v30, v54, v151 quad_perm:[1,0,3,2] row_mask:0xf bank_mask:0xf
    v_fmac_f32_dpp v31, v55, v151 quad_perm:[1,0,3,2] row_mask:0xf bank_mask:0xf
    v_fmac_f32_dpp v32, v56, v151 quad_perm:[1,0,3,2] row_mask:0xf bank_mask:0xf
    v_fmac_f32_dpp v33, v57, v151 quad_perm:[1,0,3,2] row_mask:0xf bank_mask:0xf
    v_fmac_f32_dpp v34, v58, v151 quad_perm:[1,0,3,2] row_mask:0xf bank_mask:0xf
    v_fmac_f32_dpp v35, v59, v151 quad_perm:[1,0,3,2] row_mask:0xf bank_mask:0xf
    v_mul_f32 v52, v154, v60
    v_mul_f32 v53, v154, v61
    v_mul_f32 v54, v154, v62
    v_mul_f32 v55, v154, v63
    v_mul_f32 v56, v154, v64
    v_mul_f32 v57, v154, v65
    v_mul_f32 v58, v154, v66
    v_mul_f32 v59, v154, v67
    v_fmac_f32_dpp v52, v60, v155 quad_perm:[1,0,3,2] row_mask:0xf bank_mask:0xf
    v_fmac_f32_dpp v53, v61, v155 quad_perm:[1,0,3,2] row_mask:0xf bank_mask:0xf
    v_fmac_f32_dpp v54, v62, v155 quad_perm:[1,0,3,2] row_mask:0xf bank_mask:0xf
    v_fmac_f32_dpp v55, v63, v155 quad_perm:[1,0,3,2] row_mask:0xf bank_mask:0xf
    v_fmac_f32_dpp v56, v64, v155 quad_perm:[1,0,3,2] row_mask:0xf bank_mask:0xf
    v_fmac_f32_dpp v57, v65, v155 quad_perm:[1,0,3,2] row_mask:0xf bank_mask:0xf
    v_fmac_f32_dpp v58, v66, v155 quad_perm:[1,0,3,2] row_mask:0xf bank_mask:0xf
    v_fmac_f32_dpp v59, v67, v155 quad_perm:[1,0,3,2] row_mask:0xf bank_mask:0xf
    v_mul_f32 v60, v158, v68
    v_mul_f32 v61, v158, v69
    v_mul_f32 v62, v158, v70
    v_mul_f32 v63, v158, v71
    v_mul_f32 v64, v158, v72
    v_mul_f32 v65, v158, v73
    v_mul_f32 v66, v158, v74
    v_mul_f32 v67, v158, v75
    v_fmac_f32_dpp v60, v68, v159 quad_perm:[1,0,3,2] row_mask:0xf bank_mask:0xf
    v_fmac_f32_dpp v61, v69, v159 quad_perm:[1,0,3,2] row_mask:0xf bank_mask:0xf
    v_fmac_f32_dpp v62, v70, v159 quad_perm:[1,0,3,2] row_mask:0xf bank_mask:0xf
    v_fmac_f32_dpp v63, v71, v159 quad_perm:[1,0,3,2] row_mask:0xf bank_mask:0xf
    v_fmac_f32_dpp v64, v72, v159 quad_perm:[1,0,3,2] row_mask:0xf bank_mask:0xf
    v_fmac_f32_dpp v65, v73, v159 quad_perm:[1,0,3,2] row_mask:0xf bank_mask:0xf
    v_fmac_f32_dpp v66, v74, v159 quad_perm:[1,0,3,2] row_mask:0xf bank_mask:0xf
    v_fmac_f32_dpp v67, v75, v159 quad_perm:[1,0,3,2] row_mask:0xf bank_mask:0xf
    v_mul_f32 v68, v162, v76
    v_mul_f32 v69, v162, v77
    v_mul_f32 v70, v162, v78
    v_mul_f32 v71, v162, v79
    v_mul_f32 v72, v162, v80
    v_mul_f32 v73, v162, v81
    v_mul_f32 v74, v162, v82
    v_mul_f32 v75, v162, v83
    v_fmac_f32_dpp v68, v76, v163 quad_perm:[1,0,3,2] row_mask:0xf bank_mask:0xf
    v_fmac_f32_dpp v69, v77, v163 quad_perm:[1,0,3,2] row_mask:0xf bank_mask:0xf
    v_fmac_f32_dpp v70, v78, v163 quad_perm:[1,0,3,2] row_mask:0xf bank_mask:0xf
    v_fmac_f32_dpp v71, v79, v163 quad_perm:[1,0,3,2] row_mask:0xf bank_mask:0xf
    v_fmac_f32_dpp v72, v80, v163 quad_perm:[1,0,3,2] row_mask:0xf bank_mask:0xf
    v_fmac_f32_dpp v73, v81, v163 quad_perm:[1,0,3,2] row_mask:0xf bank_mask:0xf
    v_fmac_f32_dpp v74, v82, v163 quad_perm:[1,0,3,2] row_mask:0xf bank_mask:0xf
    v_fmac_f32_dpp v75, v83, v163 quad_perm:[1,0,3,2] row_mask:0xf bank_mask:0xf
    v_mul_f32 v76, v166, v84
    v_mul_f32 v77, v166, v85
    v_mul_f32 v78, v166, v86
    v_mul_f32 v79, v166, v87
    v_mul_f32 v80, v166, v88
    v_mul_f32 v81, v166, v89
    v_mul_f32 v82, v166, v90
    v_mul_f32 v83, v166, v91
    v_fmac_f32_dpp v76, v84, v167 quad_perm:[1,0,3,2] row_mask:0xf bank_mask:0xf
    v_fmac_f32_dpp v77, v85, v167 quad_perm:[1,0,3,2] row_mask:0xf bank_mask:0xf
    v_fmac_f32_dpp v78, v86, v167 quad_perm:[1,0,3,2] row_mask:0xf bank_mask:0xf
    v_fmac_f32_dpp v79, v87, v167 quad_perm:[1,0,3,2] row_mask:0xf bank_mask:0xf
    v_fmac_f32_dpp v80, v88, v167 quad_perm:[1,0,3,2] row_mask:0xf bank_mask:0xf
    v_fmac_f32_dpp v81, v89, v167 quad_perm:[1,0,3,2] row_mask:0xf bank_mask:0xf
    v_fmac_f32_dpp v82, v90, v167 quad_perm:[1,0,3,2] row_mask:0xf bank_mask:0xf
    v_fmac_f32_dpp v83, v91, v167 quad_perm:[1,0,3,2] row_mask:0xf bank_mask:0xf
    v_sub_f32 v149, 0, v149
    v_sub_f32 v153, 0, v153
    v_sub_f32 v157, 0, v157
    v_sub_f32 v161, 0, v161
    v_sub_f32 v165, 0, v165
    v_mul_u32_u24 v232, 288, v13
    s_lshl_b32 s55, s52, 6
    v_lshlrev_b32 v2, 4, v14
    v_add3_u32 v232, v232, v2, s55
    v_lshrrev_b32 v2, 2, v13
    v_and_b32 v3, 3, v13
    v_and_b32 v236, 1, v14
    v_lshrrev_b32 v235, 1, v14
    v_lshlrev_b32 v2, 1, v2
    v_add_u32 v2, v2, v236
    v_mul_u32_u24 v2, 288, v2
    v_lshlrev_b32 v3, 3, v3
    v_add3_u32 v2, v2, v3, s55
    v_mul_u32_u24 v3, 4608, v235
    v_add_u32 v233, v2, v3
    v_lshlrev_b32 v3, 5, v235
    v_add_u32 v234, v2, v3
    s_add_u32 s40, s26, 0
    s_addc_u32 s41, s27, 0
    s_and_b32 s41, s41, 0xffff
    s_mov_b32 s42, 5242880
    s_mov_b32 s43, 0x00020000
    s_lshl_b32 s55, s53, 3
    s_lshl_b32 s56, s52, 1
    s_add_u32 s55, s55, s56
    s_mul_i32 s55, s55, 40960
    s_mul_i32 s56, s54, 5
    v_lshlrev_b32 v4, 9, v236
    v_lshlrev_b32 v5, 4, v13
    v_add3_u32 v4, v4, v5, s55
    v_add_u32 v2, 0, v235
    v_add_u32 v2, s56, v2
    v_lshrrev_b32 v3, 1, v2
    v_lshlrev_b32 v3, 10, v3
    v_and_b32 v2, 1, v2
    v_lshlrev_b32 v2, 8, v2
    v_add3_u32 v238, v2, v3, v4
    v_add_u32 v2, 2, v235
    v_add_u32 v2, s56, v2
    v_lshrrev_b32 v3, 1, v2
    v_lshlrev_b32 v3, 10, v3
    v_and_b32 v2, 1, v2
    v_lshlrev_b32 v2, 8, v2
    v_add3_u32 v239, v2, v3, v4
    v_mov_b32 v2, 4
    v_add_u32 v2, s56, v2
    v_lshrrev_b32 v3, 1, v2
    v_lshlrev_b32 v3, 10, v3
    v_and_b32 v2, 1, v2
    v_lshlrev_b32 v2, 8, v2
    v_add3_u32 v240, v2, v3, v4
    v_mul_u32_u24 v2, 40960, v235
    v_add_u32 v240, v240, v2
    v_add_u32 v2, 0, v235
    v_add_u32 v2, s56, v2
    v_lshrrev_b32 v3, 1, v2
    v_lshlrev_b32 v3, 10, v3
    v_and_b32 v2, 1, v2
    v_lshlrev_b32 v2, 8, v2
    v_add3_u32 v241, v2, v3, v4
    v_add_u32 v241, 40960, v241
    v_add_u32 v2, 2, v235
    v_add_u32 v2, s56, v2
    v_lshrrev_b32 v3, 1, v2
    v_lshlrev_b32 v3, 10, v3
    v_and_b32 v2, 1, v2
    v_lshlrev_b32 v2, 8, v2
    v_add3_u32 v242, v2, v3, v4
    v_add_u32 v242, 40960, v242
    s_mov_b32 s36, s18
    s_and_b32 s37, s19, 0xffff
    s_mov_b32 s38, 1280
    s_mov_b32 s39, 0x00020000
    s_mul_i32 s55, s76, 160
    v_min_u32 v2, 39, v1
    v_lshlrev_b32 v2, 2, v2
    buffer_load_dword v25, v2, s[36:39], s55 offen
    s_cmp_lg_u32 s52, 0
    s_cbranch_scc1 g1nw0b_18
    v_mov_b32 v124, 0
    v_mov_b32 v125, 0
    s_cmp_eq_u32 s53, 0
    s_cbranch_scc1 g1horn_21
    s_mov_b32 s8, 0
    s_cmp_gt_u32 s53, 0
    s_cbranch_scc0 g1lb2_22
    buffer_load_dwordx4 v[188:191], v185, s[28:31], s9 offen offset:0 sc1
    s_cmp_gt_u32 s53, 1
    s_cbranch_scc0 g1lb2_22
    buffer_load_dwordx4 v[192:195], v185, s[28:31], s9 offen offset:640 sc1
    s_cmp_gt_u32 s53, 2
    s_cbranch_scc0 g1lb2_22
    buffer_load_dwordx4 v[196:199], v185, s[28:31], s9 offen offset:1280 sc1
    s_cmp_gt_u32 s53, 3
    s_cbranch_scc0 g1lb2_22
    buffer_load_dwordx4 v[200:203], v185, s[28:31], s9 offen offset:1920 sc1
    s_cmp_gt_u32 s53, 4
    s_cbranch_scc0 g1lb2_22
    buffer_load_dwordx4 v[204:207], v185, s[28:31], s9 offen offset:2560 sc1
    s_cmp_gt_u32 s53, 5
    s_cbranch_scc0 g1lb2_22
    buffer_load_dwordx4 v[208:211], v185, s[28:31], s9 offen offset:3200 sc1
    s_cmp_gt_u32 s53, 6
    s_cbranch_scc0 g1lb2_22
    buffer_load_dwordx4 v[212:215], v185, s[28:31], s9 offen offset:3840 sc1
    s_cmp_gt_u32 s53, 7
    s_cbranch_scc0 g1lb2_22
    s_add_u32 s56, s9, 4480
    buffer_load_dwordx4 v[216:219], v185, s[28:31], s56 offen sc1
    s_cmp_gt_u32 s53, 8
    s_cbranch_scc0 g1lb2_22
    s_add_u32 s56, s9, 5120
    buffer_load_dwordx4 v[220:223], v185, s[28:31], s56 offen sc1
    s_cmp_gt_u32 s53, 9
    s_cbranch_scc0 g1lb2_22
    s_add_u32 s56, s9, 5760
    buffer_load_dwordx4 v[224:227], v185, s[28:31], s56 offen sc1
    s_cmp_gt_u32 s53, 10
    s_cbranch_scc0 g1lb2_22
    s_add_u32 s56, s9, 6400
    buffer_load_dwordx4 v[228:231], v185, s[28:31], s56 offen sc1
    s_cmp_gt_u32 s53, 11
    s_cbranch_scc0 g1lb2_22
    s_add_u32 s56, s9, 7040
    buffer_load_dwordx4 v[132:135], v185, s[28:31], s56 offen sc1
    s_cmp_gt_u32 s53, 12
    s_cbranch_scc0 g1lb2_22
    s_add_u32 s56, s9, 7680
    buffer_load_dwordx4 v[136:139], v185, s[28:31], s56 offen sc1
    s_cmp_gt_u32 s53, 13
    s_cbranch_scc0 g1lb2_22
    s_add_u32 s56, s9, 8320
    buffer_load_dwordx4 v[140:143], v185, s[28:31], s56 offen sc1
    s_cmp_gt_u32 s53, 14
    s_cbranch_scc0 g1lb2_22
    s_add_u32 s56, s9, 8960
    buffer_load_dwordx4 v[144:147], v185, s[28:31], s56 offen sc1
g1lb2_22:
g1poll_19:
    s_waitcnt vmcnt(0)
    v_mov_b32 v4, 0
    s_cmp_gt_u32 s53, 0
    s_cbranch_scc0 g1chk_23
    v_xor_b32 v2, s74, v190
    v_xor_b32 v3, s74, v191
    v_or3_b32 v4, v4, v2, v3
    s_cmp_gt_u32 s53, 1
    s_cbranch_scc0 g1chk_23
    v_xor_b32 v2, s74, v194
    v_xor_b32 v3, s74, v195
    v_or3_b32 v4, v4, v2, v3
    s_cmp_gt_u32 s53, 2
    s_cbranch_scc0 g1chk_23
    v_xor_b32 v2, s74, v198
    v_xor_b32 v3, s74, v199
    v_or3_b32 v4, v4, v2, v3
    s_cmp_gt_u32 s53, 3
    s_cbranch_scc0 g1chk_23
    v_xor_b32 v2, s74, v202
    v_xor_b32 v3, s74, v203
    v_or3_b32 v4, v4, v2, v3
    s_cmp_gt_u32 s53, 4
    s_cbranch_scc0 g1chk_23
    v_xor_b32 v2, s74, v206
    v_xor_b32 v3, s74, v207
    v_or3_b32 v4, v4, v2, v3
    s_cmp_gt_u32 s53, 5
    s_cbranch_scc0 g1chk_23
    v_xor_b32 v2, s74, v210
    v_xor_b32 v3, s74, v211
    v_or3_b32 v4, v4, v2, v3
    s_cmp_gt_u32 s53, 6
    s_cbranch_scc0 g1chk_23
    v_xor_b32 v2, s74, v214
    v_xor_b32 v3, s74, v215
    v_or3_b32 v4, v4, v2, v3
    s_cmp_gt_u32 s53, 7
    s_cbranch_scc0 g1chk_23
    v_xor_b32 v2, s74, v218
    v_xor_b32 v3, s74, v219
    v_or3_b32 v4, v4, v2, v3
    s_cmp_gt_u32 s53, 8
    s_cbranch_scc0 g1chk_23
    v_xor_b32 v2, s74, v222
    v_xor_b32 v3, s74, v223
    v_or3_b32 v4, v4, v2, v3
    s_cmp_gt_u32 s53, 9
    s_cbranch_scc0 g1chk_23
    v_xor_b32 v2, s74, v226
    v_xor_b32 v3, s74, v227
    v_or3_b32 v4, v4, v2, v3
    s_cmp_gt_u32 s53, 10
    s_cbranch_scc0 g1chk_23
    v_xor_b32 v2, s74, v230
    v_xor_b32 v3, s74, v231
    v_or3_b32 v4, v4, v2, v3
    s_cmp_gt_u32 s53, 11
    s_cbranch_scc0 g1chk_23
    v_xor_b32 v2, s74, v134
    v_xor_b32 v3, s74, v135
    v_or3_b32 v4, v4, v2, v3
    s_cmp_gt_u32 s53, 12
    s_cbranch_scc0 g1chk_23
    v_xor_b32 v2, s74, v138
    v_xor_b32 v3, s74, v139
    v_or3_b32 v4, v4, v2, v3
    s_cmp_gt_u32 s53, 13
    s_cbranch_scc0 g1chk_23
    v_xor_b32 v2, s74, v142
    v_xor_b32 v3, s74, v143
    v_or3_b32 v4, v4, v2, v3
    s_cmp_gt_u32 s53, 14
    s_cbranch_scc0 g1chk_23
    v_xor_b32 v2, s74, v146
    v_xor_b32 v3, s74, v147
    v_or3_b32 v4, v4, v2, v3
g1chk_23:
    v_cmp_eq_u32 vcc, 0, v4
    s_nop 4
    s_cmp_eq_u64 vcc, -1
    s_cbranch_scc1 g1got_20
    s_add_u32 s8, s8, 1
    s_cmp_ge_u32 s8, 100000
    s_cbranch_scc1 g1got_20
    s_cmp_gt_u32 s53, 0
    s_cbranch_scc0 g1re_24
    buffer_load_dwordx4 v[188:191], v185, s[28:31], s9 offen offset:0 sc1
    s_cmp_gt_u32 s53, 1
    s_cbranch_scc0 g1re_24
    buffer_load_dwordx4 v[192:195], v185, s[28:31], s9 offen offset:640 sc1
    s_cmp_gt_u32 s53, 2
    s_cbranch_scc0 g1re_24
    buffer_load_dwordx4 v[196:199], v185, s[28:31], s9 offen offset:1280 sc1
    s_cmp_gt_u32 s53, 3
    s_cbranch_scc0 g1re_24
    buffer_load_dwordx4 v[200:203], v185, s[28:31], s9 offen offset:1920 sc1
    s_cmp_gt_u32 s53, 4
    s_cbranch_scc0 g1re_24
    buffer_load_dwordx4 v[204:207], v185, s[28:31], s9 offen offset:2560 sc1
    s_cmp_gt_u32 s53, 5
    s_cbranch_scc0 g1re_24
    buffer_load_dwordx4 v[208:211], v185, s[28:31], s9 offen offset:3200 sc1
    s_cmp_gt_u32 s53, 6
    s_cbranch_scc0 g1re_24
    buffer_load_dwordx4 v[212:215], v185, s[28:31], s9 offen offset:3840 sc1
    s_cmp_gt_u32 s53, 7
    s_cbranch_scc0 g1re_24
    s_add_u32 s56, s9, 4480
    buffer_load_dwordx4 v[216:219], v185, s[28:31], s56 offen sc1
    s_cmp_gt_u32 s53, 8
    s_cbranch_scc0 g1re_24
    s_add_u32 s56, s9, 5120
    buffer_load_dwordx4 v[220:223], v185, s[28:31], s56 offen sc1
    s_cmp_gt_u32 s53, 9
    s_cbranch_scc0 g1re_24
    s_add_u32 s56, s9, 5760
    buffer_load_dwordx4 v[224:227], v185, s[28:31], s56 offen sc1
    s_cmp_gt_u32 s53, 10
    s_cbranch_scc0 g1re_24
    s_add_u32 s56, s9, 6400
    buffer_load_dwordx4 v[228:231], v185, s[28:31], s56 offen sc1
    s_cmp_gt_u32 s53, 11
    s_cbranch_scc0 g1re_24
    s_add_u32 s56, s9, 7040
    buffer_load_dwordx4 v[132:135], v185, s[28:31], s56 offen sc1
    s_cmp_gt_u32 s53, 12
    s_cbranch_scc0 g1re_24
    s_add_u32 s56, s9, 7680
    buffer_load_dwordx4 v[136:139], v185, s[28:31], s56 offen sc1
    s_cmp_gt_u32 s53, 13
    s_cbranch_scc0 g1re_24
    s_add_u32 s56, s9, 8320
    buffer_load_dwordx4 v[140:143], v185, s[28:31], s56 offen sc1
    s_cmp_gt_u32 s53, 14
    s_cbranch_scc0 g1re_24
    s_add_u32 s56, s9, 8960
    buffer_load_dwordx4 v[144:147], v185, s[28:31], s56 offen sc1
g1re_24:
    s_branch g1poll_19
g1got_20:
    s_cmp_gt_u32 s53, 0
    s_cbranch_scc0 g1hd0_25
    v_pk_fma_f32 v[126:127], v[44:45], v[124:125], v[188:189] op_sel:[0,0,0] op_sel_hi:[0,1,1]
    v_pk_fma_f32 v[126:127], v[44:45], v[124:125], v[126:127] op_sel:[1,1,0] op_sel_hi:[1,0,1] neg_lo:[1,0,0]
    s_cmp_gt_u32 s53, 1
    s_cbranch_scc0 g1hd1_26
    v_pk_fma_f32 v[124:125], v[44:45], v[126:127], v[192:193] op_sel:[0,0,0] op_sel_hi:[0,1,1]
    v_pk_fma_f32 v[124:125], v[44:45], v[126:127], v[124:125] op_sel:[1,1,0] op_sel_hi:[1,0,1] neg_lo:[1,0,0]
    s_cmp_gt_u32 s53, 2
    s_cbranch_scc0 g1hd0_25
    v_pk_fma_f32 v[126:127], v[44:45], v[124:125], v[196:197] op_sel:[0,0,0] op_sel_hi:[0,1,1]
    v_pk_fma_f32 v[126:127], v[44:45], v[124:125], v[126:127] op_sel:[1,1,0] op_sel_hi:[1,0,1] neg_lo:[1,0,0]
    s_cmp_gt_u32 s53, 3
    s_cbranch_scc0 g1hd1_26
    v_pk_fma_f32 v[124:125], v[44:45], v[126:127], v[200:201] op_sel:[0,0,0] op_sel_hi:[0,1,1]
    v_pk_fma_f32 v[124:125], v[44:45], v[126:127], v[124:125] op_sel:[1,1,0] op_sel_hi:[1,0,1] neg_lo:[1,0,0]
    s_cmp_gt_u32 s53, 4
    s_cbranch_scc0 g1hd0_25
    v_pk_fma_f32 v[126:127], v[44:45], v[124:125], v[204:205] op_sel:[0,0,0] op_sel_hi:[0,1,1]
    v_pk_fma_f32 v[126:127], v[44:45], v[124:125], v[126:127] op_sel:[1,1,0] op_sel_hi:[1,0,1] neg_lo:[1,0,0]
    s_cmp_gt_u32 s53, 5
    s_cbranch_scc0 g1hd1_26
    v_pk_fma_f32 v[124:125], v[44:45], v[126:127], v[208:209] op_sel:[0,0,0] op_sel_hi:[0,1,1]
    v_pk_fma_f32 v[124:125], v[44:45], v[126:127], v[124:125] op_sel:[1,1,0] op_sel_hi:[1,0,1] neg_lo:[1,0,0]
    s_cmp_gt_u32 s53, 6
    s_cbranch_scc0 g1hd0_25
    v_pk_fma_f32 v[126:127], v[44:45], v[124:125], v[212:213] op_sel:[0,0,0] op_sel_hi:[0,1,1]
    v_pk_fma_f32 v[126:127], v[44:45], v[124:125], v[126:127] op_sel:[1,1,0] op_sel_hi:[1,0,1] neg_lo:[1,0,0]
    s_cmp_gt_u32 s53, 7
    s_cbranch_scc0 g1hd1_26
    v_pk_fma_f32 v[124:125], v[44:45], v[126:127], v[216:217] op_sel:[0,0,0] op_sel_hi:[0,1,1]
    v_pk_fma_f32 v[124:125], v[44:45], v[126:127], v[124:125] op_sel:[1,1,0] op_sel_hi:[1,0,1] neg_lo:[1,0,0]
    s_cmp_gt_u32 s53, 8
    s_cbranch_scc0 g1hd0_25
    v_pk_fma_f32 v[126:127], v[44:45], v[124:125], v[220:221] op_sel:[0,0,0] op_sel_hi:[0,1,1]
    v_pk_fma_f32 v[126:127], v[44:45], v[124:125], v[126:127] op_sel:[1,1,0] op_sel_hi:[1,0,1] neg_lo:[1,0,0]
    s_cmp_gt_u32 s53, 9
    s_cbranch_scc0 g1hd1_26
    v_pk_fma_f32 v[124:125], v[44:45], v[126:127], v[224:225] op_sel:[0,0,0] op_sel_hi:[0,1,1]
    v_pk_fma_f32 v[124:125], v[44:45], v[126:127], v[124:125] op_sel:[1,1,0] op_sel_hi:[1,0,1] neg_lo:[1,0,0]
    s_cmp_gt_u32 s53, 10
    s_cbranch_scc0 g1hd0_25
    v_pk_fma_f32 v[126:127], v[44:45], v[124:125], v[228:229] op_sel:[0,0,0] op_sel_hi:[0,1,1]
    v_pk_fma_f32 v[126:127], v[44:45], v[124:125], v[126:127] op_sel:[1,1,0] op_sel_hi:[1,0,1] neg_lo:[1,0,0]
    s_cmp_gt_u32 s53, 11
    s_cbranch_scc0 g1hd1_26
    v_pk_fma_f32 v[124:125], v[44:45], v[126:127], v[132:133] op_sel:[0,0,0] op_sel_hi:[0,1,1]
    v_pk_fma_f32 v[124:125], v[44:45], v[126:127], v[124:125] op_sel:[1,1,0] op_sel_hi:[1,0,1] neg_lo:[1,0,0]
    s_cmp_gt_u32 s53, 12
    s_cbranch_scc0 g1hd0_25
    v_pk_fma_f32 v[126:127], v[44:45], v[124:125], v[136:137] op_sel:[0,0,0] op_sel_hi:[0,1,1]
    v_pk_fma_f32 v[126:127], v[44:45], v[124:125], v[126:127] op_sel:[1,1,0] op_sel_hi:[1,0,1] neg_lo:[1,0,0]
    s_cmp_gt_u32 s53, 13
    s_cbranch_scc0 g1hd1_26
    v_pk_fma_f32 v[124:125], v[44:45], v[126:127], v[140:141] op_sel:[0,0,0] op_sel_hi:[0,1,1]
    v_pk_fma_f32 v[124:125], v[44:45], v[126:127], v[124:125] op_sel:[1,1,0] op_sel_hi:[1,0,1] neg_lo:[1,0,0]
    s_cmp_gt_u32 s53, 14
    s_cbranch_scc0 g1hd0_25
    v_pk_fma_f32 v[126:127], v[44:45], v[124:125], v[144:145] op_sel:[0,0,0] op_sel_hi:[0,1,1]
    v_pk_fma_f32 v[126:127], v[44:45], v[124:125], v[126:127] op_sel:[1,1,0] op_sel_hi:[1,0,1] neg_lo:[1,0,0]
    s_branch g1hd1_26
g1hd1_26:
    v_mov_b32 v124, v126
    v_mov_b32 v125, v127
g1hd0_25:
g1horn_21:
    v_pk_mul_f32 v[126:127], v[6:7], v[124:125]
    v_pk_fma_f32 v[124:125], v[8:9], v[124:125], v[126:127] op_sel:[0,1,0] op_sel_hi:[1,0,1]
    v_pk_fma_f32 v[188:189], v[42:43], v[124:125], v[36:37] op_sel:[0,0,0] op_sel_hi:[0,1,1]
    v_pk_fma_f32 v[188:189], v[42:43], v[124:125], v[188:189] op_sel:[1,1,0] op_sel_hi:[1,0,1] neg_hi:[1,0,0]
    v_cmp_gt_u32 vcc, 40, v1
    s_and_saveexec_b64 s[70:71], vcc
    ds_write_b64 v183, v[124:125] offset:31744
    ds_write_b64 v183, v[188:189] offset:34304
    v_pk_fma_f32 v[126:127], v[40:41], v[124:125], v[92:93] op_sel:[0,0,0] op_sel_hi:[0,1,1]
    v_pk_fma_f32 v[126:127], v[40:41], v[124:125], v[126:127] op_sel:[1,1,0] op_sel_hi:[1,0,1] neg_hi:[1,0,0]
    v_pk_fma_f32 v[190:191], v[40:41], v[188:189], v[108:109] op_sel:[0,0,0] op_sel_hi:[0,1,1]
    v_pk_fma_f32 v[190:191], v[40:41], v[188:189], v[190:191] op_sel:[1,1,0] op_sel_hi:[1,0,1] neg_hi:[1,0,0]
    ds_write_b64 v183, v[126:127] offset:32064
    ds_write_b64 v183, v[190:191] offset:34624
    v_pk_fma_f32 v[124:125], v[40:41], v[126:127], v[94:95] op_sel:[0,0,0] op_sel_hi:[0,1,1]
    v_pk_fma_f32 v[124:125], v[40:41], v[126:127], v[124:125] op_sel:[1,1,0] op_sel_hi:[1,0,1] neg_hi:[1,0,0]
    v_pk_fma_f32 v[188:189], v[40:41], v[190:191], v[110:111] op_sel:[0,0,0] op_sel_hi:[0,1,1]
    v_pk_fma_f32 v[188:189], v[40:41], v[190:191], v[188:189] op_sel:[1,1,0] op_sel_hi:[1,0,1] neg_hi:[1,0,0]
    ds_write_b64 v183, v[124:125] offset:32384
    ds_write_b64 v183, v[188:189] offset:34944
    v_pk_fma_f32 v[126:127], v[40:41], v[124:125], v[96:97] op_sel:[0,0,0] op_sel_hi:[0,1,1]
    v_pk_fma_f32 v[126:127], v[40:41], v[124:125], v[126:127] op_sel:[1,1,0] op_sel_hi:[1,0,1] neg_hi:[1,0,0]
    v_pk_fma_f32 v[190:191], v[40:41], v[188:189], v[112:113] op_sel:[0,0,0] op_sel_hi:[0,1,1]
    v_pk_fma_f32 v[190:191], v[40:41], v[188:189], v[190:191] op_sel:[1,1,0] op_sel_hi:[1,0,1] neg_hi:[1,0,0]
    ds_write_b64 v183, v[126:127] offset:32704
    ds_write_b64 v183, v[190:191] offset:35264
    v_pk_fma_f32 v[124:125], v[40:41], v[126:127], v[98:99] op_sel:[0,0,0] op_sel_hi:[0,1,1]
    v_pk_fma_f32 v[124:125], v[40:41], v[126:127], v[124:125] op_sel:[1,1,0] op_sel_hi:[1,0,1] neg_hi:[1,0,0]
    v_pk_fma_f32 v[188:189], v[40:41], v[190:191], v[114:115] op_sel:[0,0,0] op_sel_hi:[0,1,1]
    v_pk_fma_f32 v[188:189], v[40:41], v[190:191], v[188:189] op_sel:[1,1,0] op_sel_hi:[1,0,1] neg_hi:[1,0,0]
    ds_write_b64 v183, v[124:125] offset:33024
    ds_write_b64 v183, v[188:189] offset:35584
    v_pk_fma_f32 v[126:127], v[40:41], v[124:125], v[100:101] op_sel:[0,0,0] op_sel_hi:[0,1,1]
    v_pk_fma_f32 v[126:127], v[40:41], v[124:125], v[126:127] op_sel:[1,1,0] op_sel_hi:[1,0,1] neg_hi:[1,0,0]
    v_pk_fma_f32 v[190:191], v[40:41], v[188:189], v[116:117] op_sel:[0,0,0] op_sel_hi:[0,1,1]
    v_pk_fma_f32 v[190:191], v[40:41], v[188:189], v[190:191] op_sel:[1,1,0] op_sel_hi:[1,0,1] neg_hi:[1,0,0]
    ds_write_b64 v183, v[126:127] offset:33344
    ds_write_b64 v183, v[190:191] offset:35904
    v_pk_fma_f32 v[124:125], v[40:41], v[126:127], v[102:103] op_sel:[0,0,0] op_sel_hi:[0,1,1]
    v_pk_fma_f32 v[124:125], v[40:41], v[126:127], v[124:125] op_sel:[1,1,0] op_sel_hi:[1,0,1] neg_hi:[1,0,0]
    v_pk_fma_f32 v[188:189], v[40:41], v[190:191], v[118:119] op_sel:[0,0,0] op_sel_hi:[0,1,1]
    v_pk_fma_f32 v[188:189], v[40:41], v[190:191], v[188:189] op_sel:[1,1,0] op_sel_hi:[1,0,1] neg_hi:[1,0,0]
    ds_write_b64 v183, v[124:125] offset:33664
    ds_write_b64 v183, v[188:189] offset:36224
    v_pk_fma_f32 v[126:127], v[40:41], v[124:125], v[104:105] op_sel:[0,0,0] op_sel_hi:[0,1,1]
    v_pk_fma_f32 v[126:127], v[40:41], v[124:125], v[126:127] op_sel:[1,1,0] op_sel_hi:[1,0,1] neg_hi:[1,0,0]
    v_pk_fma_f32 v[190:191], v[40:41], v[188:189], v[120:121] op_sel:[0,0,0] op_sel_hi:[0,1,1]
    v_pk_fma_f32 v[190:191], v[40:41], v[188:189], v[190:191] op_sel:[1,1,0] op_sel_hi:[1,0,1] neg_hi:[1,0,0]
    ds_write_b64 v183, v[126:127] offset:33984
    ds_write_b64 v183, v[190:191] offset:36544
    s_mov_b64 exec, s[70:71]
    s_waitcnt lgkmcnt(0)
g1nw0b_18:
    s_barrier
    ds_read_b32 v172, v182 offset:31744
    ds_read_b32 v173, v182 offset:31808
    ds_read_b32 v174, v182 offset:31872
    ds_read_b32 v175, v182 offset:31936
    ds_read_b32 v176, v182 offset:32000
    s_waitcnt lgkmcnt(0)
    v_fma_f32 v28, v148, v172, v28
    v_fma_f32 v52, v152, v173, v52
    v_fma_f32 v60, v156, v174, v60
    v_fma_f32 v68, v160, v175, v68
    v_fma_f32 v76, v164, v176, v76
    v_fmac_f32_dpp v28, v172, v149 quad_perm:[1,0,3,2] row_mask:0xf bank_mask:0xf
    v_fmac_f32_dpp v52, v173, v153 quad_perm:[1,0,3,2] row_mask:0xf bank_mask:0xf
    v_fmac_f32_dpp v60, v174, v157 quad_perm:[1,0,3,2] row_mask:0xf bank_mask:0xf
    v_fmac_f32_dpp v68, v175, v161 quad_perm:[1,0,3,2] row_mask:0xf bank_mask:0xf
    v_fmac_f32_dpp v76, v176, v165 quad_perm:[1,0,3,2] row_mask:0xf bank_mask:0xf
    v_fma_f32 v29, v148, v28, v29
    v_fma_f32 v53, v152, v52, v53
    v_fma_f32 v61, v156, v60, v61
    v_fma_f32 v69, v160, v68, v69
    v_fma_f32 v77, v164, v76, v77
    v_fmac_f32_dpp v29, v28, v149 quad_perm:[1,0,3,2] row_mask:0xf bank_mask:0xf
    v_fmac_f32_dpp v53, v52, v153 quad_perm:[1,0,3,2] row_mask:0xf bank_mask:0xf
    v_fmac_f32_dpp v61, v60, v157 quad_perm:[1,0,3,2] row_mask:0xf bank_mask:0xf
    v_fmac_f32_dpp v69, v68, v161 quad_perm:[1,0,3,2] row_mask:0xf bank_mask:0xf
    v_fmac_f32_dpp v77, v76, v165 quad_perm:[1,0,3,2] row_mask:0xf bank_mask:0xf
    v_fma_f32 v30, v148, v29, v30
    v_fma_f32 v54, v152, v53, v54
    v_fma_f32 v62, v156, v61, v62
    v_fma_f32 v70, v160, v69, v70
    v_fma_f32 v78, v164, v77, v78
    v_fmac_f32_dpp v30, v29, v149 quad_perm:[1,0,3,2] row_mask:0xf bank_mask:0xf
    v_fmac_f32_dpp v54, v53, v153 quad_perm:[1,0,3,2] row_mask:0xf bank_mask:0xf
    v_fmac_f32_dpp v62, v61, v157 quad_perm:[1,0,3,2] row_mask:0xf bank_mask:0xf
    v_fmac_f32_dpp v70, v69, v161 quad_perm:[1,0,3,2] row_mask:0xf bank_mask:0xf
    v_fmac_f32_dpp v78, v77, v165 quad_perm:[1,0,3,2] row_mask:0xf bank_mask:0xf
    v_fma_f32 v31, v148, v30, v31
    v_fma_f32 v55, v152, v54, v55
    v_fma_f32 v63, v156, v62, v63
    v_fma_f32 v71, v160, v70, v71
    v_fma_f32 v79, v164, v78, v79
    v_fmac_f32_dpp v31, v30, v149 quad_perm:[1,0,3,2] row_mask:0xf bank_mask:0xf
    v_fmac_f32_dpp v55, v54, v153 quad_perm:[1,0,3,2] row_mask:0xf bank_mask:0xf
    v_fmac_f32_dpp v63, v62, v157 quad_perm:[1,0,3,2] row_mask:0xf bank_mask:0xf
    v_fmac_f32_dpp v71, v70, v161 quad_perm:[1,0,3,2] row_mask:0xf bank_mask:0xf
    v_fmac_f32_dpp v79, v78, v165 quad_perm:[1,0,3,2] row_mask:0xf bank_mask:0xf
    v_fma_f32 v32, v148, v31, v32
    v_fma_f32 v56, v152, v55, v56
    v_fma_f32 v64, v156, v63, v64
    v_fma_f32 v72, v160, v71, v72
    v_fma_f32 v80, v164, v79, v80
    v_fmac_f32_dpp v32, v31, v149 quad_perm:[1,0,3,2] row_mask:0xf bank_mask:0xf
    v_fmac_f32_dpp v56, v55, v153 quad_perm:[1,0,3,2] row_mask:0xf bank_mask:0xf
    v_fmac_f32_dpp v64, v63, v157 quad_perm:[1,0,3,2] row_mask:0xf bank_mask:0xf
    v_fmac_f32_dpp v72, v71, v161 quad_perm:[1,0,3,2] row_mask:0xf bank_mask:0xf
    v_fmac_f32_dpp v80, v79, v165 quad_perm:[1,0,3,2] row_mask:0xf bank_mask:0xf
    v_fma_f32 v33, v148, v32, v33
    v_fma_f32 v57, v152, v56, v57
    v_fma_f32 v65, v156, v64, v65
    v_fma_f32 v73, v160, v72, v73
    v_fma_f32 v81, v164, v80, v81
    v_fmac_f32_dpp v33, v32, v149 quad_perm:[1,0,3,2] row_mask:0xf bank_mask:0xf
    v_fmac_f32_dpp v57, v56, v153 quad_perm:[1,0,3,2] row_mask:0xf bank_mask:0xf
    v_fmac_f32_dpp v65, v64, v157 quad_perm:[1,0,3,2] row_mask:0xf bank_mask:0xf
    v_fmac_f32_dpp v73, v72, v161 quad_perm:[1,0,3,2] row_mask:0xf bank_mask:0xf
    v_fmac_f32_dpp v81, v80, v165 quad_perm:[1,0,3,2] row_mask:0xf bank_mask:0xf
    v_fma_f32 v34, v148, v33, v34
    v_fma_f32 v58, v152, v57, v58
    v_fma_f32 v66, v156, v65, v66
    v_fma_f32 v74, v160, v73, v74
    v_fma_f32 v82, v164, v81, v82
    v_fmac_f32_dpp v34, v33, v149 quad_perm:[1,0,3,2] row_mask:0xf bank_mask:0xf
    v_fmac_f32_dpp v58, v57, v153 quad_perm:[1,0,3,2] row_mask:0xf bank_mask:0xf
    v_fmac_f32_dpp v66, v65, v157 quad_perm:[1,0,3,2] row_mask:0xf bank_mask:0xf
    v_fmac_f32_dpp v74, v73, v161 quad_perm:[1,0,3,2] row_mask:0xf bank_mask:0xf
    v_fmac_f32_dpp v82, v81, v165 quad_perm:[1,0,3,2] row_mask:0xf bank_mask:0xf
    v_fma_f32 v35, v148, v34, v35
    v_fma_f32 v59, v152, v58, v59
    v_fma_f32 v67, v156, v66, v67
    v_fma_f32 v75, v160, v74, v75
    v_fma_f32 v83, v164, v82, v83
    v_fmac_f32_dpp v35, v34, v149 quad_perm:[1,0,3,2] row_mask:0xf bank_mask:0xf
    v_fmac_f32_dpp v59, v58, v153 quad_perm:[1,0,3,2] row_mask:0xf bank_mask:0xf
    v_fmac_f32_dpp v67, v66, v157 quad_perm:[1,0,3,2] row_mask:0xf bank_mask:0xf
    v_fmac_f32_dpp v75, v74, v161 quad_perm:[1,0,3,2] row_mask:0xf bank_mask:0xf
    v_fmac_f32_dpp v83, v82, v165 quad_perm:[1,0,3,2] row_mask:0xf bank_mask:0xf
    v_cvt_pk_bf16_f32 v92, v28, v29
    v_cvt_pk_bf16_f32 v93, v30, v31
    v_cvt_pk_bf16_f32 v94, v32, v33
    v_cvt_pk_bf16_f32 v95, v34, v35
    ds_write_b128 v232, v[92:95] offset:37888
    v_cvt_pk_bf16_f32 v96, v52, v53
    v_cvt_pk_bf16_f32 v97, v54, v55
    v_cvt_pk_bf16_f32 v98, v56, v57
    v_cvt_pk_bf16_f32 v99, v58, v59
    ds_write_b128 v232, v[96:99] offset:42496
    v_cvt_pk_bf16_f32 v100, v60, v61
    v_cvt_pk_bf16_f32 v101, v62, v63
    v_cvt_pk_bf16_f32 v102, v64, v65
    v_cvt_pk_bf16_f32 v103, v66, v67
    ds_write_b128 v232, v[100:103] offset:47104
    v_cvt_pk_bf16_f32 v104, v68, v69
    v_cvt_pk_bf16_f32 v105, v70, v71
    v_cvt_pk_bf16_f32 v106, v72, v73
    v_cvt_pk_bf16_f32 v107, v74, v75
    ds_write_b128 v232, v[104:107] offset:51712
    v_cvt_pk_bf16_f32 v108, v76, v77
    v_cvt_pk_bf16_f32 v109, v78, v79
    v_cvt_pk_bf16_f32 v110, v80, v81
    v_cvt_pk_bf16_f32 v111, v82, v83
    ds_write_b128 v232, v[108:111] offset:56320
    s_waitcnt lgkmcnt(0)
    ds_read_b64_tr_b16 v[112:113], v233 offset:37888
    ds_read_b64_tr_b16 v[114:115], v233 offset:40192
    ds_read_b64_tr_b16 v[116:117], v233 offset:47104
    ds_read_b64_tr_b16 v[118:119], v233 offset:49408
    ds_read_b64_tr_b16 v[120:121], v234 offset:56320
    ds_read_b64_tr_b16 v[122:123], v234 offset:58624
    ds_read_b64_tr_b16 v[124:125], v233 offset:37920
    ds_read_b64_tr_b16 v[126:127], v233 offset:40224
    ds_read_b64_tr_b16 v[128:129], v233 offset:47136
    ds_read_b64_tr_b16 v[130:131], v233 offset:49440
    s_waitcnt lgkmcnt(8)
    buffer_store_dwordx4 v[112:115], v238, s[40:43], 0 offen sc1
    s_waitcnt lgkmcnt(6)
    buffer_store_dwordx4 v[116:119], v239, s[40:43], 0 offen sc1
    s_waitcnt lgkmcnt(4)
    buffer_store_dwordx4 v[120:123], v240, s[40:43], 0 offen sc1
    s_waitcnt lgkmcnt(2)
    buffer_store_dwordx4 v[124:127], v241, s[40:43], 0 offen sc1
    s_waitcnt lgkmcnt(0)
    buffer_store_dwordx4 v[128:131], v242, s[40:43], 0 offen sc1
    v_and_b32 v4, 1, v14
    v_and_b32 v5, 7, v13
    v_xor_b32 v4, v4, v5
    v_lshlrev_b32 v4, 4, v4
    v_lshlrev_b32 v2, 7, v13
    v_add_u32 v4, v4, v2
    v_lshrrev_b32 v3, 1, v14
    v_mul_u32_u24 v3, 10240, v3
    v_add_u32 v4, v4, v3
    v_xor_b32 v16, 0, v4
    v_add_u32 v28, 40960, v16
    v_xor_b32 v17, 32, v4
    v_add_u32 v29, 40960, v17
    v_xor_b32 v18, 64, v4
    v_add_u32 v30, 40960, v18
    v_xor_b32 v19, 96, v4
    v_add_u32 v31, 40960, v19
    v_lshlrev_b32 v10, 4, v1
    s_lshl_b32 s85, s24, 12
    v_add_u32 v10, s85, v10
    s_lshl_b32 s55, s75, 2
    s_add_u32 s62, s55, s52
    s_mul_i32 s60, s62, 40960
    s_lshl_b32 s63, s62, 4
    v_add_u32 v11, s63, v13
    s_mul_i32 s56, s76, 80
    v_lshlrev_b32 v20, 2, v14
    v_add_u32 v20, s56, v20
    v_lshlrev_b32 v21, 1, v20
    s_lshl_b32 s55, s75, 7
    s_add_u32 s55, s55, 5120
    v_and_b32 v33, 31, v1
    v_lshlrev_b32 v33, 2, v33
    v_add_u32 v33, s55, v33
    s_mul_i32 s55, s76, 384
    s_add_u32 s55, s55, 9216
    v_lshlrev_b32 v22, 2, v1
    v_add_u32 v22, s55, v22
    v_add_u32 v24, 256, v22
    s_lshl_b32 s55, s75, 7
    s_add_u32 s55, s55, 1024
    v_and_b32 v2, 7, v1
    v_lshlrev_b32 v2, 2, v2
    v_add_u32 v2, s55, v2
    v_cmp_gt_u32 vcc, 16, v1
    s_nop 1
    v_cndmask_b32 v24, v2, v24, vcc
    s_mul_i32 s64, s76, 327680
    s_lshl_b32 s56, s63, 1
    s_add_u32 s64, s64, s56
    s_mul_i32 s65, s52, 2560
    s_add_u32 s65, s65, 20480
    v_add_u32 v2, 0, v1
    v_lshrrev_b32 v3, 1, v2
    v_and_b32 v4, 1, v2
    v_lshlrev_b32 v3, 12, v3
    v_lshlrev_b32 v4, 4, v4
    v_add_u32 v34, v3, v4
    v_lshlrev_b32 v38, 4, v2
    v_add_u32 v38, s65, v38
    v_add_u32 v2, 64, v1
    v_lshrrev_b32 v3, 1, v2
    v_and_b32 v4, 1, v2
    v_lshlrev_b32 v3, 12, v3
    v_lshlrev_b32 v4, 4, v4
    v_add_u32 v35, v3, v4
    v_lshlrev_b32 v39, 4, v2
    v_add_u32 v39, s65, v39
    v_add_u32 v2, 128, v1
    v_min_u32 v2, 159, v2
    v_lshrrev_b32 v3, 1, v2
    v_and_b32 v4, 1, v2
    v_lshlrev_b32 v3, 12, v3
    v_lshlrev_b32 v4, 4, v4
    v_add_u32 v36, v3, v4
    v_lshlrev_b32 v40, 4, v2
    v_add_u32 v40, s65, v40
    s_mul_i32 s66, s52, 2560
    s_add_u32 s66, s66, 30720
    s_mul_i32 s55, s63, 1280
    s_mul_i32 s56, s76, 160
    s_add_u32 s67, s55, s56
    v_add_u32 v2, 0, v1
    v_mul_u32_u24 v3, 205, v2
    v_lshrrev_b32 v3, 11, v3
    v_mul_u32_u24 v4, 10, v3
    v_sub_u32 v4, v2, v4
    v_lshlrev_b32 v4, 4, v4
    v_mul_u32_u24 v44, 1280, v3
    v_add_u32 v44, v44, v4
    v_lshlrev_b32 v48, 4, v2
    v_add_u32 v48, s66, v48
    v_add_u32 v2, 64, v1
    v_mul_u32_u24 v3, 205, v2
    v_lshrrev_b32 v3, 11, v3
    v_mul_u32_u24 v4, 10, v3
    v_sub_u32 v4, v2, v4
    v_lshlrev_b32 v4, 4, v4
    v_mul_u32_u24 v45, 1280, v3
    v_add_u32 v45, v45, v4
    v_lshlrev_b32 v49, 4, v2
    v_add_u32 v49, s66, v49
    v_add_u32 v2, 128, v1
    v_min_u32 v2, 159, v2
    v_mul_u32_u24 v3, 205, v2
    v_lshrrev_b32 v3, 11, v3
    v_mul_u32_u24 v4, 10, v3
    v_sub_u32 v4, v2, v4
    v_lshlrev_b32 v4, 4, v4
    v_mul_u32_u24 v46, 1280, v3
    v_add_u32 v46, v46, v4
    v_lshlrev_b32 v50, 4, v2
    v_add_u32 v50, s66, v50
    v_mul_u32_u24 v51, 160, v13
    v_lshlrev_b32 v2, 3, v14
    v_add3_u32 v51, v51, v2, s66
    s_mul_i32 s55, s52, 5120
    s_add_u32 s55, s55, 40960
    v_mul_u32_u24 v52, 320, v13
    v_lshlrev_b32 v2, 4, v14
    v_add3_u32 v52, v52, v2, s55
    v_lshlrev_b32 v53, 4, v1
    v_add_u32 v53, s55, v53
    s_mul_i32 s68, s63, 2560
    s_mul_i32 s56, s76, 320
    s_add_u32 s68, s68, s56
    v_add_u32 v2, 0, v1
    v_mul_u32_u24 v3, 205, v2
    v_lshrrev_b32 v3, 12, v3
    v_mul_u32_u24 v4, 20, v3
    v_sub_u32 v4, v2, v4
    v_lshlrev_b32 v4, 4, v4
    v_mul_u32_u24 v54, 2560, v3
    v_add_u32 v54, v54, v4
    v_add_u32 v2, 64, v1
    v_mul_u32_u24 v3, 205, v2
    v_lshrrev_b32 v3, 12, v3
    v_mul_u32_u24 v4, 20, v3
    v_sub_u32 v4, v2, v4
    v_lshlrev_b32 v4, 4, v4
    v_mul_u32_u24 v55, 2560, v3
    v_add_u32 v55, v55, v4
    v_add_u32 v2, 128, v1
    v_mul_u32_u24 v3, 205, v2
    v_lshrrev_b32 v3, 12, v3
    v_mul_u32_u24 v4, 20, v3
    v_sub_u32 v4, v2, v4
    v_lshlrev_b32 v4, 4, v4
    v_mul_u32_u24 v56, 2560, v3
    v_add_u32 v56, v56, v4
    v_add_u32 v2, 192, v1
    v_mul_u32_u24 v3, 205, v2
    v_lshrrev_b32 v3, 12, v3
    v_mul_u32_u24 v4, 20, v3
    v_sub_u32 v4, v2, v4
    v_lshlrev_b32 v4, 4, v4
    v_mul_u32_u24 v57, 2560, v3
    v_add_u32 v57, v57, v4
    v_add_u32 v2, 256, v1
    v_mul_u32_u24 v3, 205, v2
    v_lshrrev_b32 v3, 12, v3
    v_mul_u32_u24 v4, 20, v3
    v_sub_u32 v4, v2, v4
    v_lshlrev_b32 v4, 4, v4
    v_mul_u32_u24 v58, 2560, v3
    v_add_u32 v58, v58, v4
    v_lshlrev_b32 v41, 2, v11
    v_lshrrev_b32 v2, 2, v13
    v_lshlrev_b32 v3, 2, v14
    v_add_u32 v2, v2, v3
    v_lshlrev_b32 v2, 5, v2
    v_and_b32 v3, 3, v13
    v_lshlrev_b32 v3, 3, v3
    v_add3_u32 v42, v2, v3, s65
    s_add_u32 s48, s26, 13320448
    s_addc_u32 s49, s27, 0
    s_and_b32 s49, s49, 0xffff
    s_mov_b32 s50, 12288
    s_mov_b32 s51, 0x00020000
    s_mov_b32 s28, s22
    s_and_b32 s29, s23, 0xffff
    s_mov_b32 s30, 2621440
    s_mov_b32 s31, 0x00020000
    s_mov_b32 s32, s18
    s_and_b32 s33, s19, 0xffff
    s_mov_b32 s34, 1280
    s_mov_b32 s35, 0x00020000
    s_mov_b32 s36, s20
    s_and_b32 s37, s21, 0xffff
    s_mov_b32 s38, 5242880
    s_mov_b32 s39, 0x00020000
    s_lshl_b32 s55, s53, 8
    s_lshl_b32 s56, s54, 2
    s_add_u32 s55, s55, s56
    s_lshl_b32 s56, s52, 6
    s_add_u32 s55, s55, s56
    s_add_u32 s55, s55, 5120
    v_mov_b32 v2, s55
    v_mov_b32 v3, s74
    v_cmp_eq_u32 vcc, 0, v1
    s_waitcnt vmcnt(0)
    s_and_saveexec_b64 s[70:71], vcc
    buffer_store_dword v3, v2, s[48:51], 0 offen sc1
    s_mov_b64 exec, s[70:71]
    s_barrier
    v_lshlrev_b32 v4, 3, v14
    v_add_u32 v5, 0, v4
    ds_bpermute_b32 v60, v5, v25
    v_add_u32 v5, 4, v4
    ds_bpermute_b32 v61, v5, v25
    v_add_u32 v5, 32, v4
    ds_bpermute_b32 v62, v5, v25
    v_add_u32 v5, 36, v4
    ds_bpermute_b32 v63, v5, v25
    v_add_u32 v5, 64, v4
    ds_bpermute_b32 v64, v5, v25
    v_add_u32 v5, 68, v4
    ds_bpermute_b32 v65, v5, v25
    v_add_u32 v5, 96, v4
    ds_bpermute_b32 v66, v5, v25
    v_add_u32 v5, 100, v4
    ds_bpermute_b32 v67, v5, v25
    v_add_u32 v5, 128, v4
    ds_bpermute_b32 v68, v5, v25
    v_add_u32 v5, 132, v4
    ds_bpermute_b32 v69, v5, v25
    s_waitcnt lgkmcnt(0)
    s_cmp_eq_u32 s52, 0
    s_cbranch_scc1 ce0_27
    s_add_u32 m0, s83, 61440
    s_nop 0
    buffer_load_dwordx4 v12, s[44:47], s78 offen lds
    s_add_u32 m0, s83, 63488
    s_nop 0
    buffer_load_dwordx4 v12, s[44:47], s79 offen lds
    s_add_u32 m0, s83, 65536
    s_nop 0
    buffer_load_dwordx4 v12, s[44:47], s80 offen lds
    s_add_u32 m0, s83, 67584
    s_nop 0
    buffer_load_dwordx4 v12, s[44:47], s81 offen lds
    s_add_u32 m0, s83, 69632
    s_nop 0
    buffer_load_dwordx4 v12, s[44:47], s82 offen lds
    s_cmp_lg_u32 s52, 2
    s_cbranch_scc1 ce0_27
    s_sub_u32 s56, s78, 10240
    s_add_u32 m0, s83, 61440
    s_sub_u32 m0, m0, 1024
    s_nop 0
    buffer_load_dwordx4 v12, s[44:47], s56 offen lds
    s_sub_u32 s56, s79, 10240
    s_add_u32 m0, s83, 63488
    s_sub_u32 m0, m0, 1024
    s_nop 0
    buffer_load_dwordx4 v12, s[44:47], s56 offen lds
    s_sub_u32 s56, s80, 10240
    s_add_u32 m0, s83, 65536
    s_sub_u32 m0, m0, 1024
    s_nop 0
    buffer_load_dwordx4 v12, s[44:47], s56 offen lds
    s_sub_u32 s56, s81, 10240
    s_add_u32 m0, s83, 67584
    s_sub_u32 m0, m0, 1024
    s_nop 0
    buffer_load_dwordx4 v12, s[44:47], s56 offen lds
    s_sub_u32 s56, s82, 10240
    s_add_u32 m0, s83, 69632
    s_sub_u32 m0, m0, 1024
    s_nop 0
    buffer_load_dwordx4 v12, s[44:47], s56 offen lds
ce0_27:
    s_add_u32 s25, s25, 1
    s_cmp_eq_u32 s25, 10
    s_cselect_b32 s85, 1280, 0
    s_cselect_b32 s25, 0, s25
    s_sub_u32 s85, 128, s85
    v_add_u32 v12, s85, v12
    s_cmp_eq_u32 s52, 0
    s_cbranch_scc1 ce0_29
    s_add_u32 m0, s83, 0
    s_nop 0
    buffer_load_dwordx4 v12, s[44:47], s78 offen lds
    s_add_u32 m0, s83, 2048
    s_nop 0
    buffer_load_dwordx4 v12, s[44:47], s79 offen lds
    s_add_u32 m0, s83, 4096
    s_nop 0
    buffer_load_dwordx4 v12, s[44:47], s80 offen lds
    s_add_u32 m0, s83, 6144
    s_nop 0
    buffer_load_dwordx4 v12, s[44:47], s81 offen lds
    s_add_u32 m0, s83, 8192
    s_nop 0
    buffer_load_dwordx4 v12, s[44:47], s82 offen lds
    s_cmp_lg_u32 s52, 2
    s_cbranch_scc1 ce0_29
    s_sub_u32 s56, s78, 10240
    s_add_u32 m0, s83, 0
    s_sub_u32 m0, m0, 1024
    s_nop 0
    buffer_load_dwordx4 v12, s[44:47], s56 offen lds
    s_sub_u32 s56, s79, 10240
    s_add_u32 m0, s83, 2048
    s_sub_u32 m0, m0, 1024
    s_nop 0
    buffer_load_dwordx4 v12, s[44:47], s56 offen lds
    s_sub_u32 s56, s80, 10240
    s_add_u32 m0, s83, 4096
    s_sub_u32 m0, m0, 1024
    s_nop 0
    buffer_load_dwordx4 v12, s[44:47], s56 offen lds
    s_sub_u32 s56, s81, 10240
    s_add_u32 m0, s83, 6144
    s_sub_u32 m0, m0, 1024
    s_nop 0
    buffer_load_dwordx4 v12, s[44:47], s56 offen lds
    s_sub_u32 s56, s82, 10240
    s_add_u32 m0, s83, 8192
    s_sub_u32 m0, m0, 1024
    s_nop 0
    buffer_load_dwordx4 v12, s[44:47], s56 offen lds
ce0_29:
    s_add_u32 s25, s25, 1
    s_cmp_eq_u32 s25, 10
    s_cselect_b32 s85, 1280, 0
    s_cselect_b32 s25, 0, s25
    s_sub_u32 s85, 128, s85
    v_add_u32 v12, s85, v12
    s_cmp_eq_u32 s52, 0
    s_cbranch_scc1 ce0_31
    s_add_u32 m0, s83, 20480
    s_nop 0
    buffer_load_dwordx4 v12, s[44:47], s78 offen lds
    s_add_u32 m0, s83, 22528
    s_nop 0
    buffer_load_dwordx4 v12, s[44:47], s79 offen lds
    s_add_u32 m0, s83, 24576
    s_nop 0
    buffer_load_dwordx4 v12, s[44:47], s80 offen lds
    s_add_u32 m0, s83, 26624
    s_nop 0
    buffer_load_dwordx4 v12, s[44:47], s81 offen lds
    s_add_u32 m0, s83, 28672
    s_nop 0
    buffer_load_dwordx4 v12, s[44:47], s82 offen lds
    s_cmp_lg_u32 s52, 2
    s_cbranch_scc1 ce0_31
    s_sub_u32 s56, s78, 10240
    s_add_u32 m0, s83, 20480
    s_sub_u32 m0, m0, 1024
    s_nop 0
    buffer_load_dwordx4 v12, s[44:47], s56 offen lds
    s_sub_u32 s56, s79, 10240
    s_add_u32 m0, s83, 22528
    s_sub_u32 m0, m0, 1024
    s_nop 0
    buffer_load_dwordx4 v12, s[44:47], s56 offen lds
    s_sub_u32 s56, s80, 10240
    s_add_u32 m0, s83, 24576
    s_sub_u32 m0, m0, 1024
    s_nop 0
    buffer_load_dwordx4 v12, s[44:47], s56 offen lds
    s_sub_u32 s56, s81, 10240
    s_add_u32 m0, s83, 26624
    s_sub_u32 m0, m0, 1024
    s_nop 0
    buffer_load_dwordx4 v12, s[44:47], s56 offen lds
    s_sub_u32 s56, s82, 10240
    s_add_u32 m0, s83, 28672
    s_sub_u32 m0, m0, 1024
    s_nop 0
    buffer_load_dwordx4 v12, s[44:47], s56 offen lds
ce0_31:
    s_add_u32 s25, s25, 1
    s_cmp_eq_u32 s25, 10
    s_cselect_b32 s85, 1280, 0
    s_cselect_b32 s25, 0, s25
    s_sub_u32 s85, 128, s85
    v_add_u32 v12, s85, v12
    s_cmp_eq_u32 s52, 0
    s_cbranch_scc1 ce0_33
    s_add_u32 m0, s83, 40960
    s_nop 0
    buffer_load_dwordx4 v12, s[44:47], s78 offen lds
    s_add_u32 m0, s83, 43008
    s_nop 0
    buffer_load_dwordx4 v12, s[44:47], s79 offen lds
    s_add_u32 m0, s83, 45056
    s_nop 0
    buffer_load_dwordx4 v12, s[44:47], s80 offen lds
    s_add_u32 m0, s83, 47104
    s_nop 0
    buffer_load_dwordx4 v12, s[44:47], s81 offen lds
    s_add_u32 m0, s83, 49152
    s_nop 0
    buffer_load_dwordx4 v12, s[44:47], s82 offen lds
    s_cmp_lg_u32 s52, 2
    s_cbranch_scc1 ce0_33
    s_sub_u32 s56, s78, 10240
    s_add_u32 m0, s83, 40960
    s_sub_u32 m0, m0, 1024
    s_nop 0
    buffer_load_dwordx4 v12, s[44:47], s56 offen lds
    s_sub_u32 s56, s79, 10240
    s_add_u32 m0, s83, 43008
    s_sub_u32 m0, m0, 1024
    s_nop 0
    buffer_load_dwordx4 v12, s[44:47], s56 offen lds
    s_sub_u32 s56, s80, 10240
    s_add_u32 m0, s83, 45056
    s_sub_u32 m0, m0, 1024
    s_nop 0
    buffer_load_dwordx4 v12, s[44:47], s56 offen lds
    s_sub_u32 s56, s81, 10240
    s_add_u32 m0, s83, 47104
    s_sub_u32 m0, m0, 1024
    s_nop 0
    buffer_load_dwordx4 v12, s[44:47], s56 offen lds
    s_sub_u32 s56, s82, 10240
    s_add_u32 m0, s83, 49152
    s_sub_u32 m0, m0, 1024
    s_nop 0
    buffer_load_dwordx4 v12, s[44:47], s56 offen lds
ce0_33:
    s_add_u32 s25, s25, 1
    s_cmp_eq_u32 s25, 10
    s_cselect_b32 s85, 1280, 0
    s_cselect_b32 s25, 0, s25
    s_sub_u32 s85, 128, s85
    v_add_u32 v12, s85, v12
    s_cmp_lg_u32 s52, 0
    s_cbranch_scc1 bnp_35
    buffer_load_dword v23, v33, s[48:51], 0 offen sc1
    s_mov_b32 s8, 0
    s_waitcnt vmcnt(0)
fp_37:
    v_cmp_eq_u32 vcc, s74, v23
    s_nop 4
    s_cmp_eq_u64 vcc, -1
    s_cbranch_scc1 fok_38
    s_sleep 1
    buffer_load_dword v23, v33, s[48:51], 0 offen sc1
    s_add_u32 s8, s8, 1
    s_waitcnt vmcnt(0)
    s_cmp_lt_u32 s8, 100000
    s_cbranch_scc1 fp_37
fok_38:
bnp_35:
    s_waitcnt vmcnt(0)
    s_barrier
    buffer_load_dwordx4 v[152:155], v10, s[40:43], s60 offen offset:0 sc1
    buffer_load_dwordx4 v[156:159], v10, s[40:43], s60 offen offset:1024 sc1
    buffer_load_dwordx4 v[160:163], v10, s[40:43], s60 offen offset:2048 sc1
    buffer_load_dwordx4 v[164:167], v10, s[40:43], s60 offen offset:3072 sc1
    s_add_u32 s24, s24, 1
    s_cmp_eq_u32 s24, 10
    s_cselect_b32 s85, 40960, 0
    s_cselect_b32 s24, 0, s24
    s_sub_u32 s85, 4096, s85
    v_add_u32 v10, s85, v10
    buffer_load_dwordx4 v[168:171], v10, s[40:43], s60 offen offset:0 sc1
    buffer_load_dwordx4 v[172:175], v10, s[40:43], s60 offen offset:1024 sc1
    buffer_load_dwordx4 v[176:179], v10, s[40:43], s60 offen offset:2048 sc1
    buffer_load_dwordx4 v[180:183], v10, s[40:43], s60 offen offset:3072 sc1
    s_add_u32 s24, s24, 1
    s_cmp_eq_u32 s24, 10
    s_cselect_b32 s85, 40960, 0
    s_cselect_b32 s24, 0, s24
    s_sub_u32 s85, 4096, s85
    v_add_u32 v10, s85, v10
    buffer_load_dwordx4 v[184:187], v10, s[40:43], s60 offen offset:0 sc1
    buffer_load_dwordx4 v[188:191], v10, s[40:43], s60 offen offset:1024 sc1
    buffer_load_dwordx4 v[192:195], v10, s[40:43], s60 offen offset:2048 sc1
    buffer_load_dwordx4 v[196:199], v10, s[40:43], s60 offen offset:3072 sc1
    s_add_u32 s24, s24, 1
    s_cmp_eq_u32 s24, 10
    s_cselect_b32 s85, 40960, 0
    s_cselect_b32 s24, 0, s24
    s_sub_u32 s85, 4096, s85
    v_add_u32 v10, s85, v10
    ds_read_b128 v[92:95], v28 offset:20480
    ds_read_b128 v[96:99], v28 offset:22528
    ds_read_b128 v[100:103], v28 offset:24576
    ds_read_b128 v[104:107], v28 offset:26624
    ds_read_b128 v[108:111], v28 offset:28672
    ds_read_b128 v[112:115], v29 offset:20480
    ds_read_b128 v[116:119], v29 offset:22528
    ds_read_b128 v[120:123], v29 offset:24576
    ds_read_b128 v[124:127], v29 offset:26624
    ds_read_b128 v[128:131], v29 offset:28672
    s_waitcnt vmcnt(8)
    s_waitcnt lgkmcnt(5)
    v_mfma_f32_16x16x32_bf16 v[72:75], v[92:95], v[152:155], 0
    ds_read_b128 v[132:135], v30 offset:20480
    ds_read_b128 v[136:139], v30 offset:22528
    v_mfma_f32_16x16x32_bf16 v[76:79], v[96:99], v[152:155], 0
    ds_read_b128 v[140:143], v30 offset:24576
    ds_read_b128 v[144:147], v30 offset:26624
    v_mfma_f32_16x16x32_bf16 v[80:83], v[100:103], v[152:155], 0
    ds_read_b128 v[148:151], v30 offset:28672
    v_mfma_f32_16x16x32_bf16 v[84:87], v[104:107], v[152:155], 0
    v_mfma_f32_16x16x32_bf16 v[88:91], v[108:111], v[152:155], 0
    s_waitcnt lgkmcnt(5)
    v_mfma_f32_16x16x32_bf16 v[72:75], v[112:115], v[156:159], v[72:75]
    ds_read_b128 v[92:95], v31 offset:20480
    ds_read_b128 v[96:99], v31 offset:22528
    v_mfma_f32_16x16x32_bf16 v[76:79], v[116:119], v[156:159], v[76:79]
    ds_read_b128 v[100:103], v31 offset:24576
    ds_read_b128 v[104:107], v31 offset:26624
    v_mfma_f32_16x16x32_bf16 v[80:83], v[120:123], v[156:159], v[80:83]
    ds_read_b128 v[108:111], v31 offset:28672
    v_mfma_f32_16x16x32_bf16 v[84:87], v[124:127], v[156:159], v[84:87]
    v_mfma_f32_16x16x32_bf16 v[88:91], v[128:131], v[156:159], v[88:91]
    s_waitcnt lgkmcnt(0)
    s_barrier
    v_mfma_f32_16x16x32_bf16 v[72:75], v[132:135], v[160:163], v[72:75]
    ds_read_b128 v[112:115], v16 offset:0
    ds_read_b128 v[116:119], v16 offset:2048
    v_mfma_f32_16x16x32_bf16 v[76:79], v[136:139], v[160:163], v[76:79]
    ds_read_b128 v[120:123], v16 offset:4096
    ds_read_b128 v[124:127], v16 offset:6144
    v_mfma_f32_16x16x32_bf16 v[80:83], v[140:143], v[160:163], v[80:83]
    ds_read_b128 v[128:131], v16 offset:8192
    s_add_u32 m0, s83, 61440
    s_nop 0
    buffer_load_dwordx4 v12, s[44:47], s78 offen lds
    v_mfma_f32_16x16x32_bf16 v[84:87], v[144:147], v[160:163], v[84:87]
    s_add_u32 m0, s83, 63488
    s_nop 0
    buffer_load_dwordx4 v12, s[44:47], s79 offen lds
    s_add_u32 m0, s83, 65536
    s_nop 0
    buffer_load_dwordx4 v12, s[44:47], s80 offen lds
    v_mfma_f32_16x16x32_bf16 v[88:91], v[148:151], v[160:163], v[88:91]
    buffer_load_dwordx4 v[200:203], v10, s[40:43], s60 offen offset:0 sc1
    buffer_load_dwordx4 v[204:207], v10, s[40:43], s60 offen offset:1024 sc1
    s_waitcnt lgkmcnt(5)
    v_mfma_f32_16x16x32_bf16 v[72:75], v[92:95], v[164:167], v[72:75]
    ds_read_b128 v[132:135], v17 offset:0
    ds_read_b128 v[136:139], v17 offset:2048
    v_mfma_f32_16x16x32_bf16 v[76:79], v[96:99], v[164:167], v[76:79]
    ds_read_b128 v[140:143], v17 offset:4096
    ds_read_b128 v[144:147], v17 offset:6144
    v_mfma_f32_16x16x32_bf16 v[80:83], v[100:103], v[164:167], v[80:83]
    ds_read_b128 v[148:151], v17 offset:8192
    s_add_u32 m0, s83, 67584
    s_nop 0
    buffer_load_dwordx4 v12, s[44:47], s81 offen lds
    v_mfma_f32_16x16x32_bf16 v[84:87], v[104:107], v[164:167], v[84:87]
    s_add_u32 m0, s83, 69632
    s_nop 0
    buffer_load_dwordx4 v12, s[44:47], s82 offen lds
    s_add_u32 s25, s25, 1
    s_cmp_eq_u32 s25, 10
    s_cselect_b32 s85, 1280, 0
    s_cselect_b32 s25, 0, s25
    s_sub_u32 s85, 128, s85
    v_add_u32 v12, s85, v12
    v_mfma_f32_16x16x32_bf16 v[88:91], v[108:111], v[164:167], v[88:91]
    buffer_load_dwordx4 v[208:211], v10, s[40:43], s60 offen offset:2048 sc1
    buffer_load_dwordx4 v[212:215], v10, s[40:43], s60 offen offset:3072 sc1
    s_add_u32 s24, s24, 1
    s_cmp_eq_u32 s24, 10
    s_cselect_b32 s85, 40960, 0
    s_cselect_b32 s24, 0, s24
    s_sub_u32 s85, 4096, s85
    v_add_u32 v10, s85, v10
    s_waitcnt vmcnt(13)
    s_waitcnt lgkmcnt(5)
    v_mfma_f32_16x16x32_bf16 v[72:75], v[112:115], v[168:171], v[72:75]
    ds_read_b128 v[92:95], v18 offset:0
    ds_read_b128 v[96:99], v18 offset:2048
    v_mfma_f32_16x16x32_bf16 v[76:79], v[116:119], v[168:171], v[76:79]
    ds_read_b128 v[100:103], v18 offset:4096
    ds_read_b128 v[104:107], v18 offset:6144
    v_mfma_f32_16x16x32_bf16 v[80:83], v[120:123], v[168:171], v[80:83]
    ds_read_b128 v[108:111], v18 offset:8192
    v_mfma_f32_16x16x32_bf16 v[84:87], v[124:127], v[168:171], v[84:87]
    v_mfma_f32_16x16x32_bf16 v[88:91], v[128:131], v[168:171], v[88:91]
    s_waitcnt lgkmcnt(5)
    v_mfma_f32_16x16x32_bf16 v[72:75], v[132:135], v[172:175], v[72:75]
    ds_read_b128 v[112:115], v19 offset:0
    ds_read_b128 v[116:119], v19 offset:2048
    v_mfma_f32_16x16x32_bf16 v[76:79], v[136:139], v[172:175], v[76:79]
    ds_read_b128 v[120:123], v19 offset:4096
    ds_read_b128 v[124:127], v19 offset:6144
    v_mfma_f32_16x16x32_bf16 v[80:83], v[140:143], v[172:175], v[80:83]
    ds_read_b128 v[128:131], v19 offset:8192
    v_mfma_f32_16x16x32_bf16 v[84:87], v[144:147], v[172:175], v[84:87]
    v_mfma_f32_16x16x32_bf16 v[88:91], v[148:151], v[172:175], v[88:91]
    s_waitcnt lgkmcnt(0)
    s_barrier
    v_mfma_f32_16x16x32_bf16 v[72:75], v[92:95], v[176:179], v[72:75]
    ds_read_b128 v[132:135], v16 offset:20480
    ds_read_b128 v[136:139], v16 offset:22528
    v_mfma_f32_16x16x32_bf16 v[76:79], v[96:99], v[176:179], v[76:79]
    ds_read_b128 v[140:143], v16 offset:24576
    ds_read_b128 v[144:147], v16 offset:26624
    v_mfma_f32_16x16x32_bf16 v[80:83], v[100:103], v[176:179], v[80:83]
    ds_read_b128 v[148:151], v16 offset:28672
    s_add_u32 m0, s83, 0
    s_nop 0
    buffer_load_dwordx4 v12, s[44:47], s78 offen lds
    v_mfma_f32_16x16x32_bf16 v[84:87], v[104:107], v[176:179], v[84:87]
    s_add_u32 m0, s83, 2048
    s_nop 0
    buffer_load_dwordx4 v12, s[44:47], s79 offen lds
    s_add_u32 m0, s83, 4096
    s_nop 0
    buffer_load_dwordx4 v12, s[44:47], s80 offen lds
    v_mfma_f32_16x16x32_bf16 v[88:91], v[108:111], v[176:179], v[88:91]
    buffer_load_dwordx4 v[152:155], v10, s[40:43], s60 offen offset:0 sc1
    buffer_load_dwordx4 v[156:159], v10, s[40:43], s60 offen offset:1024 sc1
    s_waitcnt lgkmcnt(5)
    v_mfma_f32_16x16x32_bf16 v[72:75], v[112:115], v[180:183], v[72:75]
    ds_read_b128 v[92:95], v17 offset:20480
    ds_read_b128 v[96:99], v17 offset:22528
    v_mfma_f32_16x16x32_bf16 v[76:79], v[116:119], v[180:183], v[76:79]
    ds_read_b128 v[100:103], v17 offset:24576
    ds_read_b128 v[104:107], v17 offset:26624
    v_mfma_f32_16x16x32_bf16 v[80:83], v[120:123], v[180:183], v[80:83]
    ds_read_b128 v[108:111], v17 offset:28672
    s_add_u32 m0, s83, 6144
    s_nop 0
    buffer_load_dwordx4 v12, s[44:47], s81 offen lds
    v_mfma_f32_16x16x32_bf16 v[84:87], v[124:127], v[180:183], v[84:87]
    s_add_u32 m0, s83, 8192
    s_nop 0
    buffer_load_dwordx4 v12, s[44:47], s82 offen lds
    s_add_u32 s25, s25, 1
    s_cmp_eq_u32 s25, 10
    s_cselect_b32 s85, 1280, 0
    s_cselect_b32 s25, 0, s25
    s_sub_u32 s85, 128, s85
    v_add_u32 v12, s85, v12
    v_mfma_f32_16x16x32_bf16 v[88:91], v[128:131], v[180:183], v[88:91]
    buffer_load_dwordx4 v[160:163], v10, s[40:43], s60 offen offset:2048 sc1
    buffer_load_dwordx4 v[164:167], v10, s[40:43], s60 offen offset:3072 sc1
    s_add_u32 s24, s24, 1
    s_cmp_eq_u32 s24, 10
    s_cselect_b32 s85, 40960, 0
    s_cselect_b32 s24, 0, s24
    s_sub_u32 s85, 4096, s85
    v_add_u32 v10, s85, v10
    s_waitcnt vmcnt(18)
    s_waitcnt lgkmcnt(5)
    v_mfma_f32_16x16x32_bf16 v[72:75], v[132:135], v[184:187], v[72:75]
    ds_read_b128 v[112:115], v18 offset:20480
    ds_read_b128 v[116:119], v18 offset:22528
    v_mfma_f32_16x16x32_bf16 v[76:79], v[136:139], v[184:187], v[76:79]
    ds_read_b128 v[120:123], v18 offset:24576
    ds_read_b128 v[124:127], v18 offset:26624
    v_mfma_f32_16x16x32_bf16 v[80:83], v[140:143], v[184:187], v[80:83]
    ds_read_b128 v[128:131], v18 offset:28672
    v_mfma_f32_16x16x32_bf16 v[84:87], v[144:147], v[184:187], v[84:87]
    v_mfma_f32_16x16x32_bf16 v[88:91], v[148:151], v[184:187], v[88:91]
    s_waitcnt lgkmcnt(5)
    v_mfma_f32_16x16x32_bf16 v[72:75], v[92:95], v[188:191], v[72:75]
    ds_read_b128 v[132:135], v19 offset:20480
    ds_read_b128 v[136:139], v19 offset:22528
    v_mfma_f32_16x16x32_bf16 v[76:79], v[96:99], v[188:191], v[76:79]
    ds_read_b128 v[140:143], v19 offset:24576
    ds_read_b128 v[144:147], v19 offset:26624
    v_mfma_f32_16x16x32_bf16 v[80:83], v[100:103], v[188:191], v[80:83]
    ds_read_b128 v[148:151], v19 offset:28672
    v_mfma_f32_16x16x32_bf16 v[84:87], v[104:107], v[188:191], v[84:87]
    v_mfma_f32_16x16x32_bf16 v[88:91], v[108:111], v[188:191], v[88:91]
    s_waitcnt lgkmcnt(0)
    s_barrier
    v_mfma_f32_16x16x32_bf16 v[72:75], v[112:115], v[192:195], v[72:75]
    ds_read_b128 v[92:95], v28 offset:0
    ds_read_b128 v[96:99], v28 offset:2048
    v_mfma_f32_16x16x32_bf16 v[76:79], v[116:119], v[192:195], v[76:79]
    ds_read_b128 v[100:103], v28 offset:4096
    ds_read_b128 v[104:107], v28 offset:6144
    v_mfma_f32_16x16x32_bf16 v[80:83], v[120:123], v[192:195], v[80:83]
    ds_read_b128 v[108:111], v28 offset:8192
    s_add_u32 m0, s83, 20480
    s_nop 0
    buffer_load_dwordx4 v12, s[44:47], s78 offen lds
    v_mfma_f32_16x16x32_bf16 v[84:87], v[124:127], v[192:195], v[84:87]
    s_add_u32 m0, s83, 22528
    s_nop 0
    buffer_load_dwordx4 v12, s[44:47], s79 offen lds
    s_add_u32 m0, s83, 24576
    s_nop 0
    buffer_load_dwordx4 v12, s[44:47], s80 offen lds
    v_mfma_f32_16x16x32_bf16 v[88:91], v[128:131], v[192:195], v[88:91]
    buffer_load_dwordx4 v[168:171], v10, s[40:43], s60 offen offset:0 sc1
    buffer_load_dwordx4 v[172:175], v10, s[40:43], s60 offen offset:1024 sc1
    s_waitcnt lgkmcnt(5)
    v_mfma_f32_16x16x32_bf16 v[72:75], v[132:135], v[196:199], v[72:75]
    ds_read_b128 v[112:115], v29 offset:0
    ds_read_b128 v[116:119], v29 offset:2048
    v_mfma_f32_16x16x32_bf16 v[76:79], v[136:139], v[196:199], v[76:79]
    ds_read_b128 v[120:123], v29 offset:4096
    ds_read_b128 v[124:127], v29 offset:6144
    v_mfma_f32_16x16x32_bf16 v[80:83], v[140:143], v[196:199], v[80:83]
    ds_read_b128 v[128:131], v29 offset:8192
    s_add_u32 m0, s83, 26624
    s_nop 0
    buffer_load_dwordx4 v12, s[44:47], s81 offen lds
    v_mfma_f32_16x16x32_bf16 v[84:87], v[144:147], v[196:199], v[84:87]
    s_add_u32 m0, s83, 28672
    s_nop 0
    buffer_load_dwordx4 v12, s[44:47], s82 offen lds
    s_add_u32 s25, s25, 1
    s_cmp_eq_u32 s25, 10
    s_cselect_b32 s85, 1280, 0
    s_cselect_b32 s25, 0, s25
    s_sub_u32 s85, 128, s85
    v_add_u32 v12, s85, v12
    v_mfma_f32_16x16x32_bf16 v[88:91], v[148:151], v[196:199], v[88:91]
    buffer_load_dwordx4 v[176:179], v10, s[40:43], s60 offen offset:2048 sc1
    buffer_load_dwordx4 v[180:183], v10, s[40:43], s60 offen offset:3072 sc1
    s_add_u32 s24, s24, 1
    s_cmp_eq_u32 s24, 10
    s_cselect_b32 s85, 40960, 0
    s_cselect_b32 s24, 0, s24
    s_sub_u32 s85, 4096, s85
    v_add_u32 v10, s85, v10
    s_waitcnt vmcnt(18)
    s_waitcnt lgkmcnt(5)
    v_mfma_f32_16x16x32_bf16 v[72:75], v[92:95], v[200:203], v[72:75]
    ds_read_b128 v[132:135], v30 offset:0
    ds_read_b128 v[136:139], v30 offset:2048
    v_mfma_f32_16x16x32_bf16 v[76:79], v[96:99], v[200:203], v[76:79]
    ds_read_b128 v[140:143], v30 offset:4096
    ds_read_b128 v[144:147], v30 offset:6144
    v_mfma_f32_16x16x32_bf16 v[80:83], v[100:103], v[200:203], v[80:83]
    ds_read_b128 v[148:151], v30 offset:8192
    v_mfma_f32_16x16x32_bf16 v[84:87], v[104:107], v[200:203], v[84:87]
    v_mfma_f32_16x16x32_bf16 v[88:91], v[108:111], v[200:203], v[88:91]
    s_waitcnt lgkmcnt(5)
    v_mfma_f32_16x16x32_bf16 v[72:75], v[112:115], v[204:207], v[72:75]
    ds_read_b128 v[92:95], v31 offset:0
    ds_read_b128 v[96:99], v31 offset:2048
    v_mfma_f32_16x16x32_bf16 v[76:79], v[116:119], v[204:207], v[76:79]
    ds_read_b128 v[100:103], v31 offset:4096
    ds_read_b128 v[104:107], v31 offset:6144
    v_mfma_f32_16x16x32_bf16 v[80:83], v[120:123], v[204:207], v[80:83]
    ds_read_b128 v[108:111], v31 offset:8192
    v_mfma_f32_16x16x32_bf16 v[84:87], v[124:127], v[204:207], v[84:87]
    v_mfma_f32_16x16x32_bf16 v[88:91], v[128:131], v[204:207], v[88:91]
    s_waitcnt vmcnt(20)
    s_waitcnt lgkmcnt(0)
    s_barrier
    v_mfma_f32_16x16x32_bf16 v[72:75], v[132:135], v[208:211], v[72:75]
    ds_read_b128 v[112:115], v28 offset:20480
    ds_read_b128 v[116:119], v28 offset:22528
    v_mfma_f32_16x16x32_bf16 v[76:79], v[136:139], v[208:211], v[76:79]
    ds_read_b128 v[120:123], v28 offset:24576
    ds_read_b128 v[124:127], v28 offset:26624
    v_mfma_f32_16x16x32_bf16 v[80:83], v[140:143], v[208:211], v[80:83]
    ds_read_b128 v[128:131], v28 offset:28672
    s_add_u32 m0, s83, 40960
    s_nop 0
    buffer_load_dwordx4 v12, s[44:47], s78 offen lds
    v_mfma_f32_16x16x32_bf16 v[84:87], v[144:147], v[208:211], v[84:87]
    s_add_u32 m0, s83, 43008
    s_nop 0
    buffer_load_dwordx4 v12, s[44:47], s79 offen lds
    s_add_u32 m0, s83, 45056
    s_nop 0
    buffer_load_dwordx4 v12, s[44:47], s80 offen lds
    v_mfma_f32_16x16x32_bf16 v[88:91], v[148:151], v[208:211], v[88:91]
    buffer_load_dwordx4 v[184:187], v10, s[40:43], s60 offen offset:0 sc1
    buffer_load_dwordx4 v[188:191], v10, s[40:43], s60 offen offset:1024 sc1
    s_waitcnt lgkmcnt(5)
    v_mfma_f32_16x16x32_bf16 v[72:75], v[92:95], v[212:215], v[72:75]
    ds_read_b128 v[132:135], v29 offset:20480
    ds_read_b128 v[136:139], v29 offset:22528
    v_mfma_f32_16x16x32_bf16 v[76:79], v[96:99], v[212:215], v[76:79]
    ds_read_b128 v[140:143], v29 offset:24576
    ds_read_b128 v[144:147], v29 offset:26624
    v_mfma_f32_16x16x32_bf16 v[80:83], v[100:103], v[212:215], v[80:83]
    ds_read_b128 v[148:151], v29 offset:28672
    s_add_u32 m0, s83, 47104
    s_nop 0
    buffer_load_dwordx4 v12, s[44:47], s81 offen lds
    v_mfma_f32_16x16x32_bf16 v[84:87], v[104:107], v[212:215], v[84:87]
    s_add_u32 m0, s83, 49152
    s_nop 0
    buffer_load_dwordx4 v12, s[44:47], s82 offen lds
    s_add_u32 s25, s25, 1
    s_cmp_eq_u32 s25, 10
    s_cselect_b32 s85, 1280, 0
    s_cselect_b32 s25, 0, s25
    s_sub_u32 s85, 128, s85
    v_add_u32 v12, s85, v12
    v_mfma_f32_16x16x32_bf16 v[88:91], v[108:111], v[212:215], v[88:91]
    buffer_load_dwordx4 v[192:195], v10, s[40:43], s60 offen offset:2048 sc1
    buffer_load_dwordx4 v[196:199], v10, s[40:43], s60 offen offset:3072 sc1
    s_add_u32 s24, s24, 1
    s_cmp_eq_u32 s24, 10
    s_cselect_b32 s85, 40960, 0
    s_cselect_b32 s24, 0, s24
    s_sub_u32 s85, 4096, s85
    v_add_u32 v10, s85, v10
    s_waitcnt vmcnt(18)
    s_waitcnt lgkmcnt(5)
    v_mfma_f32_16x16x32_bf16 v[72:75], v[112:115], v[152:155], v[72:75]
    ds_read_b128 v[92:95], v30 offset:20480
    ds_read_b128 v[96:99], v30 offset:22528
    v_mfma_f32_16x16x32_bf16 v[76:79], v[116:119], v[152:155], v[76:79]
    ds_read_b128 v[100:103], v30 offset:24576
    ds_read_b128 v[104:107], v30 offset:26624
    v_mfma_f32_16x16x32_bf16 v[80:83], v[120:123], v[152:155], v[80:83]
    ds_read_b128 v[108:111], v30 offset:28672
    v_mfma_f32_16x16x32_bf16 v[84:87], v[124:127], v[152:155], v[84:87]
    v_mfma_f32_16x16x32_bf16 v[88:91], v[128:131], v[152:155], v[88:91]
    s_waitcnt lgkmcnt(5)
    v_mfma_f32_16x16x32_bf16 v[72:75], v[132:135], v[156:159], v[72:75]
    ds_read_b128 v[112:115], v31 offset:20480
    ds_read_b128 v[116:119], v31 offset:22528
    v_mfma_f32_16x16x32_bf16 v[76:79], v[136:139], v[156:159], v[76:79]
    ds_read_b128 v[120:123], v31 offset:24576
    ds_read_b128 v[124:127], v31 offset:26624
    v_mfma_f32_16x16x32_bf16 v[80:83], v[140:143], v[156:159], v[80:83]
    ds_read_b128 v[128:131], v31 offset:28672
    v_mfma_f32_16x16x32_bf16 v[84:87], v[144:147], v[156:159], v[84:87]
    v_mfma_f32_16x16x32_bf16 v[88:91], v[148:151], v[156:159], v[88:91]
    s_waitcnt vmcnt(20)
    s_waitcnt lgkmcnt(0)
    s_barrier
    v_mfma_f32_16x16x32_bf16 v[72:75], v[92:95], v[160:163], v[72:75]
    ds_read_b128 v[132:135], v16 offset:0
    ds_read_b128 v[136:139], v16 offset:2048
    v_mfma_f32_16x16x32_bf16 v[76:79], v[96:99], v[160:163], v[76:79]
    ds_read_b128 v[140:143], v16 offset:4096
    ds_read_b128 v[144:147], v16 offset:6144
    v_mfma_f32_16x16x32_bf16 v[80:83], v[100:103], v[160:163], v[80:83]
    ds_read_b128 v[148:151], v16 offset:8192
    s_add_u32 m0, s83, 61440
    s_nop 0
    buffer_load_dwordx4 v12, s[44:47], s78 offen lds
    v_mfma_f32_16x16x32_bf16 v[84:87], v[104:107], v[160:163], v[84:87]
    s_add_u32 m0, s83, 63488
    s_nop 0
    buffer_load_dwordx4 v12, s[44:47], s79 offen lds
    s_add_u32 m0, s83, 65536
    s_nop 0
    buffer_load_dwordx4 v12, s[44:47], s80 offen lds
    v_mfma_f32_16x16x32_bf16 v[88:91], v[108:111], v[160:163], v[88:91]
    buffer_load_dwordx4 v[200:203], v10, s[40:43], s60 offen offset:0 sc1
    buffer_load_dwordx4 v[204:207], v10, s[40:43], s60 offen offset:1024 sc1
    s_waitcnt lgkmcnt(5)
    v_mfma_f32_16x16x32_bf16 v[72:75], v[112:115], v[164:167], v[72:75]
    ds_read_b128 v[92:95], v17 offset:0
    ds_read_b128 v[96:99], v17 offset:2048
    v_mfma_f32_16x16x32_bf16 v[76:79], v[116:119], v[164:167], v[76:79]
    ds_read_b128 v[100:103], v17 offset:4096
    ds_read_b128 v[104:107], v17 offset:6144
    v_mfma_f32_16x16x32_bf16 v[80:83], v[120:123], v[164:167], v[80:83]
    ds_read_b128 v[108:111], v17 offset:8192
    s_add_u32 m0, s83, 67584
    s_nop 0
    buffer_load_dwordx4 v12, s[44:47], s81 offen lds
    v_mfma_f32_16x16x32_bf16 v[84:87], v[124:127], v[164:167], v[84:87]
    s_add_u32 m0, s83, 69632
    s_nop 0
    buffer_load_dwordx4 v12, s[44:47], s82 offen lds
    s_add_u32 s25, s25, 1
    s_cmp_eq_u32 s25, 10
    s_cselect_b32 s85, 1280, 0
    s_cselect_b32 s25, 0, s25
    s_sub_u32 s85, 128, s85
    v_add_u32 v12, s85, v12
    v_mfma_f32_16x16x32_bf16 v[88:91], v[128:131], v[164:167], v[88:91]
    buffer_load_dwordx4 v[208:211], v10, s[40:43], s60 offen offset:2048 sc1
    buffer_load_dwordx4 v[212:215], v10, s[40:43], s60 offen offset:3072 sc1
    s_add_u32 s24, s24, 1
    s_cmp_eq_u32 s24, 10
    s_cselect_b32 s85, 40960, 0
    s_cselect_b32 s24, 0, s24
    s_sub_u32 s85, 4096, s85
    v_add_u32 v10, s85, v10
    buffer_load_dword v23, v22, s[48:51], 0 offen sc1
    buffer_load_dword v32, v24, s[48:51], 0 offen sc1
    s_waitcnt vmcnt(20)
    s_waitcnt lgkmcnt(5)
    v_mfma_f32_16x16x32_bf16 v[72:75], v[132:135], v[168:171], v[72:75]
    ds_read_b128 v[112:115], v18 offset:0
    ds_read_b128 v[116:119], v18 offset:2048
    v_mfma_f32_16x16x32_bf16 v[76:79], v[136:139], v[168:171], v[76:79]
    ds_read_b128 v[120:123], v18 offset:4096
    ds_read_b128 v[124:127], v18 offset:6144
    v_mfma_f32_16x16x32_bf16 v[80:83], v[140:143], v[168:171], v[80:83]
    ds_read_b128 v[128:131], v18 offset:8192
    v_mfma_f32_16x16x32_bf16 v[84:87], v[144:147], v[168:171], v[84:87]
    v_mfma_f32_16x16x32_bf16 v[88:91], v[148:151], v[168:171], v[88:91]
    s_waitcnt lgkmcnt(5)
    v_mfma_f32_16x16x32_bf16 v[72:75], v[92:95], v[172:175], v[72:75]
    ds_read_b128 v[132:135], v19 offset:0
    ds_read_b128 v[136:139], v19 offset:2048
    v_mfma_f32_16x16x32_bf16 v[76:79], v[96:99], v[172:175], v[76:79]
    ds_read_b128 v[140:143], v19 offset:4096
    ds_read_b128 v[144:147], v19 offset:6144
    v_mfma_f32_16x16x32_bf16 v[80:83], v[100:103], v[172:175], v[80:83]
    ds_read_b128 v[148:151], v19 offset:8192
    v_mfma_f32_16x16x32_bf16 v[84:87], v[104:107], v[172:175], v[84:87]
    v_mfma_f32_16x16x32_bf16 v[88:91], v[108:111], v[172:175], v[88:91]
    s_waitcnt vmcnt(22)
    s_waitcnt lgkmcnt(0)
    s_barrier
    v_mfma_f32_16x16x32_bf16 v[72:75], v[112:115], v[176:179], v[72:75]
    ds_read_b128 v[92:95], v16 offset:20480
    ds_read_b128 v[96:99], v16 offset:22528
    v_mfma_f32_16x16x32_bf16 v[76:79], v[116:119], v[176:179], v[76:79]
    ds_read_b128 v[100:103], v16 offset:24576
    ds_read_b128 v[104:107], v16 offset:26624
    v_mfma_f32_16x16x32_bf16 v[80:83], v[120:123], v[176:179], v[80:83]
    ds_read_b128 v[108:111], v16 offset:28672
    s_add_u32 m0, s83, 0
    s_nop 0
    buffer_load_dwordx4 v12, s[44:47], s78 offen lds
    v_mfma_f32_16x16x32_bf16 v[84:87], v[124:127], v[176:179], v[84:87]
    s_add_u32 m0, s83, 2048
    s_nop 0
    buffer_load_dwordx4 v12, s[44:47], s79 offen lds
    s_add_u32 m0, s83, 4096
    s_nop 0
    buffer_load_dwordx4 v12, s[44:47], s80 offen lds
    v_mfma_f32_16x16x32_bf16 v[88:91], v[128:131], v[176:179], v[88:91]
    buffer_load_dwordx4 v[152:155], v10, s[40:43], s60 offen offset:0 sc1
    buffer_load_dwordx4 v[156:159], v10, s[40:43], s60 offen offset:1024 sc1
    s_waitcnt lgkmcnt(5)
    v_mfma_f32_16x16x32_bf16 v[72:75], v[132:135], v[180:183], v[72:75]
    ds_read_b128 v[112:115], v17 offset:20480
    ds_read_b128 v[116:119], v17 offset:22528
    v_mfma_f32_16x16x32_bf16 v[76:79], v[136:139], v[180:183], v[76:79]
    ds_read_b128 v[120:123], v17 offset:24576
    ds_read_b128 v[124:127], v17 offset:26624
    v_mfma_f32_16x16x32_bf16 v[80:83], v[140:143], v[180:183], v[80:83]
    ds_read_b128 v[128:131], v17 offset:28672
    s_add_u32 m0, s83, 6144
    s_nop 0
    buffer_load_dwordx4 v12, s[44:47], s81 offen lds
    v_mfma_f32_16x16x32_bf16 v[84:87], v[144:147], v[180:183], v[84:87]
    s_add_u32 m0, s83, 8192
    s_nop 0
    buffer_load_dwordx4 v12, s[44:47], s82 offen lds
    s_add_u32 s25, s25, 1
    s_cmp_eq_u32 s25, 10
    s_cselect_b32 s85, 1280, 0
    s_cselect_b32 s25, 0, s25
    s_sub_u32 s85, 128, s85
    v_add_u32 v12, s85, v12
    v_mfma_f32_16x16x32_bf16 v[88:91], v[148:151], v[180:183], v[88:91]
    buffer_load_dwordx4 v[160:163], v10, s[40:43], s60 offen offset:2048 sc1
    buffer_load_dwordx4 v[164:167], v10, s[40:43], s60 offen offset:3072 sc1
    s_add_u32 s24, s24, 1
    s_cmp_eq_u32 s24, 10
    s_cselect_b32 s85, 40960, 0
    s_cselect_b32 s24, 0, s24
    s_sub_u32 s85, 4096, s85
    v_add_u32 v10, s85, v10
    s_waitcnt vmcnt(20)
    s_waitcnt lgkmcnt(5)
    v_mfma_f32_16x16x32_bf16 v[72:75], v[92:95], v[184:187], v[72:75]
    ds_read_b128 v[132:135], v18 offset:20480
    ds_read_b128 v[136:139], v18 offset:22528
    v_mfma_f32_16x16x32_bf16 v[76:79], v[96:99], v[184:187], v[76:79]
    ds_read_b128 v[140:143], v18 offset:24576
    ds_read_b128 v[144:147], v18 offset:26624
    v_mfma_f32_16x16x32_bf16 v[80:83], v[100:103], v[184:187], v[80:83]
    ds_read_b128 v[148:151], v18 offset:28672
    v_mfma_f32_16x16x32_bf16 v[84:87], v[104:107], v[184:187], v[84:87]
    v_mfma_f32_16x16x32_bf16 v[88:91], v[108:111], v[184:187], v[88:91]
    s_waitcnt lgkmcnt(5)
    v_mfma_f32_16x16x32_bf16 v[72:75], v[112:115], v[188:191], v[72:75]
    ds_read_b128 v[92:95], v19 offset:20480
    ds_read_b128 v[96:99], v19 offset:22528
    v_mfma_f32_16x16x32_bf16 v[76:79], v[116:119], v[188:191], v[76:79]
    ds_read_b128 v[100:103], v19 offset:24576
    ds_read_b128 v[104:107], v19 offset:26624
    v_mfma_f32_16x16x32_bf16 v[80:83], v[120:123], v[188:191], v[80:83]
    ds_read_b128 v[108:111], v19 offset:28672
    v_mfma_f32_16x16x32_bf16 v[84:87], v[124:127], v[188:191], v[84:87]
    v_mfma_f32_16x16x32_bf16 v[88:91], v[128:131], v[188:191], v[88:91]
    s_waitcnt vmcnt(22)
    s_waitcnt lgkmcnt(0)
    s_barrier
    v_mfma_f32_16x16x32_bf16 v[72:75], v[132:135], v[192:195], v[72:75]
    ds_read_b128 v[112:115], v28 offset:0
    ds_read_b128 v[116:119], v28 offset:2048
    v_mfma_f32_16x16x32_bf16 v[76:79], v[136:139], v[192:195], v[76:79]
    ds_read_b128 v[120:123], v28 offset:4096
    ds_read_b128 v[124:127], v28 offset:6144
    v_mfma_f32_16x16x32_bf16 v[80:83], v[140:143], v[192:195], v[80:83]
    ds_read_b128 v[128:131], v28 offset:8192
    buffer_load_dwordx4 v[168:171], v10, s[40:43], s60 offen offset:0 sc1
    v_mfma_f32_16x16x32_bf16 v[84:87], v[144:147], v[192:195], v[84:87]
    buffer_load_dwordx4 v[172:175], v10, s[40:43], s60 offen offset:1024 sc1
    v_mfma_f32_16x16x32_bf16 v[88:91], v[148:151], v[192:195], v[88:91]
    s_waitcnt lgkmcnt(5)
    v_mfma_f32_16x16x32_bf16 v[72:75], v[92:95], v[196:199], v[72:75]
    ds_read_b128 v[132:135], v29 offset:0
    ds_read_b128 v[136:139], v29 offset:2048
    v_mfma_f32_16x16x32_bf16 v[76:79], v[96:99], v[196:199], v[76:79]
    ds_read_b128 v[140:143], v29 offset:4096
    ds_read_b128 v[144:147], v29 offset:6144
    v_mfma_f32_16x16x32_bf16 v[80:83], v[100:103], v[196:199], v[80:83]
    ds_read_b128 v[148:151], v29 offset:8192
    buffer_load_dwordx4 v[176:179], v10, s[40:43], s60 offen offset:2048 sc1
    v_mfma_f32_16x16x32_bf16 v[84:87], v[104:107], v[196:199], v[84:87]
    buffer_load_dwordx4 v[180:183], v10, s[40:43], s60 offen offset:3072 sc1
    s_add_u32 s24, s24, 1
    s_cmp_eq_u32 s24, 10
    s_cselect_b32 s85, 40960, 0
    s_cselect_b32 s24, 0, s24
    s_sub_u32 s85, 4096, s85
    v_add_u32 v10, s85, v10
    v_mfma_f32_16x16x32_bf16 v[88:91], v[108:111], v[196:199], v[88:91]
    s_mov_b32 s8, 0
    s_waitcnt vmcnt(13)
fp_39:
    v_cmp_eq_u32 vcc, s74, v23
    v_cmp_eq_u32 s[4:5], s74, v32
    s_nop 4
    s_and_b64 vcc, vcc, s[4:5]
    s_cmp_eq_u64 vcc, -1
    s_cbranch_scc1 fok_40
    s_sleep 1
    buffer_load_dword v23, v22, s[48:51], 0 offen sc1
    buffer_load_dword v32, v24, s[48:51], 0 offen sc1
    s_add_u32 s8, s8, 1
    s_waitcnt vmcnt(0)
    s_cmp_lt_u32 s8, 100000
    s_cbranch_scc1 fp_39
fok_40:
    s_add_u32 s44, s26, 10698752
    s_addc_u32 s45, s27, 0
    s_and_b32 s45, s45, 0xffff
    s_mov_b32 s46, 2621440
    s_mov_b32 s47, 0x00020000
    buffer_load_dwordx4 v[228:231], v34, s[44:47], s64 offen sc1
    buffer_load_dwordx4 v[232:235], v35, s[44:47], s64 offen sc1
    buffer_load_dwordx4 v[236:239], v36, s[44:47], s64 offen sc1
    s_add_u32 s12, s26, 5406720
    s_addc_u32 s13, s27, 0
    s_and_b32 s13, s13, 0xffff
    s_mov_b32 s14, 8192
    s_mov_b32 s15, 0x00020000
    buffer_load_dword v240, v41, s[12:15], 0 offen sc1
    s_waitcnt vmcnt(19)
    s_waitcnt lgkmcnt(5)
    v_mfma_f32_16x16x32_bf16 v[72:75], v[112:115], v[200:203], v[72:75]
    ds_read_b128 v[92:95], v30 offset:0
    ds_read_b128 v[96:99], v30 offset:2048
    v_mfma_f32_16x16x32_bf16 v[76:79], v[116:119], v[200:203], v[76:79]
    ds_read_b128 v[100:103], v30 offset:4096
    ds_read_b128 v[104:107], v30 offset:6144
    v_mfma_f32_16x16x32_bf16 v[80:83], v[120:123], v[200:203], v[80:83]
    ds_read_b128 v[108:111], v30 offset:8192
    buffer_load_dwordx4 v[184:187], v44, s[28:31], s67 offen
    v_mfma_f32_16x16x32_bf16 v[84:87], v[124:127], v[200:203], v[84:87]
    buffer_load_dwordx4 v[188:191], v45, s[28:31], s67 offen
    buffer_load_dwordx4 v[192:195], v46, s[28:31], s67 offen
    v_mfma_f32_16x16x32_bf16 v[88:91], v[128:131], v[200:203], v[88:91]
    s_waitcnt lgkmcnt(5)
    v_mfma_f32_16x16x32_bf16 v[72:75], v[132:135], v[204:207], v[72:75]
    ds_read_b128 v[112:115], v31 offset:0
    ds_read_b128 v[116:119], v31 offset:2048
    v_mfma_f32_16x16x32_bf16 v[76:79], v[136:139], v[204:207], v[76:79]
    ds_read_b128 v[120:123], v31 offset:4096
    ds_read_b128 v[124:127], v31 offset:6144
    v_mfma_f32_16x16x32_bf16 v[80:83], v[140:143], v[204:207], v[80:83]
    ds_read_b128 v[128:131], v31 offset:8192
    v_mfma_f32_16x16x32_bf16 v[84:87], v[144:147], v[204:207], v[84:87]
    v_mfma_f32_16x16x32_bf16 v[88:91], v[148:151], v[204:207], v[88:91]
    s_waitcnt vmcnt(24)
    s_waitcnt lgkmcnt(0)
    s_barrier
    v_mfma_f32_16x16x32_bf16 v[72:75], v[92:95], v[208:211], v[72:75]
    ds_read_b128 v[132:135], v28 offset:20480
    ds_read_b128 v[136:139], v28 offset:22528
    v_mfma_f32_16x16x32_bf16 v[76:79], v[96:99], v[208:211], v[76:79]
    ds_read_b128 v[140:143], v28 offset:24576
    ds_read_b128 v[144:147], v28 offset:26624
    v_mfma_f32_16x16x32_bf16 v[80:83], v[100:103], v[208:211], v[80:83]
    ds_read_b128 v[148:151], v28 offset:28672
    v_mfma_f32_16x16x32_bf16 v[84:87], v[104:107], v[208:211], v[84:87]
    v_mfma_f32_16x16x32_bf16 v[88:91], v[108:111], v[208:211], v[88:91]
    s_waitcnt lgkmcnt(5)
    v_mfma_f32_16x16x32_bf16 v[72:75], v[112:115], v[212:215], v[72:75]
    ds_read_b128 v[92:95], v29 offset:20480
    ds_read_b128 v[96:99], v29 offset:22528
    v_mfma_f32_16x16x32_bf16 v[76:79], v[116:119], v[212:215], v[76:79]
    ds_read_b128 v[100:103], v29 offset:24576
    ds_read_b128 v[104:107], v29 offset:26624
    v_mfma_f32_16x16x32_bf16 v[80:83], v[120:123], v[212:215], v[80:83]
    ds_read_b128 v[108:111], v29 offset:28672
    v_mfma_f32_16x16x32_bf16 v[84:87], v[124:127], v[212:215], v[84:87]
    v_mfma_f32_16x16x32_bf16 v[88:91], v[128:131], v[212:215], v[88:91]
    s_waitcnt vmcnt(11)
    s_waitcnt lgkmcnt(5)
    v_mfma_f32_16x16x32_bf16 v[72:75], v[132:135], v[152:155], v[72:75]
    ds_read_b128 v[112:115], v30 offset:20480
    ds_read_b128 v[116:119], v30 offset:22528
    v_mfma_f32_16x16x32_bf16 v[76:79], v[136:139], v[152:155], v[76:79]
    ds_read_b128 v[120:123], v30 offset:24576
    ds_read_b128 v[124:127], v30 offset:26624
    v_mfma_f32_16x16x32_bf16 v[80:83], v[140:143], v[152:155], v[80:83]
    ds_read_b128 v[128:131], v30 offset:28672
    v_mfma_f32_16x16x32_bf16 v[84:87], v[144:147], v[152:155], v[84:87]
    v_mfma_f32_16x16x32_bf16 v[88:91], v[148:151], v[152:155], v[88:91]
    s_waitcnt lgkmcnt(5)
    v_mfma_f32_16x16x32_bf16 v[72:75], v[92:95], v[156:159], v[72:75]
    ds_read_b128 v[132:135], v31 offset:20480
    ds_read_b128 v[136:139], v31 offset:22528
    v_mfma_f32_16x16x32_bf16 v[76:79], v[96:99], v[156:159], v[76:79]
    ds_read_b128 v[140:143], v31 offset:24576
    ds_read_b128 v[144:147], v31 offset:26624
    v_mfma_f32_16x16x32_bf16 v[80:83], v[100:103], v[156:159], v[80:83]
    ds_read_b128 v[148:151], v31 offset:28672
    v_mfma_f32_16x16x32_bf16 v[84:87], v[104:107], v[156:159], v[84:87]
    v_mfma_f32_16x16x32_bf16 v[88:91], v[108:111], v[156:159], v[88:91]
    s_waitcnt vmcnt(13)
    s_waitcnt lgkmcnt(0)
    s_barrier
    v_mfma_f32_16x16x32_bf16 v[72:75], v[112:115], v[160:163], v[72:75]
    ds_read_b128 v[92:95], v16 offset:0
    ds_read_b128 v[96:99], v16 offset:2048
    v_mfma_f32_16x16x32_bf16 v[76:79], v[116:119], v[160:163], v[76:79]
    ds_read_b128 v[100:103], v16 offset:4096
    ds_read_b128 v[104:107], v16 offset:6144
    v_mfma_f32_16x16x32_bf16 v[80:83], v[120:123], v[160:163], v[80:83]
    ds_read_b128 v[108:111], v16 offset:8192
    v_mfma_f32_16x16x32_bf16 v[84:87], v[124:127], v[160:163], v[84:87]
    v_mfma_f32_16x16x32_bf16 v[88:91], v[128:131], v[160:163], v[88:91]
    s_waitcnt lgkmcnt(5)
    v_mfma_f32_16x16x32_bf16 v[72:75], v[132:135], v[164:167], v[72:75]
    ds_read_b128 v[112:115], v17 offset:0
    ds_read_b128 v[116:119], v17 offset:2048
    v_mfma_f32_16x16x32_bf16 v[76:79], v[136:139], v[164:167], v[76:79]
    ds_read_b128 v[120:123], v17 offset:4096
    ds_read_b128 v[124:127], v17 offset:6144
    v_mfma_f32_16x16x32_bf16 v[80:83], v[140:143], v[164:167], v[80:83]
    ds_read_b128 v[128:131], v17 offset:8192
    s_waitcnt vmcnt(4)
    ds_write_b128 v38, v[228:231]
    ds_write_b128 v39, v[232:235]
    ds_write_b128 v40, v[236:239]
    v_mfma_f32_16x16x32_bf16 v[84:87], v[144:147], v[164:167], v[84:87]
    v_mfma_f32_16x16x32_bf16 v[88:91], v[148:151], v[164:167], v[88:91]
    s_waitcnt lgkmcnt(0)
    s_waitcnt vmcnt(7)
    s_waitcnt lgkmcnt(5)
    v_mfma_f32_16x16x32_bf16 v[72:75], v[92:95], v[168:171], v[72:75]
    ds_read_b128 v[132:135], v18 offset:0
    ds_read_b128 v[136:139], v18 offset:2048
    v_mfma_f32_16x16x32_bf16 v[76:79], v[96:99], v[168:171], v[76:79]
    ds_read_b128 v[140:143], v18 offset:4096
    ds_read_b128 v[144:147], v18 offset:6144
    v_mfma_f32_16x16x32_bf16 v[80:83], v[100:103], v[168:171], v[80:83]
    ds_read_b128 v[148:151], v18 offset:8192
    v_mfma_f32_16x16x32_bf16 v[84:87], v[104:107], v[168:171], v[84:87]
    v_mfma_f32_16x16x32_bf16 v[88:91], v[108:111], v[168:171], v[88:91]
    s_waitcnt lgkmcnt(5)
    v_mfma_f32_16x16x32_bf16 v[72:75], v[112:115], v[172:175], v[72:75]
    ds_read_b128 v[92:95], v19 offset:0
    ds_read_b128 v[96:99], v19 offset:2048
    v_mfma_f32_16x16x32_bf16 v[76:79], v[116:119], v[172:175], v[76:79]
    ds_read_b128 v[100:103], v19 offset:4096
    ds_read_b128 v[104:107], v19 offset:6144
    v_mfma_f32_16x16x32_bf16 v[80:83], v[120:123], v[172:175], v[80:83]
    ds_read_b128 v[108:111], v19 offset:8192
    v_mfma_f32_16x16x32_bf16 v[84:87], v[124:127], v[172:175], v[84:87]
    v_mfma_f32_16x16x32_bf16 v[88:91], v[128:131], v[172:175], v[88:91]
    s_waitcnt lgkmcnt(0)
    v_mfma_f32_16x16x32_bf16 v[72:75], v[132:135], v[176:179], v[72:75]
    v_mfma_f32_16x16x32_bf16 v[76:79], v[136:139], v[176:179], v[76:79]
    v_mfma_f32_16x16x32_bf16 v[80:83], v[140:143], v[176:179], v[80:83]
    v_mfma_f32_16x16x32_bf16 v[84:87], v[144:147], v[176:179], v[84:87]
    v_mfma_f32_16x16x32_bf16 v[88:91], v[148:151], v[176:179], v[88:91]
    s_waitcnt lgkmcnt(0)
    v_mfma_f32_16x16x32_bf16 v[72:75], v[92:95], v[180:183], v[72:75]
    s_waitcnt vmcnt(0)
    ds_write_b128 v48, v[184:187]
    ds_write_b128 v49, v[188:191]
    ds_write_b128 v50, v[192:195]
    ds_read_b64_tr_b16 v[242:243], v42 offset:0
    v_mfma_f32_16x16x32_bf16 v[76:79], v[96:99], v[180:183], v[76:79]
    ds_read_b64_tr_b16 v[244:245], v42 offset:512
    ds_read_b64_tr_b16 v[246:247], v42 offset:1024
    v_mfma_f32_16x16x32_bf16 v[80:83], v[100:103], v[180:183], v[80:83]
    ds_read_b64_tr_b16 v[248:249], v42 offset:1536
    ds_read_b64_tr_b16 v[250:251], v42 offset:2048
    v_mfma_f32_16x16x32_bf16 v[84:87], v[104:107], v[180:183], v[84:87]
    ds_read_b64 v[216:217], v51 offset:0
    ds_read_b64 v[218:219], v51 offset:32
    v_mfma_f32_16x16x32_bf16 v[88:91], v[108:111], v[180:183], v[88:91]
    ds_read_b64 v[220:221], v51 offset:64
    ds_read_b64 v[222:223], v51 offset:96
    ds_read_b64 v[224:225], v51 offset:128
    s_waitcnt vmcnt(0) lgkmcnt(0)
    s_nop 4
    v_lshlrev_b32 v2, 16, v216
    v_lshlrev_b32 v3, 16, v60
    v_lshlrev_b32 v4, 16, v242
    v_fma_f32 v72, v2, v3, v72
    v_sub_f32 v4, v4, v72
    v_fma_f32 v72, v240, v4, v72
    v_and_b32 v2, 0xffff0000, v216
    v_and_b32 v3, 0xffff0000, v60
    v_and_b32 v4, 0xffff0000, v242
    v_fma_f32 v73, v2, v3, v73
    v_sub_f32 v4, v4, v73
    v_fma_f32 v73, v240, v4, v73
    v_lshlrev_b32 v2, 16, v217
    v_lshlrev_b32 v3, 16, v61
    v_lshlrev_b32 v4, 16, v243
    v_fma_f32 v74, v2, v3, v74
    v_sub_f32 v4, v4, v74
    v_fma_f32 v74, v240, v4, v74
    v_and_b32 v2, 0xffff0000, v217
    v_and_b32 v3, 0xffff0000, v61
    v_and_b32 v4, 0xffff0000, v243
    v_fma_f32 v75, v2, v3, v75
    v_sub_f32 v4, v4, v75
    v_fma_f32 v75, v240, v4, v75
    ds_write_b128 v52, v[72:75] offset:0
    v_lshlrev_b32 v2, 16, v218
    v_lshlrev_b32 v3, 16, v62
    v_lshlrev_b32 v4, 16, v244
    v_fma_f32 v76, v2, v3, v76
    v_sub_f32 v4, v4, v76
    v_fma_f32 v76, v240, v4, v76
    v_and_b32 v2, 0xffff0000, v218
    v_and_b32 v3, 0xffff0000, v62
    v_and_b32 v4, 0xffff0000, v244
    v_fma_f32 v77, v2, v3, v77
    v_sub_f32 v4, v4, v77
    v_fma_f32 v77, v240, v4, v77
    v_lshlrev_b32 v2, 16, v219
    v_lshlrev_b32 v3, 16, v63
    v_lshlrev_b32 v4, 16, v245
    v_fma_f32 v78, v2, v3, v78
    v_sub_f32 v4, v4, v78
    v_fma_f32 v78, v240, v4, v78
    v_and_b32 v2, 0xffff0000, v219
    v_and_b32 v3, 0xffff0000, v63
    v_and_b32 v4, 0xffff0000, v245
    v_fma_f32 v79, v2, v3, v79
    v_sub_f32 v4, v4, v79
    v_fma_f32 v79, v240, v4, v79
    ds_write_b128 v52, v[76:79] offset:64
    v_lshlrev_b32 v2, 16, v220
    v_lshlrev_b32 v3, 16, v64
    v_lshlrev_b32 v4, 16, v246
    v_fma_f32 v80, v2, v3, v80
    v_sub_f32 v4, v4, v80
    v_fma_f32 v80, v240, v4, v80
    v_and_b32 v2, 0xffff0000, v220
    v_and_b32 v3, 0xffff0000, v64
    v_and_b32 v4, 0xffff0000, v246
    v_fma_f32 v81, v2, v3, v81
    v_sub_f32 v4, v4, v81
    v_fma_f32 v81, v240, v4, v81
    v_lshlrev_b32 v2, 16, v221
    v_lshlrev_b32 v3, 16, v65
    v_lshlrev_b32 v4, 16, v247
    v_fma_f32 v82, v2, v3, v82
    v_sub_f32 v4, v4, v82
    v_fma_f32 v82, v240, v4, v82
    v_and_b32 v2, 0xffff0000, v221
    v_and_b32 v3, 0xffff0000, v65
    v_and_b32 v4, 0xffff0000, v247
    v_fma_f32 v83, v2, v3, v83
    v_sub_f32 v4, v4, v83
    v_fma_f32 v83, v240, v4, v83
    ds_write_b128 v52, v[80:83] offset:128
    v_lshlrev_b32 v2, 16, v222
    v_lshlrev_b32 v3, 16, v66
    v_lshlrev_b32 v4, 16, v248
    v_fma_f32 v84, v2, v3, v84
    v_sub_f32 v4, v4, v84
    v_fma_f32 v84, v240, v4, v84
    v_and_b32 v2, 0xffff0000, v222
    v_and_b32 v3, 0xffff0000, v66
    v_and_b32 v4, 0xffff0000, v248
    v_fma_f32 v85, v2, v3, v85
    v_sub_f32 v4, v4, v85
    v_fma_f32 v85, v240, v4, v85
    v_lshlrev_b32 v2, 16, v223
    v_lshlrev_b32 v3, 16, v67
    v_lshlrev_b32 v4, 16, v249
    v_fma_f32 v86, v2, v3, v86
    v_sub_f32 v4, v4, v86
    v_fma_f32 v86, v240, v4, v86
    v_and_b32 v2, 0xffff0000, v223
    v_and_b32 v3, 0xffff0000, v67
    v_and_b32 v4, 0xffff0000, v249
    v_fma_f32 v87, v2, v3, v87
    v_sub_f32 v4, v4, v87
    v_fma_f32 v87, v240, v4, v87
    ds_write_b128 v52, v[84:87] offset:192
    v_lshlrev_b32 v2, 16, v224
    v_lshlrev_b32 v3, 16, v68
    v_lshlrev_b32 v4, 16, v250
    v_fma_f32 v88, v2, v3, v88
    v_sub_f32 v4, v4, v88
    v_fma_f32 v88, v240, v4, v88
    v_and_b32 v2, 0xffff0000, v224
    v_and_b32 v3, 0xffff0000, v68
    v_and_b32 v4, 0xffff0000, v250
    v_fma_f32 v89, v2, v3, v89
    v_sub_f32 v4, v4, v89
    v_fma_f32 v89, v240, v4, v89
    v_lshlrev_b32 v2, 16, v225
    v_lshlrev_b32 v3, 16, v69
    v_lshlrev_b32 v4, 16, v251
    v_fma_f32 v90, v2, v3, v90
    v_sub_f32 v4, v4, v90
    v_fma_f32 v90, v240, v4, v90
    v_and_b32 v2, 0xffff0000, v225
    v_and_b32 v3, 0xffff0000, v69
    v_and_b32 v4, 0xffff0000, v251
    v_fma_f32 v91, v2, v3, v91
    v_sub_f32 v4, v4, v91
    v_fma_f32 v91, v240, v4, v91
    ds_write_b128 v52, v[88:91] offset:256
    s_waitcnt lgkmcnt(0)
    ds_read_b128 v[152:155], v53 offset:0
    ds_read_b128 v[156:159], v53 offset:1024
    ds_read_b128 v[160:163], v53 offset:2048
    ds_read_b128 v[164:167], v53 offset:3072
    ds_read_b128 v[168:171], v53 offset:4096
    s_waitcnt lgkmcnt(4)
    buffer_store_dwordx4 v[152:155], v54, s[36:39], s68 offen sc1
    s_waitcnt lgkmcnt(3)
    buffer_store_dwordx4 v[156:159], v55, s[36:39], s68 offen sc1
    s_waitcnt lgkmcnt(2)
    buffer_store_dwordx4 v[160:163], v56, s[36:39], s68 offen sc1
    s_waitcnt lgkmcnt(1)
    buffer_store_dwordx4 v[164:167], v57, s[36:39], s68 offen sc1
    s_waitcnt lgkmcnt(0)
    buffer_store_dwordx4 v[168:171], v58, s[36:39], s68 offen sc1
    s_cmp_lg_u32 s75, 31
    s_cbranch_scc1 nobump_41
    s_or_b32 s55, s76, s52
    s_cmp_lg_u32 s55, 0
    s_cbranch_scc1 nobump_41
    v_lshlrev_b32 v92, 2, v1
    v_lshlrev_b32 v93, 2, v1
    v_add_u32 v93, 256, v93
    v_lshlrev_b32 v94, 2, v1
    v_add_u32 v94, 512, v94
    v_lshlrev_b32 v95, 2, v1
    v_add_u32 v95, 768, v95
    v_add_u32 v2, 0, v1
    v_mul_u32_u24 v3, 205, v2
    v_lshrrev_b32 v3, 14, v3
    v_lshlrev_b32 v3, 6, v3
    v_lshlrev_b32 v2, 2, v2
    v_add_u32 v96, v2, v3
    v_add_u32 v96, 9216, v96
    v_add_u32 v2, 64, v1
    v_mul_u32_u24 v3, 205, v2
    v_lshrrev_b32 v3, 14, v3
    v_lshlrev_b32 v3, 6, v3
    v_lshlrev_b32 v2, 2, v2
    v_add_u32 v97, v2, v3
    v_add_u32 v97, 9216, v97
    v_add_u32 v2, 128, v1
    v_mul_u32_u24 v3, 205, v2
    v_lshrrev_b32 v3, 14, v3
    v_lshlrev_b32 v3, 6, v3
    v_lshlrev_b32 v2, 2, v2
    v_add_u32 v98, v2, v3
    v_add_u32 v98, 9216, v98
    v_add_u32 v2, 192, v1
    v_mul_u32_u24 v3, 205, v2
    v_lshrrev_b32 v3, 14, v3
    v_lshlrev_b32 v3, 6, v3
    v_lshlrev_b32 v2, 2, v2
    v_add_u32 v99, v2, v3
    v_add_u32 v99, 9216, v99
    v_add_u32 v2, 256, v1
    v_mul_u32_u24 v3, 205, v2
    v_lshrrev_b32 v3, 14, v3
    v_lshlrev_b32 v3, 6, v3
    v_lshlrev_b32 v2, 2, v2
    v_add_u32 v100, v2, v3
    v_add_u32 v100, 9216, v100
    v_add_u32 v2, 320, v1
    v_mul_u32_u24 v3, 205, v2
    v_lshrrev_b32 v3, 14, v3
    v_lshlrev_b32 v3, 6, v3
    v_lshlrev_b32 v2, 2, v2
    v_add_u32 v101, v2, v3
    v_add_u32 v101, 9216, v101
    v_add_u32 v2, 384, v1
    v_mul_u32_u24 v3, 205, v2
    v_lshrrev_b32 v3, 14, v3
    v_lshlrev_b32 v3, 6, v3
    v_lshlrev_b32 v2, 2, v2
    v_add_u32 v102, v2, v3
    v_add_u32 v102, 9216, v102
    v_add_u32 v2, 448, v1
    v_mul_u32_u24 v3, 205, v2
    v_lshrrev_b32 v3, 14, v3
    v_lshlrev_b32 v3, 6, v3
    v_lshlrev_b32 v2, 2, v2
    v_add_u32 v103, v2, v3
    v_add_u32 v103, 9216, v103
    v_add_u32 v2, 512, v1
    v_mul_u32_u24 v3, 205, v2
    v_lshrrev_b32 v3, 14, v3
    v_lshlrev_b32 v3, 6, v3
    v_lshlrev_b32 v2, 2, v2
    v_add_u32 v104, v2, v3
    v_add_u32 v104, 9216, v104
    v_add_u32 v2, 576, v1
    v_mul_u32_u24 v3, 205, v2
    v_lshrrev_b32 v3, 14, v3
    v_lshlrev_b32 v3, 6, v3
    v_lshlrev_b32 v2, 2, v2
    v_add_u32 v105, v2, v3
    v_add_u32 v105, 9216, v105
    s_mov_b32 s8, 0
bump_42:
    buffer_load_dword v108, v92, s[48:51], 0 offen sc1
    buffer_load_dword v109, v93, s[48:51], 0 offen sc1
    buffer_load_dword v110, v94, s[48:51], 0 offen sc1
    buffer_load_dword v111, v95, s[48:51], 0 offen sc1
    buffer_load_dword v112, v96, s[48:51], 0 offen sc1
    buffer_load_dword v113, v97, s[48:51], 0 offen sc1
    buffer_load_dword v114, v98, s[48:51], 0 offen sc1
    buffer_load_dword v115, v99, s[48:51], 0 offen sc1
    buffer_load_dword v116, v100, s[48:51], 0 offen sc1
    buffer_load_dword v117, v101, s[48:51], 0 offen sc1
    buffer_load_dword v118, v102, s[48:51], 0 offen sc1
    buffer_load_dword v119, v103, s[48:51], 0 offen sc1
    buffer_load_dword v120, v104, s[48:51], 0 offen sc1
    buffer_load_dword v121, v105, s[48:51], 0 offen sc1
    s_waitcnt vmcnt(0)
    s_mov_b64 s[6:7], -1
    v_cmp_eq_u32 vcc, s74, v108
    s_nop 4
    s_and_b64 s[6:7], s[6:7], vcc
    v_cmp_eq_u32 vcc, s74, v109
    s_nop 4
    s_and_b64 s[6:7], s[6:7], vcc
    v_cmp_eq_u32 vcc, s74, v110
    s_nop 4
    s_and_b64 s[6:7], s[6:7], vcc
    v_cmp_eq_u32 vcc, s74, v111
    s_nop 4
    s_and_b64 s[6:7], s[6:7], vcc
    v_cmp_eq_u32 vcc, s74, v112
    s_nop 4
    s_and_b64 s[6:7], s[6:7], vcc
    v_cmp_eq_u32 vcc, s74, v113
    s_nop 4
    s_and_b64 s[6:7], s[6:7], vcc
    v_cmp_eq_u32 vcc, s74, v114
    s_nop 4
    s_and_b64 s[6:7], s[6:7], vcc
    v_cmp_eq_u32 vcc, s74, v115
    s_nop 4
    s_and_b64 s[6:7], s[6:7], vcc
    v_cmp_eq_u32 vcc, s74, v116
    s_nop 4
    s_and_b64 s[6:7], s[6:7], vcc
    v_cmp_eq_u32 vcc, s74, v117
    s_nop 4
    s_and_b64 s[6:7], s[6:7], vcc
    v_cmp_eq_u32 vcc, s74, v118
    s_nop 4
    s_and_b64 s[6:7], s[6:7], vcc
    v_cmp_eq_u32 vcc, s74, v119
    s_nop 4
    s_and_b64 s[6:7], s[6:7], vcc
    v_cmp_eq_u32 vcc, s74, v120
    s_nop 4
    s_and_b64 s[6:7], s[6:7], vcc
    v_cmp_eq_u32 vcc, s74, v121
    s_nop 4
    s_and_b64 s[6:7], s[6:7], vcc
    s_cmp_eq_u64 s[6:7], -1
    s_cbranch_scc1 bumpok_43
    s_sleep 8
    s_add_u32 s8, s8, 1
    s_cmp_lt_u32 s8, 50000
    s_cbranch_scc1 bump_42
bumpok_43:
    s_add_u32 s28, s26, 13320192
    s_addc_u32 s29, s27, 0
    s_and_b32 s29, s29, 0xffff
    s_mov_b32 s30, 256
    s_mov_b32 s31, 0x00020000
    v_mov_b32 v2, 0
    v_mov_b32 v3, s74
    v_cmp_eq_u32 vcc, 0, v1
    s_and_saveexec_b64 s[70:71], vcc
    buffer_store_dword v3, v2, s[28:31], 0 offen sc1
    s_mov_b64 exec, s[70:71]
nobump_41:
L_done:
    s_endpgm
.section .rodata,"a"
.p2align 6
.amdhsa_kernel gated_mix__ssm_conv_s4d__ssm_conv_s5__prompt_kernel
  .amdhsa_next_free_vgpr 256
  .amdhsa_next_free_sgpr 102
  .amdhsa_accum_offset 256
  .amdhsa_group_segment_fixed_size 0
  .amdhsa_kernarg_size 160
  .amdhsa_user_sgpr_count 2
  .amdhsa_user_sgpr_kernarg_segment_ptr 1
  .amdhsa_system_sgpr_workgroup_id_x 1
.end_amdhsa_kernel
```
